```python
import torch

def _softmax(x, axis=-1):
    return torch.softmax(x, dim=axis)
def _gelu(x):
    return torch.nn.functional.gelu(x, approximate="tanh")
def _silu(x):
    return torch.nn.functional.silu(x)
def _sigmoid(x):
    return torch.sigmoid(x)
def _layernorm(x, axis=-1, eps=1e-5):
    m = x.mean(dim=axis, keepdim=True)
    v = x.var(dim=axis, keepdim=True, unbiased=False)
    return (x - m) / torch.sqrt(v + eps)
def _scatter_add(tgt, idx, src, axis=0):
    return tgt.clone().index_add_(axis, idx, src)
def _segment_sum(src, seg, n):
    out = torch.zeros((n,) + src.shape[1:], dtype=src.dtype)
    return out.index_add_(0, seg, src)
def _pad(x, pw):
    flat = tuple(v for pair in reversed(pw) for v in pair)
    return torch.nn.functional.pad(x, flat)

kernel_name = 'concat_heads__spectral_fnet__mha_block__prompt'

def setup_inputs():

    _w = (lambda a: (lambda t: t.to(torch.bfloat16) if t.is_floating_point() else t)(torch.as_tensor(a)))
    def _A_setup():
        B, S, D = 1, 2048, 1024
        ns = torch.arange(S)[:, None] * torch.arange(S)[None, :]
        nd = torch.arange(D)[:, None] * torch.arange(D)[None, :]
        Ws_re = torch.cos(-2.0 * torch.pi * ns / S).to(float)
        Ws_im = torch.sin(-2.0 * torch.pi * ns / S).to(float)
        Wd_re = torch.cos(-2.0 * torch.pi * nd / D).to(float)
        Wd_im = torch.sin(-2.0 * torch.pi * nd / D).to(float)
        return {
            "x": _w((lambda *s: torch.randn(*s, dtype=torch.bfloat16) * 0.05)(B, S, D)),
            "dft_seq_re": _w(Ws_re),
            "dft_seq_im": _w(Ws_im),
            "dft_hid_re": _w(Wd_re),
            "dft_hid_im": _w(Wd_im),
        }
    _A_in = _A_setup()

    def _B_setup():
        B, S, D, H = 1, 2048, 1024, 32
        return {
            "x": _w((lambda *s: torch.randn(*s, dtype=torch.bfloat16) * 0.2)(B, S, D)),
            "wqkv": _w((lambda *s: torch.randn(*s, dtype=torch.bfloat16) * 0.8)(D, 3 * D)),
            "wo": _w((lambda *s: torch.randn(*s, dtype=torch.bfloat16) * 0.2)(D, D)),
        }
    _B_in = _B_setup()

    return {
        "A_x": _A_in["x"],
        "A_dft_seq_re": _A_in["dft_seq_re"],
        "A_dft_seq_im": _A_in["dft_seq_im"],
        "A_dft_hid_re": _A_in["dft_hid_re"],
        "A_dft_hid_im": _A_in["dft_hid_im"],
        "B_x": _B_in["x"],
        "B_wqkv": _B_in["wqkv"],
        "B_wo": _B_in["wo"],
    }

def reference(A_x, A_dft_seq_re, A_dft_seq_im, A_dft_hid_re, A_dft_hid_im, B_x, B_wqkv, B_wo):
    def _A_ref(x, dft_seq_re, dft_seq_im, dft_hid_re, dft_hid_im):
        a = torch.einsum("bsd,ed->bse", x, dft_hid_re)
        b = torch.einsum("bsd,ed->bse", x, dft_hid_im)
        y = torch.einsum("ts,bse->bte", dft_seq_re, a) - torch.einsum("ts,bse->bte", dft_seq_im, b)
        return y

    def _B_ref(x, wqkv, wo):
        B, S, D = x.shape
        H = 32
        Dh = D // H
        qkv = (lambda x, *d: x.permute(*d))((x @ wqkv).reshape(B, S, 3, H, Dh), 2, 0, 3, 1, 4)
        q, k, v = qkv[0], qkv[1], qkv[2]
        scores = torch.einsum("bhqd,bhkd->bhqk", q, k) * (Dh ** -0.5)
        p = _softmax(scores, axis=-1)
        o = torch.einsum("bhqk,bhkd->bhqd", p, v)
        return (lambda x, *d: x.permute(*d))(o, 0, 2, 1, 3).reshape(B, S, D) @ wo

    a = _A_ref(A_x, A_dft_seq_re, A_dft_seq_im, A_dft_hid_re, A_dft_hid_im)
    b = _B_ref(B_x, B_wqkv, B_wo)
    return torch.concatenate([a, b], axis=-1)
```

```asm
; @launch grid=(256,1,1) block=(512,1,1) lds=163840
.amdgcn_target "amdgcn-amd-amdhsa--gfx950"
.text
.globl concat_heads__spectral_fnet__mha_block__prompt_kernel
.p2align 8
.type concat_heads__spectral_fnet__mha_block__prompt_kernel,@function
concat_heads__spectral_fnet__mha_block__prompt_kernel:
    s_cmp_ge_u32 s2, 256
    s_cbranch_scc1 F_END
    s_load_dwordx16 s[4:19], s[0:1], 0
    s_load_dwordx4 s[20:23], s[0:1], 64
    s_load_dwordx2 s[24:25], s[0:1], 80
    v_lshrrev_b32 v1, 6, v0
    v_and_b32 v0, 63, v0
    v_readfirstlane_b32 s26, v1
    s_and_b32 s27, s2, 7
    s_lshr_b32 s28, s2, 3
    s_and_b32 s3, s27, 1
    s_lshr_b32 s52, s28, 2
    s_lshl_b32 s29, s3, 3
    s_add_u32 s29, s29, s52
    s_mov_b32 s31, s29
    s_lshr_b32 s30, s27, 1
    s_lshl_b32 s30, s30, 2
    s_and_b32 s3, s28, 3
    s_add_u32 s30, s30, s3
    s_add_u32 s52, s30, 0
    s_and_b32 s52, s52, 15
    s_add_u32 s53, s30, 0
    s_and_b32 s53, s53, 15
    s_and_b32 s34, s26, 3
    s_movk_i32 s35, 20000
    s_cmp_ge_u32 s26, 4
    s_cbranch_scc1 F_L
    s_lshl_b32 s3, s29, 2
    s_and_b32 s58, s28, 3
    s_add_u32 s3, s3, s58
    s_lshl_b32 s3, s3, 2
    s_add_u32 s3, s3, s26
    s_lshl_b32 s3, s3, 14
    v_and_b32 v17, 7, v0
    v_lshlrev_b32 v17, 11, v17
    v_lshrrev_b32 v18, 3, v0
    v_lshl_add_u32 v17, v18, 7, v17
    v_add_u32 v17, s3, v17
    v_mov_b32 v21, 1073741824
    v_cmp_gt_u32 vcc, 16, v0
    s_nop 1
    v_cndmask_b32 v17, v21, v17, vcc
    s_lshr_b32 s3, s28, 2
    s_lshl_b32 s3, s3, 2
    s_add_u32 s3, s3, s26
    s_lshl_b32 s3, s3, 1
    v_and_b32 v18, 1, v0
    v_add_u32 v22, s3, v18
    v_bfe_u32 v18, v0, 1, 1
    v_lshl_add_u32 v18, v18, 6, v22
    v_mul_u32_u24 v18, 0x1800, v18
    s_lshl_b32 s3, s52, 7
    s_add_u32 s3, s3, 2048
    s_lshl_b32 s58, s53, 7
    s_add_u32 s58, s58, 4096
    v_mov_b32 v20, s3
    v_mov_b32 v23, s58
    s_mov_b32 vcc_lo, 0x0f0f0f0f
    s_mov_b32 vcc_hi, 0
    v_cndmask_b32 v20, v23, v20, vcc
    v_add_u32 v18, v18, v20
    v_cmp_gt_u32 vcc, 8, v0
    s_nop 1
    v_cndmask_b32 v18, v21, v18, vcc
    s_waitcnt lgkmcnt(0)
    s_mov_b32 s40, s14
    s_mov_b32 s41, s15
    s_mov_b32 s42, 4194304
    s_mov_b32 s43, 0x00020000
    s_mov_b32 s44, s16
    s_mov_b32 s45, s17
    s_mov_b32 s46, 6291456
    s_mov_b32 s47, 0x00020000
    v_lshrrev_b32 v19, 1, v0
    v_lshl_add_u32 v19, v19, 6, v22
    v_mul_u32_u24 v19, 0x1800, v19
    s_lshl_b32 s3, s30, 7
    v_add_u32 v19, s3, v19
    v_and_b32 v10, 31, v0
    v_lshrrev_b32 v2, 5, v0
    v_bfe_u32 v11, v0, 1, 3
    v_xor_b32 v2, v2, v11
    v_lshlrev_b32 v2, 4, v2
    v_lshl_add_u32 v2, v10, 7, v2
    s_lshl_b32 s3, s34, 12
    v_add_u32 v2, s3, v2
    v_xor_b32 v3, 32, v2
    v_xor_b32 v4, 64, v2
    v_xor_b32 v5, 96, v2
    v_xor_b32 v6, 0x1000, v2
    v_xor_b32 v7, 0x1000, v3
    v_xor_b32 v8, 0x1000, v4
    v_xor_b32 v9, 0x1000, v5
    s_and_b32 s101, s26, 1
    v_lshrrev_b32 v10, 5, v0
    v_bfe_u32 v11, v0, 2, 2
    v_lshl_add_u32 v10, v10, 3, v11
    v_lshlrev_b32 v10, 7, v10
    v_bfe_u32 v11, v0, 3, 1
    v_xor_b32 v11, s101, v11
    v_lshl_add_u32 v10, v11, 6, v10
    v_bfe_u32 v11, v0, 4, 1
    v_lshl_add_u32 v10, v11, 5, v10
    v_and_b32 v11, 3, v0
    v_lshl_add_u32 v10, v11, 3, v10
    v_add_u32 v10, 0x4000, v10
    v_lshlrev_b32 v1, 4, v0
    v_mov_b32 v16, 0
    s_mov_b32 s36, s24
    s_mov_b32 s37, s25
    s_mov_b32 s38, 22020096
    s_mov_b32 s39, 0x00020000
    s_mov_b32 s48, s22
    s_mov_b32 s49, s23
    s_mov_b32 s50, 256
    s_mov_b32 s51, 0x00020000
    s_or_b32 s3, s2, s26
    s_cmp_lg_u32 s3, 0
    s_cbranch_scc1 C_NN
    s_memrealtime s[58:59]
    s_waitcnt lgkmcnt(0)
    s_or_b32 s58, s58, 1
    v_mov_b32 v12, s58
    v_mov_b32 v13, s59
    buffer_store_dwordx2 v[12:13], v16, s[48:51], 0 offen sc1
C_NN:
    s_setprio 2
    s_barrier
    ds_read_b128 v[32:35], v2
    ds_read_b64_tr_b16 v[40:41], v10 offset:0
    ds_read_b64_tr_b16 v[42:43], v10 offset:512
    ds_read_b128 v[36:39], v6
    ds_read_b64_tr_b16 v[44:45], v10 offset:8192
    ds_read_b64_tr_b16 v[46:47], v10 offset:8704
    s_waitcnt lgkmcnt(3)
    v_mfma_f32_32x32x16_bf16 v[64:79], v[40:43], v[32:35], 0
    ds_read_b128 v[48:51], v3
    ds_read_b64_tr_b16 v[56:57], v10 offset:2048
    ds_read_b64_tr_b16 v[58:59], v10 offset:2560
    s_waitcnt lgkmcnt(5)
    v_mfma_f32_32x32x16_bf16 v[80:95], v[40:43], v[36:39], 0
    ds_read_b128 v[52:55], v7
    ds_read_b64_tr_b16 v[60:61], v10 offset:10240
    ds_read_b64_tr_b16 v[62:63], v10 offset:10752
    s_waitcnt lgkmcnt(6)
    v_mfma_f32_32x32x16_bf16 v[96:111], v[32:35], v[44:47], 0
    v_mfma_f32_32x32x16_bf16 v[112:127], v[36:39], v[44:47], 0
    s_waitcnt lgkmcnt(3)
    v_mfma_f32_32x32x16_bf16 v[64:79], v[56:59], v[48:51], v[64:79]
    ds_read_b128 v[32:35], v4
    ds_read_b64_tr_b16 v[40:41], v10 offset:4096
    ds_read_b64_tr_b16 v[42:43], v10 offset:4608
    s_waitcnt lgkmcnt(5)
    v_mfma_f32_32x32x16_bf16 v[80:95], v[56:59], v[52:55], v[80:95]
    ds_read_b128 v[36:39], v8
    ds_read_b64_tr_b16 v[44:45], v10 offset:12288
    ds_read_b64_tr_b16 v[46:47], v10 offset:12800
    s_waitcnt lgkmcnt(6)
    v_mfma_f32_32x32x16_bf16 v[96:111], v[48:51], v[60:63], v[96:111]
    v_mfma_f32_32x32x16_bf16 v[112:127], v[52:55], v[60:63], v[112:127]
    s_barrier
    s_waitcnt lgkmcnt(3)
    v_mfma_f32_32x32x16_bf16 v[64:79], v[40:43], v[32:35], v[64:79]
    ds_read_b128 v[48:51], v5
    ds_read_b64_tr_b16 v[56:57], v10 offset:6144
    ds_read_b64_tr_b16 v[58:59], v10 offset:6656
    s_waitcnt lgkmcnt(5)
    v_mfma_f32_32x32x16_bf16 v[80:95], v[40:43], v[36:39], v[80:95]
    ds_read_b128 v[52:55], v9
    ds_read_b64_tr_b16 v[60:61], v10 offset:14336
    ds_read_b64_tr_b16 v[62:63], v10 offset:14848
    s_waitcnt lgkmcnt(6)
    v_mfma_f32_32x32x16_bf16 v[96:111], v[32:35], v[44:47], v[96:111]
    v_mfma_f32_32x32x16_bf16 v[112:127], v[36:39], v[44:47], v[112:127]
    s_waitcnt lgkmcnt(3)
    v_mfma_f32_32x32x16_bf16 v[64:79], v[56:59], v[48:51], v[64:79]
    v_add_u32 v2, 0x8000, v2
    v_add_u32 v10, 0x8000, v10
    v_add_u32 v6, 0x8000, v6
    ds_read_b128 v[32:35], v2
    ds_read_b64_tr_b16 v[40:41], v10 offset:0
    ds_read_b64_tr_b16 v[42:43], v10 offset:512
    s_waitcnt lgkmcnt(5)
    v_mfma_f32_32x32x16_bf16 v[80:95], v[56:59], v[52:55], v[80:95]
    ds_read_b128 v[36:39], v6
    ds_read_b64_tr_b16 v[44:45], v10 offset:8192
    ds_read_b64_tr_b16 v[46:47], v10 offset:8704
    s_waitcnt lgkmcnt(6)
    v_mfma_f32_32x32x16_bf16 v[96:111], v[48:51], v[60:63], v[96:111]
    v_add_u32 v3, 0x8000, v3
    v_add_u32 v7, 0x8000, v7
    v_add_u32 v4, 0x8000, v4
    v_add_u32 v8, 0x8000, v8
    v_add_u32 v5, 0x8000, v5
    v_add_u32 v9, 0x8000, v9
    v_mfma_f32_32x32x16_bf16 v[112:127], v[52:55], v[60:63], v[112:127]
    s_waitcnt lgkmcnt(3)
    v_mfma_f32_32x32x16_bf16 v[64:79], v[40:43], v[32:35], v[64:79]
    ds_read_b128 v[48:51], v3
    ds_read_b64_tr_b16 v[56:57], v10 offset:2048
    ds_read_b64_tr_b16 v[58:59], v10 offset:2560
    s_waitcnt lgkmcnt(5)
    v_mfma_f32_32x32x16_bf16 v[80:95], v[40:43], v[36:39], v[80:95]
    ds_read_b128 v[52:55], v7
    ds_read_b64_tr_b16 v[60:61], v10 offset:10240
    ds_read_b64_tr_b16 v[62:63], v10 offset:10752
    s_waitcnt lgkmcnt(6)
    v_mfma_f32_32x32x16_bf16 v[96:111], v[32:35], v[44:47], v[96:111]
    v_mfma_f32_32x32x16_bf16 v[112:127], v[36:39], v[44:47], v[112:127]
    s_waitcnt lgkmcnt(3)
    v_mfma_f32_32x32x16_bf16 v[64:79], v[56:59], v[48:51], v[64:79]
    ds_read_b128 v[32:35], v4
    ds_read_b64_tr_b16 v[40:41], v10 offset:4096
    ds_read_b64_tr_b16 v[42:43], v10 offset:4608
    s_waitcnt lgkmcnt(5)
    v_mfma_f32_32x32x16_bf16 v[80:95], v[56:59], v[52:55], v[80:95]
    ds_read_b128 v[36:39], v8
    ds_read_b64_tr_b16 v[44:45], v10 offset:12288
    ds_read_b64_tr_b16 v[46:47], v10 offset:12800
    s_waitcnt lgkmcnt(6)
    v_mfma_f32_32x32x16_bf16 v[96:111], v[48:51], v[60:63], v[96:111]
    v_mfma_f32_32x32x16_bf16 v[112:127], v[52:55], v[60:63], v[112:127]
    s_barrier
    s_waitcnt lgkmcnt(3)
    v_mfma_f32_32x32x16_bf16 v[64:79], v[40:43], v[32:35], v[64:79]
    ds_read_b128 v[48:51], v5
    ds_read_b64_tr_b16 v[56:57], v10 offset:6144
    ds_read_b64_tr_b16 v[58:59], v10 offset:6656
    s_lshr_b32 s54, s26, 2
    s_waitcnt lgkmcnt(5)
    v_mfma_f32_32x32x16_bf16 v[80:95], v[40:43], v[36:39], v[80:95]
    ds_read_b128 v[52:55], v9
    ds_read_b64_tr_b16 v[60:61], v10 offset:14336
    ds_read_b64_tr_b16 v[62:63], v10 offset:14848
    s_lshr_b32 s55, s28, 1
    s_waitcnt lgkmcnt(6)
    v_mfma_f32_32x32x16_bf16 v[96:111], v[32:35], v[44:47], v[96:111]
    s_lshl_b32 s56, s27, 1
    v_mfma_f32_32x32x16_bf16 v[112:127], v[36:39], v[44:47], v[112:127]
    s_and_b32 s96, s28, 1
    s_waitcnt lgkmcnt(3)
    v_mfma_f32_32x32x16_bf16 v[64:79], v[56:59], v[48:51], v[64:79]
    v_add_u32 v2, 0x8000, v2
    v_add_u32 v10, 0x8000, v10
    v_add_u32 v6, 0x8000, v6
    ds_read_b128 v[32:35], v2
    ds_read_b64_tr_b16 v[40:41], v10 offset:0
    ds_read_b64_tr_b16 v[42:43], v10 offset:512
    s_add_u32 s56, s56, s96
    s_waitcnt lgkmcnt(5)
    v_mfma_f32_32x32x16_bf16 v[80:95], v[56:59], v[52:55], v[80:95]
    ds_read_b128 v[36:39], v6
    ds_read_b64_tr_b16 v[44:45], v10 offset:8192
    ds_read_b64_tr_b16 v[46:47], v10 offset:8704
    s_lshl_b32 s56, s56, 2
    s_waitcnt lgkmcnt(6)
    v_mfma_f32_32x32x16_bf16 v[96:111], v[48:51], v[60:63], v[96:111]
    v_add_u32 v3, 0x8000, v3
    v_add_u32 v7, 0x8000, v7
    v_add_u32 v4, 0x8000, v4
    v_add_u32 v8, 0x8000, v8
    v_add_u32 v5, 0x8000, v5
    v_add_u32 v9, 0x8000, v9
    s_add_u32 s56, s56, s34
    v_mfma_f32_32x32x16_bf16 v[112:127], v[52:55], v[60:63], v[112:127]
    s_lshl_b32 s96, s29, 2
    s_waitcnt lgkmcnt(3)
    v_mfma_f32_32x32x16_bf16 v[64:79], v[40:43], v[32:35], v[64:79]
    ds_read_b128 v[48:51], v3
    ds_read_b64_tr_b16 v[56:57], v10 offset:2048
    ds_read_b64_tr_b16 v[58:59], v10 offset:2560
    s_add_u32 s96, s96, s34
    s_waitcnt lgkmcnt(5)
    v_mfma_f32_32x32x16_bf16 v[80:95], v[40:43], v[36:39], v[80:95]
    ds_read_b128 v[52:55], v7
    ds_read_b64_tr_b16 v[60:61], v10 offset:10240
    ds_read_b64_tr_b16 v[62:63], v10 offset:10752
    s_lshl_b32 s96, s96, 4
    s_waitcnt lgkmcnt(6)
    v_mfma_f32_32x32x16_bf16 v[96:111], v[32:35], v[44:47], v[96:111]
    s_add_u32 s96, s96, s30
    v_mfma_f32_32x32x16_bf16 v[112:127], v[36:39], v[44:47], v[112:127]
    s_lshl_b32 s96, s96, 1
    s_waitcnt lgkmcnt(3)
    v_mfma_f32_32x32x16_bf16 v[64:79], v[56:59], v[48:51], v[64:79]
    ds_read_b128 v[32:35], v4
    ds_read_b64_tr_b16 v[40:41], v10 offset:4096
    ds_read_b64_tr_b16 v[42:43], v10 offset:4608
    s_add_u32 s96, s96, s54
    s_waitcnt lgkmcnt(5)
    v_mfma_f32_32x32x16_bf16 v[80:95], v[56:59], v[52:55], v[80:95]
    ds_read_b128 v[36:39], v8
    ds_read_b64_tr_b16 v[44:45], v10 offset:12288
    ds_read_b64_tr_b16 v[46:47], v10 offset:12800
    s_lshl_b32 s77, s96, 11
    s_waitcnt lgkmcnt(6)
    v_mfma_f32_32x32x16_bf16 v[96:111], v[48:51], v[60:63], v[96:111]
    s_add_u32 s77, s77, 8388608
    v_mfma_f32_32x32x16_bf16 v[112:127], v[52:55], v[60:63], v[112:127]
    s_barrier
    s_lshl_b32 s78, s96, 3
    s_waitcnt lgkmcnt(3)
    v_mfma_f32_32x32x16_bf16 v[64:79], v[40:43], v[32:35], v[64:79]
    ds_read_b128 v[48:51], v5
    ds_read_b64_tr_b16 v[56:57], v10 offset:6144
    ds_read_b64_tr_b16 v[58:59], v10 offset:6656
    s_add_u32 s78, s78, 16883712
    s_waitcnt lgkmcnt(5)
    v_mfma_f32_32x32x16_bf16 v[80:95], v[40:43], v[36:39], v[80:95]
    ds_read_b128 v[52:55], v9
    ds_read_b64_tr_b16 v[60:61], v10 offset:14336
    ds_read_b64_tr_b16 v[62:63], v10 offset:14848
    s_lshr_b32 s92, s55, 1
    s_waitcnt lgkmcnt(6)
    v_mfma_f32_32x32x16_bf16 v[96:111], v[32:35], v[44:47], v[96:111]
    s_lshl_b32 s92, s92, 17
    v_mfma_f32_32x32x16_bf16 v[112:127], v[36:39], v[44:47], v[112:127]
    s_and_b32 s96, s55, 1
    s_waitcnt lgkmcnt(3)
    v_mfma_f32_32x32x16_bf16 v[64:79], v[56:59], v[48:51], v[64:79]
    v_add_u32 v2, 0x8000, v2
    v_add_u32 v10, 0x8000, v10
    v_add_u32 v6, 0x8000, v6
    ds_read_b128 v[32:35], v2
    ds_read_b64_tr_b16 v[40:41], v10 offset:0
    ds_read_b64_tr_b16 v[42:43], v10 offset:512
    s_lshl_b32 s96, s96, 11
    s_waitcnt lgkmcnt(5)
    v_mfma_f32_32x32x16_bf16 v[80:95], v[56:59], v[52:55], v[80:95]
    ds_read_b128 v[36:39], v6
    ds_read_b64_tr_b16 v[44:45], v10 offset:8192
    ds_read_b64_tr_b16 v[46:47], v10 offset:8704
    s_add_u32 s92, s92, s96
    s_waitcnt lgkmcnt(6)
    v_mfma_f32_32x32x16_bf16 v[96:111], v[48:51], v[60:63], v[96:111]
    v_add_u32 v3, 0x8000, v3
    v_add_u32 v7, 0x8000, v7
    v_add_u32 v4, 0x8000, v4
    v_add_u32 v8, 0x8000, v8
    v_add_u32 v5, 0x8000, v5
    v_add_u32 v9, 0x8000, v9
    s_and_b32 s96, s34, 1
    v_mfma_f32_32x32x16_bf16 v[112:127], v[52:55], v[60:63], v[112:127]
    s_lshl_b32 s96, s96, 8
    s_waitcnt lgkmcnt(3)
    v_mfma_f32_32x32x16_bf16 v[64:79], v[40:43], v[32:35], v[64:79]
    ds_read_b128 v[48:51], v3
    ds_read_b64_tr_b16 v[56:57], v10 offset:2048
    ds_read_b64_tr_b16 v[58:59], v10 offset:2560
    s_add_u32 s92, s92, s96
    s_waitcnt lgkmcnt(5)
    v_mfma_f32_32x32x16_bf16 v[80:95], v[40:43], v[36:39], v[80:95]
    ds_read_b128 v[52:55], v7
    ds_read_b64_tr_b16 v[60:61], v10 offset:10240
    ds_read_b64_tr_b16 v[62:63], v10 offset:10752
    s_lshl_b32 s96, s54, 16
    s_waitcnt lgkmcnt(6)
    v_mfma_f32_32x32x16_bf16 v[96:111], v[32:35], v[44:47], v[96:111]
    s_add_u32 s92, s92, s96
    v_mfma_f32_32x32x16_bf16 v[112:127], v[36:39], v[44:47], v[112:127]
    s_and_b32 s79, s56, 31
    s_waitcnt lgkmcnt(3)
    v_mfma_f32_32x32x16_bf16 v[64:79], v[56:59], v[48:51], v[64:79]
    ds_read_b128 v[32:35], v4
    ds_read_b64_tr_b16 v[40:41], v10 offset:4096
    ds_read_b64_tr_b16 v[42:43], v10 offset:4608
    s_lshl_b32 s79, s79, 8
    s_waitcnt lgkmcnt(5)
    v_mfma_f32_32x32x16_bf16 v[80:95], v[56:59], v[52:55], v[80:95]
    ds_read_b128 v[36:39], v8
    ds_read_b64_tr_b16 v[44:45], v10 offset:12288
    ds_read_b64_tr_b16 v[46:47], v10 offset:12800
    s_add_u32 s79, s79, 16842752
    s_waitcnt lgkmcnt(6)
    v_mfma_f32_32x32x16_bf16 v[96:111], v[48:51], v[60:63], v[96:111]
    s_lshl_b32 s80, s56, 6
    v_mfma_f32_32x32x16_bf16 v[112:127], v[52:55], v[60:63], v[112:127]
    s_barrier
    s_lshl_b32 s96, s54, 12
    s_waitcnt lgkmcnt(3)
    v_mfma_f32_32x32x16_bf16 v[64:79], v[40:43], v[32:35], v[64:79]
    ds_read_b128 v[48:51], v5
    ds_read_b64_tr_b16 v[56:57], v10 offset:6144
    ds_read_b64_tr_b16 v[58:59], v10 offset:6656
    s_add_u32 s80, s80, s96
    s_waitcnt lgkmcnt(5)
    v_mfma_f32_32x32x16_bf16 v[80:95], v[40:43], v[36:39], v[80:95]
    ds_read_b128 v[52:55], v9
    ds_read_b64_tr_b16 v[60:61], v10 offset:14336
    ds_read_b64_tr_b16 v[62:63], v10 offset:14848
    s_add_u32 s80, s80, 16777216
    s_waitcnt lgkmcnt(6)
    v_mfma_f32_32x32x16_bf16 v[96:111], v[32:35], v[44:47], v[96:111]
    s_xor_b32 s96, s54, s55
    v_mfma_f32_32x32x16_bf16 v[112:127], v[36:39], v[44:47], v[112:127]
    s_bitcmp0_b32 s96, 0
    s_cselect_b32 s80, s80, 1073741824
    s_waitcnt lgkmcnt(3)
    v_mfma_f32_32x32x16_bf16 v[64:79], v[56:59], v[48:51], v[64:79]
    v_add_u32 v2, 0x8000, v2
    v_add_u32 v10, 0x8000, v10
    v_add_u32 v6, 0x8000, v6
    ds_read_b128 v[32:35], v2
    ds_read_b64_tr_b16 v[40:41], v10 offset:0
    ds_read_b64_tr_b16 v[42:43], v10 offset:512
    s_lshl_b32 s81, s56, 13
    s_waitcnt lgkmcnt(5)
    v_mfma_f32_32x32x16_bf16 v[80:95], v[56:59], v[52:55], v[80:95]
    ds_read_b128 v[36:39], v6
    ds_read_b64_tr_b16 v[44:45], v10 offset:8192
    ds_read_b64_tr_b16 v[46:47], v10 offset:8704
    s_lshl_b32 s96, s54, 20
    s_waitcnt lgkmcnt(6)
    v_mfma_f32_32x32x16_bf16 v[96:111], v[48:51], v[60:63], v[96:111]
    v_add_u32 v3, 0x8000, v3
    v_add_u32 v7, 0x8000, v7
    v_add_u32 v4, 0x8000, v4
    v_add_u32 v8, 0x8000, v8
    v_add_u32 v5, 0x8000, v5
    v_add_u32 v9, 0x8000, v9
    s_add_u32 s81, s81, s96
    v_mfma_f32_32x32x16_bf16 v[112:127], v[52:55], v[60:63], v[112:127]
    s_and_b32 s96, s55, 1
    s_waitcnt lgkmcnt(3)
    v_mfma_f32_32x32x16_bf16 v[64:79], v[40:43], v[32:35], v[64:79]
    ds_read_b128 v[48:51], v3
    ds_read_b64_tr_b16 v[56:57], v10 offset:2048
    ds_read_b64_tr_b16 v[58:59], v10 offset:2560
    s_lshl_b32 s96, s96, 19
    s_waitcnt lgkmcnt(5)
    v_mfma_f32_32x32x16_bf16 v[80:95], v[40:43], v[36:39], v[80:95]
    ds_read_b128 v[52:55], v7
    ds_read_b64_tr_b16 v[60:61], v10 offset:10240
    ds_read_b64_tr_b16 v[62:63], v10 offset:10752
    s_add_u32 s81, s81, s96
    s_waitcnt lgkmcnt(6)
    v_mfma_f32_32x32x16_bf16 v[96:111], v[32:35], v[44:47], v[96:111]
    s_add_u32 s81, s81, 12582912
    v_mfma_f32_32x32x16_bf16 v[112:127], v[36:39], v[44:47], v[112:127]
    s_lshl_b32 s96, s54, 4
    s_waitcnt lgkmcnt(3)
    v_mfma_f32_32x32x16_bf16 v[64:79], v[56:59], v[48:51], v[64:79]
    ds_read_b128 v[32:35], v4
    ds_read_b64_tr_b16 v[40:41], v10 offset:4096
    ds_read_b64_tr_b16 v[42:43], v10 offset:4608
    s_add_u32 s96, s96, s55
    s_waitcnt lgkmcnt(5)
    v_mfma_f32_32x32x16_bf16 v[80:95], v[56:59], v[52:55], v[80:95]
    ds_read_b128 v[36:39], v8
    ds_read_b64_tr_b16 v[44:45], v10 offset:12288
    ds_read_b64_tr_b16 v[46:47], v10 offset:12800
    s_lshl_b32 s96, s96, 6
    s_waitcnt lgkmcnt(6)
    v_mfma_f32_32x32x16_bf16 v[96:111], v[48:51], v[60:63], v[96:111]
    s_add_u32 s96, s96, s56
    v_mfma_f32_32x32x16_bf16 v[112:127], v[52:55], v[60:63], v[112:127]
    s_barrier
    s_lshl_b32 s82, s96, 10
    s_waitcnt lgkmcnt(3)
    v_mfma_f32_32x32x16_bf16 v[64:79], v[40:43], v[32:35], v[64:79]
    ds_read_b128 v[48:51], v5
    ds_read_b64_tr_b16 v[56:57], v10 offset:6144
    ds_read_b64_tr_b16 v[58:59], v10 offset:6656
    s_add_u32 s82, s82, 14680064
    s_waitcnt lgkmcnt(5)
    v_mfma_f32_32x32x16_bf16 v[80:95], v[40:43], v[36:39], v[80:95]
    ds_read_b128 v[52:55], v9
    ds_read_b64_tr_b16 v[60:61], v10 offset:14336
    ds_read_b64_tr_b16 v[62:63], v10 offset:14848
    s_lshl_b32 s83, s96, 3
    s_waitcnt lgkmcnt(6)
    v_mfma_f32_32x32x16_bf16 v[96:111], v[32:35], v[44:47], v[96:111]
    s_add_u32 s83, s83, 16867328
    v_mfma_f32_32x32x16_bf16 v[112:127], v[36:39], v[44:47], v[112:127]
    s_lshl_b32 s84, s56, 5
    s_waitcnt lgkmcnt(3)
    v_mfma_f32_32x32x16_bf16 v[64:79], v[56:59], v[48:51], v[64:79]
    v_add_u32 v2, 0xfffe0000, v2
    v_add_u32 v10, 0xfffe0000, v10
    v_add_u32 v6, 0xfffe0000, v6
    ds_read_b128 v[32:35], v2
    ds_read_b64_tr_b16 v[40:41], v10 offset:0
    ds_read_b64_tr_b16 v[42:43], v10 offset:512
    s_add_u32 s84, s84, 16793600
    s_waitcnt lgkmcnt(5)
    v_mfma_f32_32x32x16_bf16 v[80:95], v[56:59], v[52:55], v[80:95]
    ds_read_b128 v[36:39], v6
    ds_read_b64_tr_b16 v[44:45], v10 offset:8192
    ds_read_b64_tr_b16 v[46:47], v10 offset:8704
    s_or_b32 s96, s55, s54
    s_waitcnt lgkmcnt(6)
    v_mfma_f32_32x32x16_bf16 v[96:111], v[48:51], v[60:63], v[96:111]
    v_add_u32 v3, 0xfffe0000, v3
    v_add_u32 v7, 0xfffe0000, v7
    v_add_u32 v4, 0xfffe0000, v4
    v_add_u32 v8, 0xfffe0000, v8
    v_add_u32 v5, 0xfffe0000, v5
    v_add_u32 v9, 0xfffe0000, v9
    s_cmp_eq_u32 s96, 0
    s_cselect_b32 s84, s84, 1073741824
    v_mfma_f32_32x32x16_bf16 v[112:127], v[52:55], v[60:63], v[112:127]
    s_andn2_b32 s57, s27, 1
    s_waitcnt lgkmcnt(3)
    v_mfma_f32_32x32x16_bf16 v[64:79], v[40:43], v[32:35], v[64:79]
    ds_read_b128 v[48:51], v3
    ds_read_b64_tr_b16 v[56:57], v10 offset:2048
    ds_read_b64_tr_b16 v[58:59], v10 offset:2560
    s_lshl_b32 s57, s57, 1
    s_waitcnt lgkmcnt(5)
    v_mfma_f32_32x32x16_bf16 v[80:95], v[40:43], v[36:39], v[80:95]
    ds_read_b128 v[52:55], v7
    ds_read_b64_tr_b16 v[60:61], v10 offset:10240
    ds_read_b64_tr_b16 v[62:63], v10 offset:10752
    s_and_b32 s96, s28, 3
    s_waitcnt lgkmcnt(6)
    v_mfma_f32_32x32x16_bf16 v[96:111], v[32:35], v[44:47], v[96:111]
    s_add_u32 s57, s57, s96
    v_mfma_f32_32x32x16_bf16 v[112:127], v[36:39], v[44:47], v[112:127]
    s_lshl_b32 s57, s57, 1
    s_waitcnt lgkmcnt(3)
    v_mfma_f32_32x32x16_bf16 v[64:79], v[56:59], v[48:51], v[64:79]
    ds_read_b128 v[32:35], v4
    ds_read_b64_tr_b16 v[40:41], v10 offset:4096
    ds_read_b64_tr_b16 v[42:43], v10 offset:4608
    s_and_b32 s96, s27, 1
    s_waitcnt lgkmcnt(5)
    v_mfma_f32_32x32x16_bf16 v[80:95], v[56:59], v[52:55], v[80:95]
    ds_read_b128 v[36:39], v8
    ds_read_b64_tr_b16 v[44:45], v10 offset:12288
    ds_read_b64_tr_b16 v[46:47], v10 offset:12800
    s_add_u32 s57, s57, s96
    s_waitcnt lgkmcnt(6)
    v_mfma_f32_32x32x16_bf16 v[96:111], v[48:51], v[60:63], v[96:111]
    s_bfe_u32 s55, s26, 0x10001
    v_mfma_f32_32x32x16_bf16 v[112:127], v[52:55], v[60:63], v[112:127]
    s_barrier
    s_and_b32 s56, s26, 1
    s_waitcnt lgkmcnt(3)
    v_mfma_f32_32x32x16_bf16 v[64:79], v[40:43], v[32:35], v[64:79]
    ds_read_b128 v[48:51], v5
    ds_read_b64_tr_b16 v[56:57], v10 offset:6144
    ds_read_b64_tr_b16 v[58:59], v10 offset:6656
    s_lshr_b32 s93, s57, 1
    s_waitcnt lgkmcnt(5)
    v_mfma_f32_32x32x16_bf16 v[80:95], v[40:43], v[36:39], v[80:95]
    ds_read_b128 v[52:55], v9
    ds_read_b64_tr_b16 v[60:61], v10 offset:14336
    ds_read_b64_tr_b16 v[62:63], v10 offset:14848
    s_lshl_b32 s93, s93, 18
    s_waitcnt lgkmcnt(6)
    v_mfma_f32_32x32x16_bf16 v[96:111], v[32:35], v[44:47], v[96:111]
    s_and_b32 s96, s57, 1
    v_mfma_f32_32x32x16_bf16 v[112:127], v[36:39], v[44:47], v[112:127]
    s_lshl_b32 s96, s96, 12
    s_waitcnt lgkmcnt(3)
    v_mfma_f32_32x32x16_bf16 v[64:79], v[56:59], v[48:51], v[64:79]
    v_add_u32 v2, 0x8000, v2
    v_add_u32 v10, 0x8000, v10
    v_add_u32 v6, 0x8000, v6
    ds_read_b128 v[32:35], v2
    ds_read_b64_tr_b16 v[40:41], v10 offset:0
    ds_read_b64_tr_b16 v[42:43], v10 offset:512
    s_add_u32 s93, s93, s96
    s_waitcnt lgkmcnt(5)
    v_mfma_f32_32x32x16_bf16 v[80:95], v[56:59], v[52:55], v[80:95]
    ds_read_b128 v[36:39], v6
    ds_read_b64_tr_b16 v[44:45], v10 offset:8192
    ds_read_b64_tr_b16 v[46:47], v10 offset:8704
    s_lshl_b32 s96, s55, 17
    s_waitcnt lgkmcnt(6)
    v_mfma_f32_32x32x16_bf16 v[96:111], v[48:51], v[60:63], v[96:111]
    v_add_u32 v3, 0x8000, v3
    v_add_u32 v7, 0x8000, v7
    v_add_u32 v4, 0x8000, v4
    v_add_u32 v8, 0x8000, v8
    v_add_u32 v5, 0x8000, v5
    v_add_u32 v9, 0x8000, v9
    s_add_u32 s93, s93, s96
    v_mfma_f32_32x32x16_bf16 v[112:127], v[52:55], v[60:63], v[112:127]
    s_lshl_b32 s96, s56, 9
    s_waitcnt lgkmcnt(3)
    v_mfma_f32_32x32x16_bf16 v[64:79], v[40:43], v[32:35], v[64:79]
    ds_read_b128 v[48:51], v3
    ds_read_b64_tr_b16 v[56:57], v10 offset:2048
    ds_read_b64_tr_b16 v[58:59], v10 offset:2560
    s_add_u32 s93, s93, s96
    s_waitcnt lgkmcnt(5)
    v_mfma_f32_32x32x16_bf16 v[80:95], v[40:43], v[36:39], v[80:95]
    ds_read_b128 v[52:55], v7
    ds_read_b64_tr_b16 v[60:61], v10 offset:10240
    ds_read_b64_tr_b16 v[62:63], v10 offset:10752
    s_lshr_b32 s97, s28, 2
    s_waitcnt lgkmcnt(6)
    v_mfma_f32_32x32x16_bf16 v[96:111], v[32:35], v[44:47], v[96:111]
    s_lshl_b32 s97, s97, 1
    v_mfma_f32_32x32x16_bf16 v[112:127], v[36:39], v[44:47], v[112:127]
    s_add_u32 s97, s97, s55
    s_waitcnt lgkmcnt(3)
    v_mfma_f32_32x32x16_bf16 v[64:79], v[56:59], v[48:51], v[64:79]
    ds_read_b128 v[32:35], v4
    ds_read_b64_tr_b16 v[40:41], v10 offset:4096
    ds_read_b64_tr_b16 v[42:43], v10 offset:4608
    s_lshl_b32 s96, s54, 4
    s_waitcnt lgkmcnt(5)
    v_mfma_f32_32x32x16_bf16 v[80:95], v[56:59], v[52:55], v[80:95]
    ds_read_b128 v[36:39], v8
    ds_read_b64_tr_b16 v[44:45], v10 offset:12288
    ds_read_b64_tr_b16 v[46:47], v10 offset:12800
    s_add_u32 s96, s96, s97
    s_waitcnt lgkmcnt(6)
    v_mfma_f32_32x32x16_bf16 v[96:111], v[48:51], v[60:63], v[96:111]
    s_lshl_b32 s96, s96, 1
    v_mfma_f32_32x32x16_bf16 v[112:127], v[52:55], v[60:63], v[112:127]
    s_barrier
    s_and_b32 s97, s57, 1
    s_waitcnt lgkmcnt(3)
    v_mfma_f32_32x32x16_bf16 v[64:79], v[40:43], v[32:35], v[64:79]
    ds_read_b128 v[48:51], v5
    ds_read_b64_tr_b16 v[56:57], v10 offset:6144
    ds_read_b64_tr_b16 v[58:59], v10 offset:6656
    s_add_u32 s96, s96, s97
    s_waitcnt lgkmcnt(5)
    v_mfma_f32_32x32x16_bf16 v[80:95], v[40:43], v[36:39], v[80:95]
    ds_read_b128 v[52:55], v9
    ds_read_b64_tr_b16 v[60:61], v10 offset:14336
    ds_read_b64_tr_b16 v[62:63], v10 offset:14848
    s_lshl_b32 s96, s96, 1
    s_waitcnt lgkmcnt(6)
    v_mfma_f32_32x32x16_bf16 v[96:111], v[32:35], v[44:47], v[96:111]
    s_add_u32 s96, s96, s56
    v_mfma_f32_32x32x16_bf16 v[112:127], v[36:39], v[44:47], v[112:127]
    s_lshl_b32 s85, s96, 14
    s_waitcnt lgkmcnt(3)
    v_mfma_f32_32x32x16_bf16 v[64:79], v[56:59], v[48:51], v[64:79]
    v_add_u32 v2, 0x8000, v2
    v_add_u32 v10, 0x8000, v10
    v_add_u32 v6, 0x8000, v6
    ds_read_b128 v[32:35], v2
    ds_read_b64_tr_b16 v[40:41], v10 offset:0
    ds_read_b64_tr_b16 v[42:43], v10 offset:512
    s_add_u32 s85, s85, 14680064
    s_waitcnt lgkmcnt(5)
    v_mfma_f32_32x32x16_bf16 v[80:95], v[56:59], v[52:55], v[80:95]
    ds_read_b128 v[36:39], v6
    ds_read_b64_tr_b16 v[44:45], v10 offset:8192
    ds_read_b64_tr_b16 v[46:47], v10 offset:8704
    s_lshl_b32 s86, s96, 7
    s_waitcnt lgkmcnt(6)
    v_mfma_f32_32x32x16_bf16 v[96:111], v[48:51], v[60:63], v[96:111]
    v_add_u32 v3, 0x8000, v3
    v_add_u32 v7, 0x8000, v7
    v_add_u32 v4, 0x8000, v4
    v_add_u32 v8, 0x8000, v8
    v_add_u32 v5, 0x8000, v5
    v_add_u32 v9, 0x8000, v9
    s_add_u32 s86, s86, 16867328
    v_mfma_f32_32x32x16_bf16 v[112:127], v[52:55], v[60:63], v[112:127]
    s_lshr_b32 s94, s28, 2
    s_waitcnt lgkmcnt(3)
    v_mfma_f32_32x32x16_bf16 v[64:79], v[40:43], v[32:35], v[64:79]
    ds_read_b128 v[48:51], v3
    ds_read_b64_tr_b16 v[56:57], v10 offset:2048
    ds_read_b64_tr_b16 v[58:59], v10 offset:2560
    s_lshl_b32 s94, s94, 6
    s_waitcnt lgkmcnt(5)
    v_mfma_f32_32x32x16_bf16 v[80:95], v[40:43], v[36:39], v[80:95]
    ds_read_b128 v[52:55], v7
    ds_read_b64_tr_b16 v[60:61], v10 offset:10240
    ds_read_b64_tr_b16 v[62:63], v10 offset:10752
    s_lshl_b32 s97, s97, 9
    s_waitcnt lgkmcnt(6)
    v_mfma_f32_32x32x16_bf16 v[96:111], v[32:35], v[44:47], v[96:111]
    s_add_u32 s94, s94, s97
    v_mfma_f32_32x32x16_bf16 v[112:127], v[36:39], v[44:47], v[112:127]
    s_lshl_b32 s94, s94, 2
    s_waitcnt lgkmcnt(3)
    v_mfma_f32_32x32x16_bf16 v[64:79], v[56:59], v[48:51], v[64:79]
    ds_read_b128 v[32:35], v4
    ds_read_b64_tr_b16 v[40:41], v10 offset:4096
    ds_read_b64_tr_b16 v[42:43], v10 offset:4608
    s_lshl_b32 s95, s30, 1
    s_waitcnt lgkmcnt(5)
    v_mfma_f32_32x32x16_bf16 v[80:95], v[56:59], v[52:55], v[80:95]
    ds_read_b128 v[36:39], v8
    ds_read_b64_tr_b16 v[44:45], v10 offset:12288
    ds_read_b64_tr_b16 v[46:47], v10 offset:12800
    s_add_u32 s95, s95, s54
    s_waitcnt lgkmcnt(6)
    v_mfma_f32_32x32x16_bf16 v[96:111], v[48:51], v[60:63], v[96:111]
    s_lshl_b32 s95, s95, 8
    v_mfma_f32_32x32x16_bf16 v[112:127], v[52:55], v[60:63], v[112:127]
    s_barrier
    s_add_u32 s95, s95, 16850944
    s_waitcnt lgkmcnt(3)
    v_mfma_f32_32x32x16_bf16 v[64:79], v[40:43], v[32:35], v[64:79]
    ds_read_b128 v[48:51], v5
    ds_read_b64_tr_b16 v[56:57], v10 offset:6144
    ds_read_b64_tr_b16 v[58:59], v10 offset:6656
    s_lshl_b32 s65, s54, 18
    s_waitcnt lgkmcnt(5)
    v_mfma_f32_32x32x16_bf16 v[80:95], v[40:43], v[36:39], v[80:95]
    ds_read_b128 v[52:55], v9
    ds_read_b64_tr_b16 v[60:61], v10 offset:14336
    ds_read_b64_tr_b16 v[62:63], v10 offset:14848
    s_lshl_b32 s61, s27, 5
    s_waitcnt lgkmcnt(6)
    v_mfma_f32_32x32x16_bf16 v[96:111], v[32:35], v[44:47], v[96:111]
    s_add_u32 s61, s61, s28
    v_mfma_f32_32x32x16_bf16 v[112:127], v[36:39], v[44:47], v[112:127]
    s_lshl_b32 s61, s61, 2
    s_waitcnt lgkmcnt(3)
    v_mfma_f32_32x32x16_bf16 v[64:79], v[56:59], v[48:51], v[64:79]
    v_add_u32 v2, 0x8000, v2
    v_add_u32 v10, 0x8000, v10
    v_add_u32 v6, 0x8000, v6
    ds_read_b128 v[128:131], v2
    ds_read_b64_tr_b16 v[40:41], v10 offset:0
    ds_read_b64_tr_b16 v[42:43], v10 offset:512
    s_add_u32 s61, s61, s34
    s_waitcnt lgkmcnt(5)
    v_mfma_f32_32x32x16_bf16 v[80:95], v[56:59], v[52:55], v[80:95]
    ds_read_b128 v[36:39], v6
    ds_read_b64_tr_b16 v[44:45], v10 offset:8192
    ds_read_b64_tr_b16 v[46:47], v10 offset:8704
    s_lshl_b32 s76, s61, 3
    s_waitcnt lgkmcnt(6)
    v_mfma_f32_32x32x16_bf16 v[96:111], v[48:51], v[60:63], v[96:111]
    v_add_u32 v3, 0x8000, v3
    v_add_u32 v7, 0x8000, v7
    v_add_u32 v4, 0x8000, v4
    v_add_u32 v8, 0x8000, v8
    v_add_u32 v5, 0x8000, v5
    v_add_u32 v9, 0x8000, v9
    s_add_u32 s76, s76, 16842752
    v_mfma_f32_32x32x16_bf16 v[112:127], v[52:55], v[60:63], v[112:127]
    s_cmp_lt_u32 s26, 4
    s_cselect_b32 s76, 1073741824, s76
    s_waitcnt lgkmcnt(3)
    v_mfma_f32_32x32x16_bf16 v[64:79], v[40:43], v[128:131], v[64:79]
    ds_read_b128 v[132:135], v3
    ds_read_b64_tr_b16 v[56:57], v10 offset:2048
    ds_read_b64_tr_b16 v[58:59], v10 offset:2560
    s_lshr_b32 s99, s27, 1
    s_waitcnt lgkmcnt(5)
    v_mfma_f32_32x32x16_bf16 v[80:95], v[40:43], v[36:39], v[80:95]
    ds_read_b128 v[52:55], v7
    ds_read_b64_tr_b16 v[60:61], v10 offset:10240
    ds_read_b64_tr_b16 v[62:63], v10 offset:10752
    s_lshl_b32 s99, s99, 5
    s_waitcnt lgkmcnt(6)
    v_mfma_f32_32x32x16_bf16 v[96:111], v[128:131], v[44:47], v[96:111]
    s_add_u32 s99, s99, s28
    v_mfma_f32_32x32x16_bf16 v[112:127], v[36:39], v[44:47], v[112:127]
    s_lshl_b32 s99, s99, 2
    s_waitcnt lgkmcnt(3)
    v_mfma_f32_32x32x16_bf16 v[64:79], v[56:59], v[132:135], v[64:79]
    ds_read_b128 v[136:139], v4
    ds_read_b64_tr_b16 v[40:41], v10 offset:4096
    ds_read_b64_tr_b16 v[42:43], v10 offset:4608
    s_add_u32 s99, s99, s34
    s_waitcnt lgkmcnt(5)
    v_mfma_f32_32x32x16_bf16 v[80:95], v[56:59], v[52:55], v[80:95]
    ds_read_b128 v[36:39], v8
    ds_read_b64_tr_b16 v[44:45], v10 offset:12288
    ds_read_b64_tr_b16 v[46:47], v10 offset:12800
    s_lshl_b32 s99, s99, 1
    s_waitcnt lgkmcnt(6)
    v_mfma_f32_32x32x16_bf16 v[96:111], v[132:135], v[60:63], v[96:111]
    s_and_b32 s96, s27, 1
    v_mfma_f32_32x32x16_bf16 v[112:127], v[52:55], v[60:63], v[112:127]
    s_barrier
    s_add_u32 s99, s99, s96
    s_waitcnt lgkmcnt(3)
    v_mfma_f32_32x32x16_bf16 v[64:79], v[40:43], v[136:139], v[64:79]
    ds_read_b128 v[140:143], v5
    ds_read_b64_tr_b16 v[56:57], v10 offset:6144
    ds_read_b64_tr_b16 v[58:59], v10 offset:6656
    s_lshl_b32 s96, s2, 3
    s_waitcnt lgkmcnt(5)
    v_mfma_f32_32x32x16_bf16 v[80:95], v[40:43], v[36:39], v[80:95]
    ds_read_b128 v[52:55], v9
    ds_read_b64_tr_b16 v[60:61], v10 offset:14336
    ds_read_b64_tr_b16 v[62:63], v10 offset:14848
    s_add_u32 s96, s96, s26
    s_waitcnt lgkmcnt(6)
    v_mfma_f32_32x32x16_bf16 v[96:111], v[136:139], v[44:47], v[96:111]
    s_cmp_eq_u32 s96, 4
    s_cselect_b32 s99, 0x400, s99
    s_cselect_b32 s96, 0, s26
    v_mfma_f32_32x32x16_bf16 v[112:127], v[36:39], v[44:47], v[112:127]
    s_lshl_b32 s87, s99, 12
    s_waitcnt lgkmcnt(3)
    v_mfma_f32_32x32x16_bf16 v[64:79], v[56:59], v[140:143], v[64:79]
    v_add_u32 v2, 0x8000, v2
    v_add_u32 v10, 0x8000, v10
    v_add_u32 v6, 0x8000, v6
    ds_read_b128 v[144:147], v2
    ds_read_b64_tr_b16 v[40:41], v10 offset:0
    ds_read_b64_tr_b16 v[42:43], v10 offset:512
    s_cmp_lt_u32 s96, 4
    s_cselect_b32 s99, s99, 0x10000
    s_waitcnt lgkmcnt(5)
    v_mfma_f32_32x32x16_bf16 v[80:95], v[56:59], v[52:55], v[80:95]
    ds_read_b128 v[36:39], v6
    ds_read_b64_tr_b16 v[44:45], v10 offset:8192
    ds_read_b64_tr_b16 v[46:47], v10 offset:8704
    s_and_b32 s88, s99, 1
    s_waitcnt lgkmcnt(6)
    v_mfma_f32_32x32x16_bf16 v[96:111], v[140:143], v[60:63], v[96:111]
    v_add_u32 v3, 0x8000, v3
    v_add_u32 v7, 0x8000, v7
    v_add_u32 v4, 0x8000, v4
    v_add_u32 v8, 0x8000, v8
    v_add_u32 v5, 0x8000, v5
    v_add_u32 v9, 0x8000, v9
    s_lshl_b32 s88, s88, 10
    v_mfma_f32_32x32x16_bf16 v[112:127], v[52:55], v[60:63], v[112:127]
    s_add_u32 s88, s88, 16793600
    s_waitcnt lgkmcnt(3)
    v_mfma_f32_32x32x16_bf16 v[64:79], v[40:43], v[144:147], v[64:79]
    ds_read_b128 v[148:151], v3
    ds_read_b64_tr_b16 v[56:57], v10 offset:2048
    ds_read_b64_tr_b16 v[58:59], v10 offset:2560
    s_lshl_b32 s89, s99, 31
    s_waitcnt lgkmcnt(5)
    v_mfma_f32_32x32x16_bf16 v[80:95], v[40:43], v[36:39], v[80:95]
    ds_read_b128 v[52:55], v7
    ds_read_b64_tr_b16 v[60:61], v10 offset:10240
    ds_read_b64_tr_b16 v[62:63], v10 offset:10752
    s_lshr_b32 s89, s89, 1
    s_waitcnt lgkmcnt(6)
    v_mfma_f32_32x32x16_bf16 v[96:111], v[144:147], v[44:47], v[96:111]
    s_add_u32 s89, s89, 16787456
    v_mfma_f32_32x32x16_bf16 v[112:127], v[36:39], v[44:47], v[112:127]
    s_lshl_b32 s63, s54, 1
    s_waitcnt lgkmcnt(3)
    v_mfma_f32_32x32x16_bf16 v[64:79], v[56:59], v[148:151], v[64:79]
    ds_read_b128 v[152:155], v4
    ds_read_b64_tr_b16 v[40:41], v10 offset:4096
    ds_read_b64_tr_b16 v[42:43], v10 offset:4608
    s_add_u32 s63, s63, s56
    s_waitcnt lgkmcnt(5)
    v_mfma_f32_32x32x16_bf16 v[80:95], v[56:59], v[52:55], v[80:95]
    ds_read_b128 v[36:39], v8
    ds_read_b64_tr_b16 v[44:45], v10 offset:12288
    ds_read_b64_tr_b16 v[46:47], v10 offset:12800
    s_and_b32 s64, s27, 1
    s_waitcnt lgkmcnt(6)
    v_mfma_f32_32x32x16_bf16 v[96:111], v[148:151], v[60:63], v[96:111]
    s_lshl_b32 s64, s64, 3
    v_mfma_f32_32x32x16_bf16 v[112:127], v[52:55], v[60:63], v[112:127]
    s_barrier
    s_lshr_b32 s96, s28, 3
    s_waitcnt lgkmcnt(3)
    v_mfma_f32_32x32x16_bf16 v[64:79], v[40:43], v[152:155], v[64:79]
    ds_read_b128 v[156:159], v5
    ds_read_b64_tr_b16 v[56:57], v10 offset:6144
    ds_read_b64_tr_b16 v[58:59], v10 offset:6656
    s_lshl_b32 s96, s96, 1
    s_waitcnt lgkmcnt(5)
    v_mfma_f32_32x32x16_bf16 v[80:95], v[40:43], v[36:39], v[80:95]
    ds_read_b128 v[52:55], v9
    ds_read_b64_tr_b16 v[60:61], v10 offset:14336
    ds_read_b64_tr_b16 v[62:63], v10 offset:14848
    s_add_u32 s64, s64, s96
    s_waitcnt lgkmcnt(6)
    v_mfma_f32_32x32x16_bf16 v[96:111], v[152:155], v[44:47], v[96:111]
    s_bfe_u32 s96, s27, 0x10001
    v_mfma_f32_32x32x16_bf16 v[112:127], v[36:39], v[44:47], v[112:127]
    s_add_u32 s64, s64, s96
    s_waitcnt lgkmcnt(3)
    v_mfma_f32_32x32x16_bf16 v[64:79], v[56:59], v[156:159], v[64:79]
    v_add_u32 v2, 0xfffe0000, v2
    v_add_u32 v10, 0xfffe0000, v10
    v_add_u32 v6, 0xfffe0000, v6
    ds_read_b128 v[160:163], v2
    ds_read_b64_tr_b16 v[40:41], v10 offset:0
    ds_read_b64_tr_b16 v[42:43], v10 offset:512
    s_lshl_b32 s64, s64, 2
    s_waitcnt lgkmcnt(5)
    v_mfma_f32_32x32x16_bf16 v[80:95], v[56:59], v[52:55], v[80:95]
    ds_read_b128 v[36:39], v6
    ds_read_b64_tr_b16 v[44:45], v10 offset:8192
    ds_read_b64_tr_b16 v[46:47], v10 offset:8704
    s_add_u32 s64, s64, s34
    s_waitcnt lgkmcnt(6)
    v_mfma_f32_32x32x16_bf16 v[96:111], v[156:159], v[60:63], v[96:111]
    v_add_u32 v3, 0xfffe0000, v3
    v_add_u32 v7, 0xfffe0000, v7
    v_add_u32 v4, 0xfffe0000, v4
    v_add_u32 v8, 0xfffe0000, v8
    v_add_u32 v5, 0xfffe0000, v5
    v_add_u32 v9, 0xfffe0000, v9
    s_lshr_b32 s62, s27, 2
    v_mfma_f32_32x32x16_bf16 v[112:127], v[52:55], v[60:63], v[112:127]
    s_lshl_b32 s62, s62, 3
    s_waitcnt lgkmcnt(3)
    v_mfma_f32_32x32x16_bf16 v[64:79], v[40:43], v[160:163], v[64:79]
    ds_read_b128 v[164:167], v3
    ds_read_b64_tr_b16 v[56:57], v10 offset:2048
    ds_read_b64_tr_b16 v[58:59], v10 offset:2560
    s_and_b32 s96, s28, 7
    s_waitcnt lgkmcnt(5)
    v_mfma_f32_32x32x16_bf16 v[80:95], v[40:43], v[36:39], v[80:95]
    ds_read_b128 v[52:55], v7
    ds_read_b64_tr_b16 v[60:61], v10 offset:10240
    ds_read_b64_tr_b16 v[62:63], v10 offset:10752
    s_add_u32 s62, s62, s96
    s_waitcnt lgkmcnt(6)
    v_mfma_f32_32x32x16_bf16 v[96:111], v[160:163], v[44:47], v[96:111]
    s_andn2_b32 s90, s28, 7
    v_mfma_f32_32x32x16_bf16 v[112:127], v[36:39], v[44:47], v[112:127]
    s_add_u32 s90, s90, s26
    s_waitcnt lgkmcnt(3)
    v_mfma_f32_32x32x16_bf16 v[64:79], v[56:59], v[164:167], v[64:79]
    ds_read_b128 v[168:171], v4
    ds_read_b64_tr_b16 v[40:41], v10 offset:4096
    ds_read_b64_tr_b16 v[42:43], v10 offset:4608
    s_lshl_b32 s90, s90, 16
    s_waitcnt lgkmcnt(5)
    v_mfma_f32_32x32x16_bf16 v[80:95], v[56:59], v[52:55], v[80:95]
    ds_read_b128 v[36:39], v8
    ds_read_b64_tr_b16 v[44:45], v10 offset:12288
    ds_read_b64_tr_b16 v[46:47], v10 offset:12800
    s_lshl_b32 s96, s62, 7
    s_waitcnt lgkmcnt(6)
    v_mfma_f32_32x32x16_bf16 v[96:111], v[164:167], v[60:63], v[96:111]
    s_add_u32 s90, s90, s96
    v_mfma_f32_32x32x16_bf16 v[112:127], v[52:55], v[60:63], v[112:127]
    s_barrier
    s_lshl_b32 s75, s54, 20
    s_waitcnt lgkmcnt(3)
    v_mfma_f32_32x32x16_bf16 v[64:79], v[40:43], v[168:171], v[64:79]
    ds_read_b128 v[172:175], v5
    ds_read_b64_tr_b16 v[56:57], v10 offset:6144
    ds_read_b64_tr_b16 v[58:59], v10 offset:6656
    s_add_u32 s75, s75, s96
    s_waitcnt lgkmcnt(5)
    v_mfma_f32_32x32x16_bf16 v[80:95], v[40:43], v[36:39], v[80:95]
    ds_read_b128 v[52:55], v9
    ds_read_b64_tr_b16 v[60:61], v10 offset:14336
    ds_read_b64_tr_b16 v[62:63], v10 offset:14848
    s_lshl_b32 s96, s34, 16
    s_waitcnt lgkmcnt(6)
    v_mfma_f32_32x32x16_bf16 v[96:111], v[168:171], v[44:47], v[96:111]
    s_add_u32 s75, s75, s96
    v_mfma_f32_32x32x16_bf16 v[112:127], v[36:39], v[44:47], v[112:127]
    s_lshl_b32 s91, s64, 1
    s_waitcnt lgkmcnt(3)
    v_mfma_f32_32x32x16_bf16 v[64:79], v[56:59], v[172:175], v[64:79]
    v_add_u32 v2, 0x8000, v2
    v_add_u32 v10, 0x8000, v10
    v_add_u32 v6, 0x8000, v6
    ds_read_b128 v[176:179], v2
    ds_read_b64_tr_b16 v[40:41], v10 offset:0
    ds_read_b64_tr_b16 v[42:43], v10 offset:512
    s_add_u32 s91, s91, s54
    s_waitcnt lgkmcnt(5)
    v_mfma_f32_32x32x16_bf16 v[80:95], v[56:59], v[52:55], v[80:95]
    ds_read_b128 v[36:39], v6
    ds_read_b64_tr_b16 v[44:45], v10 offset:8192
    ds_read_b64_tr_b16 v[46:47], v10 offset:8704
    s_lshl_b32 s91, s91, 7
    s_waitcnt lgkmcnt(6)
    v_mfma_f32_32x32x16_bf16 v[96:111], v[172:175], v[60:63], v[96:111]
    v_add_u32 v3, 0x8000, v3
    v_add_u32 v7, 0x8000, v7
    v_add_u32 v4, 0x8000, v4
    v_add_u32 v8, 0x8000, v8
    v_add_u32 v5, 0x8000, v5
    v_add_u32 v9, 0x8000, v9
    s_add_u32 s91, s91, 16883712
    v_mfma_f32_32x32x16_bf16 v[112:127], v[52:55], v[60:63], v[112:127]
    s_lshl_b32 s98, s34, 12
    s_waitcnt lgkmcnt(3)
    v_mfma_f32_32x32x16_bf16 v[64:79], v[40:43], v[176:179], v[64:79]
    ds_read_b128 v[180:183], v3
    ds_read_b64_tr_b16 v[56:57], v10 offset:2048
    ds_read_b64_tr_b16 v[58:59], v10 offset:2560
    s_lshr_b32 s58, s28, 2
    s_waitcnt lgkmcnt(5)
    v_mfma_f32_32x32x16_bf16 v[80:95], v[40:43], v[36:39], v[80:95]
    ds_read_b128 v[52:55], v7
    ds_read_b64_tr_b16 v[60:61], v10 offset:10240
    ds_read_b64_tr_b16 v[62:63], v10 offset:10752
    s_lshl_b32 s58, s58, 1
    s_waitcnt lgkmcnt(6)
    v_mfma_f32_32x32x16_bf16 v[96:111], v[176:179], v[44:47], v[96:111]
    s_add_u32 s58, s58, s55
    v_mfma_f32_32x32x16_bf16 v[112:127], v[36:39], v[44:47], v[112:127]
    s_lshl_b32 s59, s63, 1
    s_waitcnt lgkmcnt(3)
    v_mfma_f32_32x32x16_bf16 v[64:79], v[56:59], v[180:183], v[64:79]
    ds_read_b128 v[184:187], v4
    ds_read_b64_tr_b16 v[40:41], v10 offset:4096
    ds_read_b64_tr_b16 v[42:43], v10 offset:4608
    s_add_u32 s59, s59, s55
    s_waitcnt lgkmcnt(5)
    v_mfma_f32_32x32x16_bf16 v[80:95], v[56:59], v[52:55], v[80:95]
    ds_read_b128 v[36:39], v8
    ds_read_b64_tr_b16 v[44:45], v10 offset:12288
    ds_read_b64_tr_b16 v[46:47], v10 offset:12800
    s_lshl_b32 s59, s59, 12
    s_waitcnt lgkmcnt(6)
    v_mfma_f32_32x32x16_bf16 v[96:111], v[180:183], v[60:63], v[96:111]
    s_lshl_b32 s60, s64, 1
    v_mfma_f32_32x32x16_bf16 v[112:127], v[52:55], v[60:63], v[112:127]
    s_barrier
    s_add_u32 s60, s60, s54
    s_waitcnt lgkmcnt(3)
    v_mfma_f32_32x32x16_bf16 v[64:79], v[40:43], v[184:187], v[64:79]
    ds_read_b128 v[188:191], v5
    ds_read_b64_tr_b16 v[56:57], v10 offset:6144
    ds_read_b64_tr_b16 v[58:59], v10 offset:6656
    s_lshl_b32 s60, s60, 15
    s_waitcnt lgkmcnt(5)
    v_mfma_f32_32x32x16_bf16 v[80:95], v[40:43], v[36:39], v[80:95]
    ds_read_b128 v[52:55], v9
    ds_read_b64_tr_b16 v[60:61], v10 offset:14336
    ds_read_b64_tr_b16 v[62:63], v10 offset:14848
    s_add_u32 s60, s60, 8388608
    s_waitcnt lgkmcnt(6)
    v_mfma_f32_32x32x16_bf16 v[96:111], v[184:187], v[44:47], v[96:111]
    v_mfma_f32_32x32x16_bf16 v[112:127], v[36:39], v[44:47], v[112:127]
    s_waitcnt lgkmcnt(3)
    v_mfma_f32_32x32x16_bf16 v[64:79], v[56:59], v[188:191], v[64:79]
    v_add_u32 v2, 0x8000, v2
    v_add_u32 v10, 0x8000, v10
    v_add_u32 v6, 0x8000, v6
    ds_read_b128 v[192:195], v2
    ds_read_b64_tr_b16 v[40:41], v10 offset:0
    ds_read_b64_tr_b16 v[42:43], v10 offset:512
    s_waitcnt lgkmcnt(5)
    v_mfma_f32_32x32x16_bf16 v[80:95], v[56:59], v[52:55], v[80:95]
    ds_read_b128 v[36:39], v6
    ds_read_b64_tr_b16 v[44:45], v10 offset:8192
    ds_read_b64_tr_b16 v[46:47], v10 offset:8704
    s_waitcnt lgkmcnt(6)
    v_mfma_f32_32x32x16_bf16 v[96:111], v[188:191], v[60:63], v[96:111]
    v_add_u32 v3, 0x8000, v3
    v_add_u32 v7, 0x8000, v7
    v_add_u32 v4, 0x8000, v4
    v_add_u32 v8, 0x8000, v8
    v_add_u32 v5, 0x8000, v5
    v_add_u32 v9, 0x8000, v9
    v_mfma_f32_32x32x16_bf16 v[112:127], v[52:55], v[60:63], v[112:127]
    s_waitcnt lgkmcnt(3)
    v_mfma_f32_32x32x16_bf16 v[64:79], v[40:43], v[192:195], v[64:79]
    ds_read_b128 v[196:199], v3
    ds_read_b64_tr_b16 v[56:57], v10 offset:2048
    ds_read_b64_tr_b16 v[58:59], v10 offset:2560
    s_waitcnt lgkmcnt(5)
    v_mfma_f32_32x32x16_bf16 v[80:95], v[40:43], v[36:39], v[80:95]
    ds_read_b128 v[52:55], v7
    ds_read_b64_tr_b16 v[60:61], v10 offset:10240
    ds_read_b64_tr_b16 v[62:63], v10 offset:10752
    s_waitcnt lgkmcnt(6)
    v_mfma_f32_32x32x16_bf16 v[96:111], v[192:195], v[44:47], v[96:111]
    v_mfma_f32_32x32x16_bf16 v[112:127], v[36:39], v[44:47], v[112:127]
    s_waitcnt lgkmcnt(3)
    v_mfma_f32_32x32x16_bf16 v[64:79], v[56:59], v[196:199], v[64:79]
    ds_read_b128 v[200:203], v4
    ds_read_b64_tr_b16 v[40:41], v10 offset:4096
    ds_read_b64_tr_b16 v[42:43], v10 offset:4608
    s_waitcnt lgkmcnt(5)
    v_mfma_f32_32x32x16_bf16 v[80:95], v[56:59], v[52:55], v[80:95]
    ds_read_b128 v[36:39], v8
    ds_read_b64_tr_b16 v[44:45], v10 offset:12288
    ds_read_b64_tr_b16 v[46:47], v10 offset:12800
    s_waitcnt lgkmcnt(6)
    v_mfma_f32_32x32x16_bf16 v[96:111], v[196:199], v[60:63], v[96:111]
    v_mfma_f32_32x32x16_bf16 v[112:127], v[52:55], v[60:63], v[112:127]
    s_barrier
    s_waitcnt lgkmcnt(3)
    v_mfma_f32_32x32x16_bf16 v[64:79], v[40:43], v[200:203], v[64:79]
    ds_read_b128 v[204:207], v5
    ds_read_b64_tr_b16 v[56:57], v10 offset:6144
    ds_read_b64_tr_b16 v[58:59], v10 offset:6656
    s_waitcnt lgkmcnt(5)
    v_mfma_f32_32x32x16_bf16 v[80:95], v[40:43], v[36:39], v[80:95]
    ds_read_b128 v[52:55], v9
    ds_read_b64_tr_b16 v[60:61], v10 offset:14336
    ds_read_b64_tr_b16 v[62:63], v10 offset:14848
    s_waitcnt lgkmcnt(6)
    v_mfma_f32_32x32x16_bf16 v[96:111], v[200:203], v[44:47], v[96:111]
    buffer_load_dwordx2 v[12:13], v16, s[48:51], 0 offen sc1
    v_mfma_f32_32x32x16_bf16 v[112:127], v[36:39], v[44:47], v[112:127]
    s_waitcnt lgkmcnt(3)
    v_mfma_f32_32x32x16_bf16 v[64:79], v[56:59], v[204:207], v[64:79]
    v_add_u32 v2, 0x8000, v2
    v_add_u32 v10, 0x8000, v10
    v_add_u32 v6, 0x8000, v6
    ds_read_b128 v[208:211], v2
    ds_read_b64_tr_b16 v[40:41], v10 offset:0
    ds_read_b64_tr_b16 v[42:43], v10 offset:512
    s_waitcnt lgkmcnt(5)
    v_mfma_f32_32x32x16_bf16 v[80:95], v[56:59], v[52:55], v[80:95]
    ds_read_b128 v[36:39], v6
    ds_read_b64_tr_b16 v[44:45], v10 offset:8192
    ds_read_b64_tr_b16 v[46:47], v10 offset:8704
    s_waitcnt lgkmcnt(6)
    v_mfma_f32_32x32x16_bf16 v[96:111], v[204:207], v[60:63], v[96:111]
    v_add_u32 v3, 0x8000, v3
    v_add_u32 v7, 0x8000, v7
    v_add_u32 v4, 0x8000, v4
    v_add_u32 v8, 0x8000, v8
    v_add_u32 v5, 0x8000, v5
    v_add_u32 v9, 0x8000, v9
    v_mfma_f32_32x32x16_bf16 v[112:127], v[52:55], v[60:63], v[112:127]
    s_waitcnt lgkmcnt(3)
    v_mfma_f32_32x32x16_bf16 v[64:79], v[40:43], v[208:211], v[64:79]
    ds_read_b128 v[212:215], v3
    ds_read_b64_tr_b16 v[56:57], v10 offset:2048
    ds_read_b64_tr_b16 v[58:59], v10 offset:2560
    s_waitcnt lgkmcnt(5)
    v_mfma_f32_32x32x16_bf16 v[80:95], v[40:43], v[36:39], v[80:95]
    ds_read_b128 v[52:55], v7
    ds_read_b64_tr_b16 v[60:61], v10 offset:10240
    ds_read_b64_tr_b16 v[62:63], v10 offset:10752
    s_waitcnt lgkmcnt(6)
    v_mfma_f32_32x32x16_bf16 v[96:111], v[208:211], v[44:47], v[96:111]
    v_mfma_f32_32x32x16_bf16 v[112:127], v[36:39], v[44:47], v[112:127]
    s_waitcnt lgkmcnt(3)
    v_mfma_f32_32x32x16_bf16 v[64:79], v[56:59], v[212:215], v[64:79]
    ds_read_b128 v[216:219], v4
    ds_read_b64_tr_b16 v[40:41], v10 offset:4096
    ds_read_b64_tr_b16 v[42:43], v10 offset:4608
    s_waitcnt lgkmcnt(5)
    v_mfma_f32_32x32x16_bf16 v[80:95], v[56:59], v[52:55], v[80:95]
    ds_read_b128 v[36:39], v8
    ds_read_b64_tr_b16 v[44:45], v10 offset:12288
    ds_read_b64_tr_b16 v[46:47], v10 offset:12800
    s_waitcnt lgkmcnt(6)
    v_mfma_f32_32x32x16_bf16 v[96:111], v[212:215], v[60:63], v[96:111]
    v_mfma_f32_32x32x16_bf16 v[112:127], v[52:55], v[60:63], v[112:127]
    s_barrier
    s_waitcnt lgkmcnt(3)
    v_mfma_f32_32x32x16_bf16 v[64:79], v[40:43], v[216:219], v[64:79]
    ds_read_b128 v[220:223], v5
    ds_read_b64_tr_b16 v[56:57], v10 offset:6144
    ds_read_b64_tr_b16 v[58:59], v10 offset:6656
    s_waitcnt lgkmcnt(5)
    v_mfma_f32_32x32x16_bf16 v[80:95], v[40:43], v[36:39], v[80:95]
    ds_read_b128 v[52:55], v9
    ds_read_b64_tr_b16 v[60:61], v10 offset:14336
    ds_read_b64_tr_b16 v[62:63], v10 offset:14848
    s_waitcnt lgkmcnt(6)
    v_mfma_f32_32x32x16_bf16 v[96:111], v[216:219], v[44:47], v[96:111]
    v_mfma_f32_32x32x16_bf16 v[112:127], v[36:39], v[44:47], v[112:127]
    s_waitcnt lgkmcnt(3)
    v_mfma_f32_32x32x16_bf16 v[64:79], v[56:59], v[220:223], v[64:79]
    v_add_u32 v2, 0x8000, v2
    v_add_u32 v10, 0x8000, v10
    v_add_u32 v6, 0x8000, v6
    ds_read_b128 v[224:227], v2
    ds_read_b64_tr_b16 v[40:41], v10 offset:0
    ds_read_b64_tr_b16 v[42:43], v10 offset:512
    s_waitcnt lgkmcnt(5)
    v_mfma_f32_32x32x16_bf16 v[80:95], v[56:59], v[52:55], v[80:95]
    ds_read_b128 v[36:39], v6
    ds_read_b64_tr_b16 v[44:45], v10 offset:8192
    ds_read_b64_tr_b16 v[46:47], v10 offset:8704
    s_waitcnt lgkmcnt(6)
    v_mfma_f32_32x32x16_bf16 v[96:111], v[220:223], v[60:63], v[96:111]
    v_add_u32 v3, 0x8000, v3
    v_add_u32 v7, 0x8000, v7
    v_add_u32 v4, 0x8000, v4
    v_add_u32 v8, 0x8000, v8
    v_add_u32 v5, 0x8000, v5
    v_add_u32 v9, 0x8000, v9
    v_mfma_f32_32x32x16_bf16 v[112:127], v[52:55], v[60:63], v[112:127]
    s_waitcnt lgkmcnt(3)
    v_mfma_f32_32x32x16_bf16 v[64:79], v[40:43], v[224:227], v[64:79]
    ds_read_b128 v[228:231], v3
    ds_read_b64_tr_b16 v[56:57], v10 offset:2048
    ds_read_b64_tr_b16 v[58:59], v10 offset:2560
    s_waitcnt lgkmcnt(5)
    v_mfma_f32_32x32x16_bf16 v[80:95], v[40:43], v[36:39], v[80:95]
    ds_read_b128 v[52:55], v7
    ds_read_b64_tr_b16 v[60:61], v10 offset:10240
    ds_read_b64_tr_b16 v[62:63], v10 offset:10752
    s_waitcnt lgkmcnt(6)
    v_mfma_f32_32x32x16_bf16 v[96:111], v[224:227], v[44:47], v[96:111]
    v_mfma_f32_32x32x16_bf16 v[112:127], v[36:39], v[44:47], v[112:127]
    s_waitcnt lgkmcnt(3)
    v_mfma_f32_32x32x16_bf16 v[64:79], v[56:59], v[228:231], v[64:79]
    ds_read_b128 v[232:235], v4
    ds_read_b64_tr_b16 v[40:41], v10 offset:4096
    ds_read_b64_tr_b16 v[42:43], v10 offset:4608
    s_waitcnt lgkmcnt(5)
    v_mfma_f32_32x32x16_bf16 v[80:95], v[56:59], v[52:55], v[80:95]
    ds_read_b128 v[36:39], v8
    ds_read_b64_tr_b16 v[44:45], v10 offset:12288
    ds_read_b64_tr_b16 v[46:47], v10 offset:12800
    s_waitcnt lgkmcnt(6)
    v_mfma_f32_32x32x16_bf16 v[96:111], v[228:231], v[60:63], v[96:111]
    v_mfma_f32_32x32x16_bf16 v[112:127], v[52:55], v[60:63], v[112:127]
    s_barrier
    s_waitcnt lgkmcnt(3)
    v_mfma_f32_32x32x16_bf16 v[64:79], v[40:43], v[232:235], v[64:79]
    ds_read_b128 v[236:239], v5
    ds_read_b64_tr_b16 v[56:57], v10 offset:6144
    ds_read_b64_tr_b16 v[58:59], v10 offset:6656
    s_waitcnt lgkmcnt(5)
    v_mfma_f32_32x32x16_bf16 v[80:95], v[40:43], v[36:39], v[80:95]
    ds_read_b128 v[52:55], v9
    ds_read_b64_tr_b16 v[60:61], v10 offset:14336
    ds_read_b64_tr_b16 v[62:63], v10 offset:14848
    s_waitcnt lgkmcnt(6)
    v_mfma_f32_32x32x16_bf16 v[96:111], v[232:235], v[44:47], v[96:111]
    v_mfma_f32_32x32x16_bf16 v[112:127], v[36:39], v[44:47], v[112:127]
    s_waitcnt lgkmcnt(3)
    v_mfma_f32_32x32x16_bf16 v[64:79], v[56:59], v[236:239], v[64:79]
    v_add_u32 v2, 0xfffe0000, v2
    v_add_u32 v10, 0xfffe0000, v10
    v_add_u32 v6, 0xfffe0000, v6
    ds_read_b128 v[240:243], v2
    ds_read_b64_tr_b16 v[40:41], v10 offset:0
    ds_read_b64_tr_b16 v[42:43], v10 offset:512
    s_waitcnt lgkmcnt(5)
    v_mfma_f32_32x32x16_bf16 v[80:95], v[56:59], v[52:55], v[80:95]
    ds_read_b128 v[36:39], v6
    ds_read_b64_tr_b16 v[44:45], v10 offset:8192
    ds_read_b64_tr_b16 v[46:47], v10 offset:8704
    s_waitcnt lgkmcnt(6)
    v_mfma_f32_32x32x16_bf16 v[96:111], v[236:239], v[60:63], v[96:111]
    v_add_u32 v3, 0xfffe0000, v3
    v_add_u32 v7, 0xfffe0000, v7
    v_add_u32 v4, 0xfffe0000, v4
    v_add_u32 v8, 0xfffe0000, v8
    v_add_u32 v5, 0xfffe0000, v5
    v_add_u32 v9, 0xfffe0000, v9
    v_mfma_f32_32x32x16_bf16 v[112:127], v[52:55], v[60:63], v[112:127]
    s_waitcnt lgkmcnt(3)
    v_mfma_f32_32x32x16_bf16 v[64:79], v[40:43], v[240:243], v[64:79]
    ds_read_b128 v[244:247], v3
    ds_read_b64_tr_b16 v[56:57], v10 offset:2048
    ds_read_b64_tr_b16 v[58:59], v10 offset:2560
    s_waitcnt lgkmcnt(5)
    v_mfma_f32_32x32x16_bf16 v[80:95], v[40:43], v[36:39], v[80:95]
    ds_read_b128 v[52:55], v7
    ds_read_b64_tr_b16 v[60:61], v10 offset:10240
    ds_read_b64_tr_b16 v[62:63], v10 offset:10752
    s_waitcnt lgkmcnt(6)
    v_mfma_f32_32x32x16_bf16 v[96:111], v[240:243], v[44:47], v[96:111]
    s_waitcnt vmcnt(0)
SP1:
    v_readfirstlane_b32 s32, v12
    v_readfirstlane_b32 s33, v13
    s_cmp_lg_u32 s32, 0
    s_cbranch_scc1 SQ2
    s_sub_u32 s35, s35, 1
    s_cbranch_scc1 SQ2_t
    s_sleep 2
    buffer_load_dwordx2 v[12:13], v16, s[48:51], 0 offen sc1
    s_waitcnt vmcnt(0)
    s_branch SP1
SQ2_t:
    s_mov_b32 s35, 0
SQ2:
    s_lshl_b32 s100, s31, 2
    s_add_u32 s100, s100, s26
    s_lshl_b32 s100, s100, 12
    s_lshl_b32 s40, s52, 1
    s_add_u32 s40, s40, s101
    s_lshl_b32 s41, s53, 1
    s_add_u32 s41, s41, s101
    s_lshl_b32 s44, s40, 18
    s_add_u32 s44, s44, s100
    s_xor_b32 s45, s44, 0x1000
    s_lshl_b32 s46, s41, 18
    s_add_u32 s46, s46, s100
    s_xor_b32 s47, s46, 0x1000
    v_mfma_f32_32x32x16_bf16 v[112:127], v[36:39], v[44:47], v[112:127]
    s_waitcnt lgkmcnt(3)
    v_mfma_f32_32x32x16_bf16 v[64:79], v[56:59], v[244:247], v[64:79]
    ds_read_b128 v[248:251], v4
    ds_read_b64_tr_b16 v[40:41], v10 offset:4096
    ds_read_b64_tr_b16 v[42:43], v10 offset:4608
    s_waitcnt lgkmcnt(5)
    v_mfma_f32_32x32x16_bf16 v[80:95], v[56:59], v[52:55], v[80:95]
    ds_read_b128 v[36:39], v8
    ds_read_b64_tr_b16 v[44:45], v10 offset:12288
    ds_read_b64_tr_b16 v[46:47], v10 offset:12800
    s_waitcnt lgkmcnt(6)
    v_mfma_f32_32x32x16_bf16 v[96:111], v[244:247], v[60:63], v[96:111]
    v_and_b32 v30, 0x33, v0
    v_bfe_u32 v31, v0, 2, 1
    v_lshl_or_b32 v30, v31, 3, v30
    v_bfe_u32 v31, v0, 3, 1
    v_lshl_or_b32 v30, v31, 2, v30
    v_lshlrev_b32 v30, 4, v30
    v_mfma_f32_32x32x16_bf16 v[112:127], v[52:55], v[60:63], v[112:127]
    s_barrier
    s_waitcnt lgkmcnt(3)
    v_mfma_f32_32x32x16_bf16 v[64:79], v[40:43], v[248:251], v[64:79]
    ds_read_b128 v[252:255], v5
    ds_read_b64_tr_b16 v[56:57], v10 offset:6144
    ds_read_b64_tr_b16 v[58:59], v10 offset:6656
    s_waitcnt lgkmcnt(5)
    v_mfma_f32_32x32x16_bf16 v[80:95], v[40:43], v[36:39], v[80:95]
    ds_read_b128 v[52:55], v9
    ds_read_b64_tr_b16 v[60:61], v10 offset:14336
    ds_read_b64_tr_b16 v[62:63], v10 offset:14848
    s_waitcnt lgkmcnt(6)
    v_mfma_f32_32x32x16_bf16 v[96:111], v[248:251], v[44:47], v[96:111]
    v_mfma_f32_32x32x16_bf16 v[112:127], v[36:39], v[44:47], v[112:127]
    s_waitcnt lgkmcnt(3)
    v_mfma_f32_32x32x16_bf16 v[64:79], v[56:59], v[252:255], v[64:79]
    s_lshl_b32 s3, s101, 6
    v_xor_b32 v2, s3, v10
    v_add_u32 v2, 32768, v2
    v_xor_b32 v3, 64, v2
    s_waitcnt lgkmcnt(2)
    v_mfma_f32_32x32x16_bf16 v[80:95], v[56:59], v[52:55], v[80:95]
    s_waitcnt lgkmcnt(0)
    v_mfma_f32_32x32x16_bf16 v[96:111], v[252:255], v[60:63], v[96:111]
    v_mfma_f32_32x32x16_bf16 v[112:127], v[52:55], v[60:63], v[112:127]
    s_nop 2
    v_cvt_pk_bf16_f32 v64, v64, v65
    v_cvt_pk_bf16_f32 v65, v66, v67
    v_cvt_pk_bf16_f32 v66, v68, v69
    v_cvt_pk_bf16_f32 v67, v70, v71
    v_cvt_pk_bf16_f32 v68, v72, v73
    v_cvt_pk_bf16_f32 v69, v74, v75
    v_cvt_pk_bf16_f32 v70, v76, v77
    v_cvt_pk_bf16_f32 v71, v78, v79
    v_cvt_pk_bf16_f32 v72, v80, v81
    v_cvt_pk_bf16_f32 v73, v82, v83
    v_cvt_pk_bf16_f32 v74, v84, v85
    v_cvt_pk_bf16_f32 v75, v86, v87
    v_cvt_pk_bf16_f32 v76, v88, v89
    v_cvt_pk_bf16_f32 v77, v90, v91
    v_cvt_pk_bf16_f32 v78, v92, v93
    v_cvt_pk_bf16_f32 v79, v94, v95
    v_cvt_pk_bf16_f32 v80, v96, v97
    v_cvt_pk_bf16_f32 v81, v98, v99
    v_cvt_pk_bf16_f32 v82, v100, v101
    v_cvt_pk_bf16_f32 v83, v102, v103
    v_cvt_pk_bf16_f32 v84, v104, v105
    v_cvt_pk_bf16_f32 v85, v106, v107
    v_cvt_pk_bf16_f32 v86, v108, v109
    v_cvt_pk_bf16_f32 v87, v110, v111
    v_mov_b32 v102, v30
    ds_read_b64_tr_b16 v[8:9], v2 offset:0
    ds_read_b64_tr_b16 v[10:11], v2 offset:512
    ds_read_b64_tr_b16 v[12:13], v3 offset:0
    ds_read_b64_tr_b16 v[14:15], v3 offset:512
    v_cvt_pk_bf16_f32 v88, v112, v113
    v_cvt_pk_bf16_f32 v89, v114, v115
    v_cvt_pk_bf16_f32 v90, v116, v117
    v_cvt_pk_bf16_f32 v91, v118, v119
    v_cvt_pk_bf16_f32 v92, v120, v121
    v_cvt_pk_bf16_f32 v93, v122, v123
    v_cvt_pk_bf16_f32 v94, v124, v125
    v_cvt_pk_bf16_f32 v95, v126, v127
    ds_read_b64_tr_b16 v[16:17], v2 offset:2048
    ds_read_b64_tr_b16 v[18:19], v2 offset:2560
    ds_read_b64_tr_b16 v[20:21], v3 offset:2048
    ds_read_b64_tr_b16 v[22:23], v3 offset:2560
    s_setprio 0
    s_waitcnt lgkmcnt(6)
    v_mfma_f32_32x32x16_bf16 v[32:47], v[8:11], v[128:131], 0
    ds_read_b64_tr_b16 v[24:25], v2 offset:4096
    ds_read_b64_tr_b16 v[26:27], v2 offset:4608
    s_waitcnt lgkmcnt(6)
    v_mfma_f32_32x32x16_bf16 v[48:63], v[12:15], v[128:131], 0
    ds_read_b64_tr_b16 v[28:29], v3 offset:4096
    ds_read_b64_tr_b16 v[30:31], v3 offset:4608
    s_add_u32 s41, s41, 32
    s_lshl_b32 s40, s40, 8
    s_lshl_b32 s41, s41, 8
    s_lshl_b32 s3, s31, 1
    s_lshr_b32 s100, s26, 1
    s_add_u32 s100, s3, s100
    s_lshl_b32 s100, s100, 3
    s_add_u32 s100, s100, 16850944
    v_mov_b32 v96, s40
    v_mov_b32 v97, s41
    v_cmp_eq_u32 vcc, 0, v0
    s_nop 1
    v_cndmask_b32 v96, v97, v96, vcc
    v_mov_b32 v98, s32
    v_mov_b32 v99, s33
    buffer_store_dwordx4 v[64:67], v102, s[36:39], s44 offen offset:0 sc1
    s_waitcnt lgkmcnt(6)
    v_mfma_f32_32x32x16_bf16 v[32:47], v[16:19], v[132:135], v[32:47]
    ds_read_b64_tr_b16 v[8:9], v2 offset:6144
    ds_read_b64_tr_b16 v[10:11], v2 offset:6656
    s_waitcnt lgkmcnt(6)
    v_mfma_f32_32x32x16_bf16 v[48:63], v[20:23], v[132:135], v[48:63]
    ds_read_b64_tr_b16 v[12:13], v3 offset:6144
    ds_read_b64_tr_b16 v[14:15], v3 offset:6656
    s_lshl_b32 s42, s30, 19
    s_add_u32 s40, s24, s42
    s_addc_u32 s41, s25, 0
    s_mov_b32 s42, 524288
    s_mov_b32 s43, 0x00020000
    v_add_u32 v4, s65, v1
    buffer_store_dwordx4 v[68:71], v102, s[36:39], s44 offen offset:1024 sc1
    s_waitcnt lgkmcnt(6)
    v_mfma_f32_32x32x16_bf16 v[32:47], v[24:27], v[136:139], v[32:47]
    ds_read_b64_tr_b16 v[16:17], v2 offset:8192
    ds_read_b64_tr_b16 v[18:19], v2 offset:8704
    s_waitcnt lgkmcnt(6)
    v_mfma_f32_32x32x16_bf16 v[48:63], v[28:31], v[136:139], v[48:63]
    ds_read_b64_tr_b16 v[20:21], v3 offset:8192
    ds_read_b64_tr_b16 v[22:23], v3 offset:8704
    s_lshl_b32 s52, s34, 1
    s_add_u32 s52, s52, s54
    s_lshl_b32 s52, s52, 12
    s_lshl_b32 s31, s31, 14
    s_or_b32 s74, s98, s31
    v_mov_b32 v116, s32
    buffer_store_dwordx4 v[72:75], v102, s[36:39], s45 offen offset:0 sc1
    s_barrier
    s_waitcnt lgkmcnt(6)
    v_mfma_f32_32x32x16_bf16 v[32:47], v[8:11], v[140:143], v[32:47]
    ds_read_b64_tr_b16 v[24:25], v2 offset:10240
    ds_read_b64_tr_b16 v[26:27], v2 offset:10752
    s_waitcnt lgkmcnt(6)
    v_mfma_f32_32x32x16_bf16 v[48:63], v[12:15], v[140:143], v[48:63]
    ds_read_b64_tr_b16 v[28:29], v3 offset:10240
    ds_read_b64_tr_b16 v[30:31], v3 offset:10752
    v_mov_b32 v117, s33
    v_lshrrev_b32 v5, 4, v0
    v_and_b32 v6, 15, v0
    v_xor_b32 v7, v6, v5
    v_lshlrev_b32 v7, 4, v7
    v_lshl_add_u32 v112, v6, 8, v7
    buffer_store_dwordx4 v[76:79], v102, s[36:39], s45 offen offset:1024 sc1
    s_waitcnt lgkmcnt(6)
    v_mfma_f32_32x32x16_bf16 v[32:47], v[16:19], v[144:147], v[32:47]
    ds_read_b64_tr_b16 v[8:9], v2 offset:12288
    ds_read_b64_tr_b16 v[10:11], v2 offset:12800
    s_waitcnt lgkmcnt(6)
    v_mfma_f32_32x32x16_bf16 v[48:63], v[20:23], v[144:147], v[48:63]
    ds_read_b64_tr_b16 v[12:13], v3 offset:12288
    ds_read_b64_tr_b16 v[14:15], v3 offset:12800
    v_lshl_add_u32 v108, v5, 12, v7
    v_lshl_add_u32 v118, v5, 13, v7
    v_lshlrev_b32 v124, 3, v6
    v_xor_b32 v109, 64, v108
    v_add_u32 v109, 15360, v109
    v_xor_b32 v119, 64, v118
    buffer_store_dwordx4 v[80:83], v1, s[36:39], s46 offen offset:2048 sc1
    s_waitcnt lgkmcnt(6)
    v_mfma_f32_32x32x16_bf16 v[32:47], v[24:27], v[148:151], v[32:47]
    ds_read_b64_tr_b16 v[16:17], v2 offset:14336
    ds_read_b64_tr_b16 v[18:19], v2 offset:14848
    s_waitcnt lgkmcnt(6)
    v_mfma_f32_32x32x16_bf16 v[48:63], v[28:31], v[148:151], v[48:63]
    ds_read_b64_tr_b16 v[20:21], v3 offset:14336
    ds_read_b64_tr_b16 v[22:23], v3 offset:14848
    v_add_u32 v119, 31744, v119
    v_xor_b32 v110, 128, v108
    v_add_u32 v110, 30720, v110
    v_xor_b32 v120, 128, v118
    v_add_u32 v120, 63488, v120
    v_xor_b32 v111, 192, v108
    buffer_store_dwordx4 v[84:87], v1, s[36:39], s46 offen offset:3072 sc1
    v_add_u32 v2, 0x8000, v2
    v_add_u32 v3, 0x8000, v3
    s_waitcnt lgkmcnt(6)
    v_mfma_f32_32x32x16_bf16 v[32:47], v[8:11], v[152:155], v[32:47]
    ds_read_b64_tr_b16 v[24:25], v2 offset:0
    ds_read_b64_tr_b16 v[26:27], v2 offset:512
    s_waitcnt lgkmcnt(6)
    v_mfma_f32_32x32x16_bf16 v[48:63], v[12:15], v[152:155], v[48:63]
    ds_read_b64_tr_b16 v[28:29], v3 offset:0
    ds_read_b64_tr_b16 v[30:31], v3 offset:512
    v_add_u32 v111, 46080, v111
    v_xor_b32 v121, 192, v118
    v_add_u32 v121, 95232, v121
    s_lshl_b32 s96, s54, 14
    s_add_u32 s96, s96, 98304
    v_add_u32 v112, s96, v112
    buffer_store_dwordx4 v[88:91], v1, s[36:39], s47 offen offset:2048 sc1
    s_waitcnt lgkmcnt(6)
    v_mfma_f32_32x32x16_bf16 v[32:47], v[16:19], v[156:159], v[32:47]
    ds_read_b64_tr_b16 v[8:9], v2 offset:2048
    ds_read_b64_tr_b16 v[10:11], v2 offset:2560
    s_waitcnt lgkmcnt(6)
    v_mfma_f32_32x32x16_bf16 v[48:63], v[20:23], v[156:159], v[48:63]
    ds_read_b64_tr_b16 v[12:13], v3 offset:2048
    ds_read_b64_tr_b16 v[14:15], v3 offset:2560
    v_xor_b32 v113, 64, v112
    v_xor_b32 v114, 128, v112
    v_xor_b32 v115, 192, v112
    v_and_b32 v5, 31, v0
    v_lshlrev_b32 v123, 3, v5
    v_lshlrev_b32 v125, 2, v5
    buffer_store_dwordx4 v[92:95], v1, s[36:39], s47 offen offset:3072 sc1
    s_waitcnt lgkmcnt(6)
    v_mfma_f32_32x32x16_bf16 v[32:47], v[24:27], v[160:163], v[32:47]
    ds_read_b64_tr_b16 v[16:17], v2 offset:4096
    ds_read_b64_tr_b16 v[18:19], v2 offset:4608
    v_lshlrev_b32 v127, 3, v0
    v_add_u32 v127, 16867328, v127
    v_mov_b32 v122, 0
    s_lshl_b32 s96, s29, 1
    v_xor_b32 v5, s96, v0
    v_and_b32 v5, 31, v5
    s_waitcnt lgkmcnt(6)
    v_mfma_f32_32x32x16_bf16 v[48:63], v[28:31], v[160:163], v[48:63]
    ds_read_b64_tr_b16 v[20:21], v3 offset:4096
    ds_read_b64_tr_b16 v[22:23], v3 offset:4608
    s_cmp_lt_u32 s34, 2
    s_cselect_b32 s44, s10, s12
    s_cselect_b32 s45, s11, s13
    s_mov_b32 s46, 2097152
    s_mov_b32 s47, 0x00020000
    s_waitcnt lgkmcnt(6)
    v_mfma_f32_32x32x16_bf16 v[32:47], v[8:11], v[164:167], v[32:47]
    ds_read_b64_tr_b16 v[24:25], v2 offset:6144
    ds_read_b64_tr_b16 v[26:27], v2 offset:6656
    v_lshrrev_b32 v6, 5, v0
    v_lshlrev_b32 v6, 13, v6
    v_lshl_add_u32 v5, v5, 3, v6
    s_waitcnt lgkmcnt(6)
    v_mfma_f32_32x32x16_bf16 v[48:63], v[12:15], v[164:167], v[48:63]
    ds_read_b64_tr_b16 v[28:29], v3 offset:6144
    ds_read_b64_tr_b16 v[30:31], v3 offset:6656
    v_add_u32 v104, s95, v5
    s_lshl_b32 s96, s63, 3
    v_xor_b32 v6, s96, v0
    s_mov_b32 s48, s4
    s_mov_b32 s49, s5
    s_mov_b32 s50, 4194304
    s_mov_b32 s51, 0x00020000
    s_mov_b32 s3, 1048576
    buffer_load_dwordx4 v[128:131], v1, s[48:51], s3 offen
    buffer_load_dwordx4 v[132:135], v1, s[48:51], s3 offen offset:1024
    s_mov_b32 s3, 3145728
    buffer_load_dwordx4 v[136:139], v1, s[48:51], s3 offen
    buffer_load_dwordx4 v[140:143], v1, s[48:51], s3 offen offset:1024
    s_waitcnt lgkmcnt(6)
    v_mfma_f32_32x32x16_bf16 v[32:47], v[16:19], v[168:171], v[32:47]
    ds_read_b64_tr_b16 v[8:9], v2 offset:8192
    ds_read_b64_tr_b16 v[10:11], v2 offset:8704
    v_lshrrev_b32 v7, 5, v6
    v_and_b32 v5, 15, v6
    v_xor_b32 v7, v7, v5
    s_waitcnt lgkmcnt(6)
    v_mfma_f32_32x32x16_bf16 v[48:63], v[20:23], v[168:171], v[48:63]
    ds_read_b64_tr_b16 v[12:13], v3 offset:8192
    ds_read_b64_tr_b16 v[14:15], v3 offset:8704
    v_lshlrev_b32 v7, 4, v7
    v_and_b32 v6, 31, v6
    v_lshl_add_u32 v156, v6, 8, v7
    s_cmp_gt_u32 s61, 512
    s_cselect_b32 s48, s12, s10
    s_cselect_b32 s49, s13, s11
    s_cselect_b32 s3, 512, 0
    s_mov_b32 s50, 2097152
    s_sub_u32 s3, s61, s3
    s_lshl_b32 s3, s3, 11
    buffer_load_dwordx4 v[144:147], v1, s[48:51], s3 offen
    buffer_load_dwordx4 v[148:151], v1, s[48:51], s3 offen offset:1024
    s_barrier
    s_waitcnt lgkmcnt(6)
    v_mfma_f32_32x32x16_bf16 v[32:47], v[24:27], v[172:175], v[32:47]
    ds_read_b64_tr_b16 v[16:17], v2 offset:10240
    ds_read_b64_tr_b16 v[18:19], v2 offset:10752
    s_lshl_b32 s96, s63, 13
    s_add_u32 s96, s96, 98304
    v_add_u32 v156, s96, v156
    s_waitcnt lgkmcnt(6)
    v_mfma_f32_32x32x16_bf16 v[48:63], v[28:31], v[172:175], v[48:63]
    ds_read_b64_tr_b16 v[20:21], v3 offset:10240
    ds_read_b64_tr_b16 v[22:23], v3 offset:10752
    v_xor_b32 v157, 32, v156
    v_xor_b32 v158, 64, v156
    v_xor_b32 v159, 96, v156
    v_mov_b32 v153, 1073741824
    v_cmp_eq_u32 vcc, 63, v0
    s_nop 1
    v_cndmask_b32 v153, v153, 0, vcc
    s_waitcnt lgkmcnt(6)
    v_mfma_f32_32x32x16_bf16 v[32:47], v[8:11], v[176:179], v[32:47]
    ds_read_b64_tr_b16 v[24:25], v2 offset:12288
    ds_read_b64_tr_b16 v[26:27], v2 offset:12800
    v_xor_b32 v160, 128, v156
    v_xor_b32 v161, 160, v156
    v_xor_b32 v162, 192, v156
    s_waitcnt lgkmcnt(6)
    v_mfma_f32_32x32x16_bf16 v[48:63], v[12:15], v[176:179], v[48:63]
    ds_read_b64_tr_b16 v[28:29], v3 offset:12288
    ds_read_b64_tr_b16 v[30:31], v3 offset:12800
    v_xor_b32 v163, 224, v156
    v_mov_b32 v7, 0xbf803f80
    s_mov_b32 vcc_lo, 0x00020001
    s_mov_b32 vcc_hi, 0x00020001
    v_cndmask_b32 v164, 0, v7, vcc
    v_cndmask_b32 v165, 0, v7, vcc
    v_cndmask_b32 v166, 0, v7, vcc
    v_cndmask_b32 v167, 0, v7, vcc
    s_waitcnt lgkmcnt(6)
    v_mfma_f32_32x32x16_bf16 v[32:47], v[16:19], v[180:183], v[32:47]
    ds_read_b64_tr_b16 v[8:9], v2 offset:14336
    ds_read_b64_tr_b16 v[10:11], v2 offset:14848
    v_lshrrev_b32 v6, 3, v0
    v_and_b32 v7, 7, v0
    v_bfe_u32 v5, v0, 4, 1
    s_waitcnt lgkmcnt(6)
    v_mfma_f32_32x32x16_bf16 v[48:63], v[20:23], v[180:183], v[48:63]
    ds_read_b64_tr_b16 v[12:13], v3 offset:14336
    ds_read_b64_tr_b16 v[14:15], v3 offset:14848
    v_lshlrev_b32 v5, 2, v5
    v_xor_b32 v7, v7, v5
    v_lshlrev_b32 v7, 4, v7
    v_add_u32 v2, 0x8000, v2
    v_add_u32 v3, 0x8000, v3
    s_waitcnt lgkmcnt(6)
    v_mfma_f32_32x32x16_bf16 v[32:47], v[24:27], v[184:187], v[32:47]
    ds_read_b64_tr_b16 v[16:17], v2 offset:0
    ds_read_b64_tr_b16 v[18:19], v2 offset:512
    v_lshl_add_u32 v176, v6, 11, v7
    v_add_u32 v177, 15360, v176
    v_add_u32 v178, 30720, v176
    s_waitcnt lgkmcnt(6)
    v_mfma_f32_32x32x16_bf16 v[48:63], v[28:31], v[184:187], v[48:63]
    ds_read_b64_tr_b16 v[20:21], v3 offset:0
    ds_read_b64_tr_b16 v[22:23], v3 offset:512
    v_add_u32 v179, 46080, v176
    v_mov_b32 v180, -1
    v_mov_b32 v181, -1
    s_waitcnt lgkmcnt(6)
    v_mfma_f32_32x32x16_bf16 v[32:47], v[8:11], v[188:191], v[32:47]
    ds_read_b64_tr_b16 v[24:25], v2 offset:2048
    ds_read_b64_tr_b16 v[26:27], v2 offset:2560
    v_mov_b32 v182, -1
    v_mov_b32 v183, -1
    v_and_b32 v184, 48, v0
    s_waitcnt lgkmcnt(6)
    v_mfma_f32_32x32x16_bf16 v[48:63], v[12:15], v[188:191], v[48:63]
    ds_read_b64_tr_b16 v[28:29], v3 offset:2048
    ds_read_b64_tr_b16 v[30:31], v3 offset:2560
    v_lshrrev_b32 v185, 1, v184
    v_lshrrev_b32 v7, 5, v0
    v_lshl_add_u32 v186, v7, 2, v123
    s_waitcnt lgkmcnt(6)
    v_mfma_f32_32x32x16_bf16 v[32:47], v[16:19], v[192:195], v[32:47]
    ds_read_b64_tr_b16 v[8:9], v2 offset:4096
    ds_read_b64_tr_b16 v[10:11], v2 offset:4608
    v_add_u32 v186, s94, v186
    v_mov_b32 v7, 1073741824
    v_cmp_eq_u32 vcc, 0x800, v186
    s_nop 1
    v_cndmask_b32 v186, v186, v7, vcc
    s_waitcnt lgkmcnt(6)
    v_mfma_f32_32x32x16_bf16 v[48:63], v[20:23], v[192:195], v[48:63]
    ds_read_b64_tr_b16 v[12:13], v3 offset:4096
    ds_read_b64_tr_b16 v[14:15], v3 offset:4608
    v_add_u32 v186, 16785408, v186
    v_lshlrev_b32 v187, 9, v125
    s_waitcnt lgkmcnt(6)
    v_mfma_f32_32x32x16_bf16 v[32:47], v[24:27], v[196:199], v[32:47]
    ds_read_b64_tr_b16 v[16:17], v2 offset:6144
    ds_read_b64_tr_b16 v[18:19], v2 offset:6656
    v_cmp_eq_u32 vcc, 63, v0
    s_nop 1
    v_cndmask_b32 v189, v7, 0, vcc
    s_waitcnt lgkmcnt(6)
    v_mfma_f32_32x32x16_bf16 v[48:63], v[28:31], v[196:199], v[48:63]
    ds_read_b64_tr_b16 v[20:21], v3 offset:6144
    ds_read_b64_tr_b16 v[22:23], v3 offset:6656
    s_waitcnt vmcnt(6)
    buffer_store_dwordx2 v[98:99], v96, s[36:39], s100 offen sc1
    s_waitcnt lgkmcnt(6)
    v_mfma_f32_32x32x16_bf16 v[32:47], v[8:11], v[200:203], v[32:47]
    ds_read_b64_tr_b16 v[24:25], v2 offset:8192
    ds_read_b64_tr_b16 v[26:27], v2 offset:8704
    s_waitcnt lgkmcnt(6)
    v_mfma_f32_32x32x16_bf16 v[48:63], v[12:15], v[200:203], v[48:63]
    ds_read_b64_tr_b16 v[28:29], v3 offset:8192
    ds_read_b64_tr_b16 v[30:31], v3 offset:8704
    s_barrier
    s_waitcnt lgkmcnt(6)
    v_mfma_f32_32x32x16_bf16 v[32:47], v[16:19], v[204:207], v[32:47]
    ds_read_b64_tr_b16 v[8:9], v2 offset:10240
    ds_read_b64_tr_b16 v[10:11], v2 offset:10752
    s_waitcnt lgkmcnt(6)
    v_mfma_f32_32x32x16_bf16 v[48:63], v[20:23], v[204:207], v[48:63]
    ds_read_b64_tr_b16 v[12:13], v3 offset:10240
    ds_read_b64_tr_b16 v[14:15], v3 offset:10752
    s_waitcnt lgkmcnt(6)
    v_mfma_f32_32x32x16_bf16 v[32:47], v[24:27], v[208:211], v[32:47]
    ds_read_b64_tr_b16 v[16:17], v2 offset:12288
    ds_read_b64_tr_b16 v[18:19], v2 offset:12800
    s_waitcnt lgkmcnt(6)
    v_mfma_f32_32x32x16_bf16 v[48:63], v[28:31], v[208:211], v[48:63]
    ds_read_b64_tr_b16 v[20:21], v3 offset:12288
    ds_read_b64_tr_b16 v[22:23], v3 offset:12800
    s_waitcnt lgkmcnt(6)
    v_mfma_f32_32x32x16_bf16 v[32:47], v[8:11], v[212:215], v[32:47]
    ds_read_b64_tr_b16 v[24:25], v2 offset:14336
    ds_read_b64_tr_b16 v[26:27], v2 offset:14848
    s_waitcnt lgkmcnt(6)
    v_mfma_f32_32x32x16_bf16 v[48:63], v[12:15], v[212:215], v[48:63]
    ds_read_b64_tr_b16 v[28:29], v3 offset:14336
    ds_read_b64_tr_b16 v[30:31], v3 offset:14848
    v_add_u32 v2, 0x8000, v2
    v_add_u32 v3, 0x8000, v3
    s_waitcnt lgkmcnt(6)
    v_mfma_f32_32x32x16_bf16 v[32:47], v[16:19], v[216:219], v[32:47]
    ds_read_b64_tr_b16 v[8:9], v2 offset:0
    ds_read_b64_tr_b16 v[10:11], v2 offset:512
    s_sub_u32 s3, s26, 2
    s_cselect_b32 s100, 12, 0
    s_add_u32 s3, s3, s100
    s_lshl_b32 s3, s3, 1
    s_add_u32 s3, s3, s101
    s_lshl_b32 s3, s3, 12
    v_add_u32 v96, s3, v102
    v_xor_b32 v97, 0x2000, v96
    s_sub_u32 s3, s26, 0
    s_cselect_b32 s100, 12, 0
    s_add_u32 s3, s3, s100
    s_lshl_b32 s3, s3, 1
    s_add_u32 s3, s3, s101
    s_lshl_b32 s3, s3, 12
    v_add_u32 v100, s3, v1
    v_xor_b32 v101, 0x2000, v100
    s_waitcnt lgkmcnt(6)
    v_mfma_f32_32x32x16_bf16 v[48:63], v[20:23], v[216:219], v[48:63]
    ds_read_b64_tr_b16 v[12:13], v3 offset:0
    ds_read_b64_tr_b16 v[14:15], v3 offset:512
    s_waitcnt vmcnt(1)
    v_mov_b32 v152, 0
    v_dot2_f32_bf16 v152, v136, v144, v152
    v_dot2_f32_bf16 v152, v137, v145, v152
    v_dot2_f32_bf16 v152, v138, v146, v152
    v_dot2_f32_bf16 v152, v139, v147, v152
    s_waitcnt lgkmcnt(6)
    v_mfma_f32_32x32x16_bf16 v[32:47], v[24:27], v[220:223], v[32:47]
    ds_read_b64_tr_b16 v[16:17], v2 offset:2048
    ds_read_b64_tr_b16 v[18:19], v2 offset:2560
    v_dot2_f32_bf16 v152, v140, v148, v152
    v_dot2_f32_bf16 v152, v141, v149, v152
    s_waitcnt lgkmcnt(6)
    v_mfma_f32_32x32x16_bf16 v[48:63], v[28:31], v[220:223], v[48:63]
    ds_read_b64_tr_b16 v[20:21], v3 offset:2048
    ds_read_b64_tr_b16 v[22:23], v3 offset:2560
    v_dot2_f32_bf16 v152, v142, v150, v152
    v_dot2_f32_bf16 v152, v143, v151, v152
    buffer_load_dwordx2 v[106:107], v104, s[36:39], 0 offen sc1
    s_waitcnt lgkmcnt(6)
    v_mfma_f32_32x32x16_bf16 v[32:47], v[8:11], v[224:227], v[32:47]
    ds_read_b64_tr_b16 v[24:25], v2 offset:4096
    ds_read_b64_tr_b16 v[26:27], v2 offset:4608
    ds_write_b128 v96, v[64:67] offset:0
    ds_write_b128 v96, v[68:71] offset:1024
    s_waitcnt lgkmcnt(8)
    v_mfma_f32_32x32x16_bf16 v[48:63], v[12:15], v[224:227], v[48:63]
    ds_read_b64_tr_b16 v[28:29], v3 offset:4096
    ds_read_b64_tr_b16 v[30:31], v3 offset:4608
    s_cmp_gt_u32 s61, 512
    s_cselect_b32 s3, 0x80000000, 0
    v_xor_b32 v152, s3, v152
    v_dot2_f32_bf16 v152, v128, v144, v152
    v_dot2_f32_bf16 v152, v129, v145, v152
    v_dot2_f32_bf16 v152, v130, v146, v152
    v_dot2_f32_bf16 v152, v131, v147, v152
    s_waitcnt lgkmcnt(8)
    v_mfma_f32_32x32x16_bf16 v[32:47], v[16:19], v[228:231], v[32:47]
    ds_read_b64_tr_b16 v[8:9], v2 offset:6144
    ds_read_b64_tr_b16 v[10:11], v2 offset:6656
    ds_write_b128 v97, v[72:75] offset:0
    ds_write_b128 v97, v[76:79] offset:1024
    s_waitcnt lgkmcnt(10)
    v_mfma_f32_32x32x16_bf16 v[48:63], v[20:23], v[228:231], v[48:63]
    ds_read_b64_tr_b16 v[12:13], v3 offset:6144
    ds_read_b64_tr_b16 v[14:15], v3 offset:6656
    v_dot2_f32_bf16 v152, v132, v148, v152
    v_dot2_f32_bf16 v152, v133, v149, v152
    v_dot2_f32_bf16 v152, v134, v150, v152
    v_dot2_f32_bf16 v152, v135, v151, v152
    s_waitcnt lgkmcnt(10)
    v_mfma_f32_32x32x16_bf16 v[32:47], v[24:27], v[232:235], v[32:47]
    ds_read_b64_tr_b16 v[16:17], v2 offset:8192
    ds_read_b64_tr_b16 v[18:19], v2 offset:8704
    ds_write_b128 v100, v[80:83] offset:2048
    ds_write_b128 v100, v[84:87] offset:3072
    s_waitcnt lgkmcnt(10)
    v_mfma_f32_32x32x16_bf16 v[48:63], v[28:31], v[232:235], v[48:63]
    ds_read_b64_tr_b16 v[20:21], v3 offset:8192
    ds_read_b64_tr_b16 v[22:23], v3 offset:8704
    v_add_f32_dpp v152, v152, v152 row_shr:1 row_mask:0xf bank_mask:0xf bound_ctrl:0
    s_nop 1
    v_add_f32_dpp v152, v152, v152 row_shr:2 row_mask:0xf bank_mask:0xf bound_ctrl:0
    s_barrier
    s_waitcnt lgkmcnt(10)
    v_mfma_f32_32x32x16_bf16 v[32:47], v[8:11], v[236:239], v[32:47]
    ds_read_b64_tr_b16 v[24:25], v2 offset:10240
    ds_read_b64_tr_b16 v[26:27], v2 offset:10752
    ds_write_b128 v101, v[88:91] offset:2048
    ds_write_b128 v101, v[92:95] offset:3072
    s_waitcnt lgkmcnt(10)
    v_mfma_f32_32x32x16_bf16 v[48:63], v[12:15], v[236:239], v[48:63]
    ds_read_b64_tr_b16 v[28:29], v3 offset:10240
    ds_read_b64_tr_b16 v[30:31], v3 offset:10752
    v_add_f32_dpp v152, v152, v152 row_shr:4 row_mask:0xf bank_mask:0xf bound_ctrl:0
    s_nop 1
    v_add_f32_dpp v152, v152, v152 row_shr:8 row_mask:0xf bank_mask:0xf bound_ctrl:0
    s_waitcnt lgkmcnt(10)
    v_mfma_f32_32x32x16_bf16 v[32:47], v[16:19], v[240:243], v[32:47]
    ds_read_b64_tr_b16 v[8:9], v2 offset:12288
    ds_read_b64_tr_b16 v[10:11], v2 offset:12800
    v_add_f32_dpp v152, v152, v152 row_bcast:15 row_mask:0xa bank_mask:0xf
    s_waitcnt lgkmcnt(8)
    v_mfma_f32_32x32x16_bf16 v[48:63], v[20:23], v[240:243], v[48:63]
    ds_read_b64_tr_b16 v[12:13], v3 offset:12288
    ds_read_b64_tr_b16 v[14:15], v3 offset:12800
    v_add_f32_dpp v152, v152, v152 row_bcast:31 row_mask:0xc bank_mask:0xf
    s_waitcnt lgkmcnt(8)
    v_mfma_f32_32x32x16_bf16 v[32:47], v[24:27], v[244:247], v[32:47]
    ds_read_b64_tr_b16 v[16:17], v2 offset:14336
    ds_read_b64_tr_b16 v[18:19], v2 offset:14848
    s_waitcnt lgkmcnt(6)
    v_mfma_f32_32x32x16_bf16 v[48:63], v[28:31], v[244:247], v[48:63]
    ds_read_b64_tr_b16 v[20:21], v3 offset:14336
    ds_read_b64_tr_b16 v[22:23], v3 offset:14848
    s_lshl_b32 s3, s61, 2
    s_add_u32 s3, s3, 16785408
    buffer_store_dword v152, v153, s[36:39], s3 offen sc1
    s_waitcnt lgkmcnt(6)
    v_mfma_f32_32x32x16_bf16 v[32:47], v[8:11], v[248:251], v[32:47]
    s_waitcnt lgkmcnt(4)
    v_mfma_f32_32x32x16_bf16 v[48:63], v[12:15], v[248:251], v[48:63]
    s_waitcnt lgkmcnt(0)
    v_mfma_f32_32x32x16_bf16 v[48:63], v[20:23], v[252:255], v[48:63]
    v_mfma_f32_32x32x16_bf16 v[32:47], v[16:19], v[252:255], v[32:47]
    s_waitcnt vmcnt(1)
    s_branch F_ATT
F_L:
    v_lshrrev_b32 v1, 3, v0
    v_and_b32 v6, 7, v0
    v_lshrrev_b32 v7, 4, v0
    v_xor_b32 v8, v6, v7
    v_lshlrev_b32 v8, 4, v8
    v_lshl_add_u32 v8, v1, 11, v8
    s_lshl_b32 s56, s29, 18
    s_lshl_b32 s57, s34, 16
    s_add_u32 s56, s56, s57
    v_add_u32 v2, s56, v8
    v_xor_b32 v3, 64, v2
    v_add_u32 v3, 15360, v3
    v_add_u32 v4, 30720, v2
    v_add_u32 v5, 30720, v3
    v_and_b32 v7, 1, v7
    v_lshlrev_b32 v7, 2, v7
    v_xor_b32 v6, v6, v7
    v_lshlrev_b32 v6, 4, v6
    s_lshl_b32 s56, s34, 4
    v_add_u32 v1, s56, v1
    v_mul_u32_u24 v1, 0x1800, v1
    v_add_u32 v6, v1, v6
    v_add_u32 v7, 48128, v6
    s_lshl_b32 s52, s52, 7
    s_add_u32 s52, s52, 2048
    s_lshl_b32 s53, s53, 7
    s_add_u32 s53, s53, 4096
    s_lshl_b32 s58, s34, 12
    s_lshl_b32 s59, s34, 11
    s_lshl_b32 s60, s30, 7
    s_waitcnt lgkmcnt(0)
    s_mov_b32 s40, s14
    s_mov_b32 s41, s15
    s_mov_b32 s42, 4194304
    s_mov_b32 s43, 0x00020000
    s_mov_b32 s44, s16
    s_mov_b32 s45, s17
    s_mov_b32 s46, 6291456
    s_mov_b32 s47, 0x00020000
    s_and_b32 s56, s28, 15
    s_lshr_b32 s57, s28, 4
    s_lshl_b32 s61, s57, 1
    s_and_b32 s3, s28, 1
    s_add_u32 s61, s61, s3
    s_mul_i32 s64, s3, 393216
    s_bfe_u32 s3, s56, 0x20001
    s_add_u32 s3, s3, 1
    s_cmp_eq_u32 s3, 3
    s_cselect_b32 s3, 0, s3
    s_lshl_b32 s3, s3, 11
    s_add_u32 s64, s64, s3
    s_lshr_b32 s3, s27, 1
    s_lshl_b32 s3, s3, 9
    s_add_u32 s64, s64, s3
    s_cmp_lt_u32 s56, 14
    s_cselect_b32 s64, s64, 1073741824
    s_and_b32 s3, s27, 1
    s_lshl_b32 s3, s3, 3
    s_add_u32 s3, s3, s56
    s_lshl_b32 s3, s3, 18
    s_cmp_lt_u32 s56, 8
    s_cselect_b32 s64, s3, s64
    s_movk_i32 s3, 256
    s_cselect_b32 s63, s3, 786432
    s_cselect_b32 s96, s40, s44
    s_cselect_b32 s97, s41, s45
    s_cselect_b32 s98, s42, s46
    s_cselect_b32 s56, 1, 2
    s_movk_i32 s3, 2048
    s_cselect_b32 s3, s3, 6144
    s_cselect_b32 s65, 1, 3
    s_mov_b32 s99, 0x00020000
    s_mul_i32 s62, s57, s63
    s_lshl_b32 s63, s63, 1
    s_lshl_b32 s57, s34, 6
    v_add_u32 v22, s57, v0
    v_lshrrev_b32 v22, s56, v22
    v_mul_u32_u24 v22, s3, v22
    v_and_b32 v23, s65, v0
    v_lshl_add_u32 v22, v23, 7, v22
    v_add_u32 v22, s64, v22
    buffer_load_dword v24, v22, s[96:99], s62 offen
    s_add_u32 m0, s58, 0
    s_movk_i32 s3, 0
    buffer_load_dwordx4 v2, s[40:43], s3 offen offset:0 lds
    buffer_load_dwordx4 v3, s[40:43], s3 offen offset:1024 lds
    buffer_load_dwordx4 v4, s[40:43], s3 offen offset:2048 lds
    buffer_load_dwordx4 v5, s[40:43], s3 offen offset:3072 lds
    s_add_u32 m0, s59, 16384
    s_add_u32 s3, s52, 0
    buffer_load_dwordx4 v6, s[44:47], s3 offen lds
    buffer_load_dwordx4 v7, s[44:47], s3 offen offset:1024 lds
    s_add_u32 m0, s59, 24576
    s_add_u32 s3, s53, 0
    buffer_load_dwordx4 v6, s[44:47], s3 offen lds
    buffer_load_dwordx4 v7, s[44:47], s3 offen offset:1024 lds
    s_add_u32 m0, s58, 32768
    s_movk_i32 s3, 128
    buffer_load_dwordx4 v2, s[40:43], s3 offen offset:0 lds
    buffer_load_dwordx4 v3, s[40:43], s3 offen offset:1024 lds
    buffer_load_dwordx4 v4, s[40:43], s3 offen offset:2048 lds
    buffer_load_dwordx4 v5, s[40:43], s3 offen offset:3072 lds
    s_add_u32 m0, s59, 49152
    s_add_u32 s3, s52, 393216
    buffer_load_dwordx4 v6, s[44:47], s3 offen lds
    buffer_load_dwordx4 v7, s[44:47], s3 offen offset:1024 lds
    s_add_u32 m0, s59, 57344
    s_add_u32 s3, s53, 393216
    buffer_load_dwordx4 v6, s[44:47], s3 offen lds
    buffer_load_dwordx4 v7, s[44:47], s3 offen offset:1024 lds
    s_mov_b32 s36, s24
    s_mov_b32 s37, s25
    s_mov_b32 s38, 22020096
    s_mov_b32 s39, 0x00020000
    s_mov_b32 s48, s22
    s_mov_b32 s49, s23
    s_mov_b32 s50, 256
    s_mov_b32 s51, 0x00020000
    v_and_b32 v18, 31, v0
    v_lshrrev_b32 v8, 5, v0
    v_bfe_u32 v19, v0, 1, 3
    v_xor_b32 v8, v8, v19
    v_lshlrev_b32 v8, 4, v8
    v_lshl_add_u32 v8, v18, 7, v8
    s_lshl_b32 s3, s34, 12
    v_add_u32 v8, s3, v8
    v_xor_b32 v9, 32, v8
    v_xor_b32 v10, 64, v8
    v_xor_b32 v11, 96, v8
    v_lshlrev_b32 v1, 4, v0
    v_mov_b32 v16, 0
    s_waitcnt vmcnt(8)
    s_barrier
    ds_read_b128 v[128:131], v8
    ds_read_b128 v[132:135], v9
    ds_read_b128 v[136:139], v10
    ds_read_b128 v[140:143], v11
    v_add_u32 v8, 0x8000, v8
    v_add_u32 v9, 0x8000, v9
    v_add_u32 v10, 0x8000, v10
    v_add_u32 v11, 0x8000, v11
    s_add_u32 m0, s58, 65536
    s_movk_i32 s3, 256
    buffer_load_dwordx4 v2, s[40:43], s3 offen offset:0 lds
    buffer_load_dwordx4 v3, s[40:43], s3 offen offset:1024 lds
    buffer_load_dwordx4 v4, s[40:43], s3 offen offset:2048 lds
    buffer_load_dwordx4 v5, s[40:43], s3 offen offset:3072 lds
    s_add_u32 m0, s59, 81920
    s_add_u32 s3, s52, 786432
    buffer_load_dwordx4 v6, s[44:47], s3 offen lds
    buffer_load_dwordx4 v7, s[44:47], s3 offen offset:1024 lds
    s_add_u32 m0, s59, 90112
    s_add_u32 s3, s53, 786432
    buffer_load_dwordx4 v6, s[44:47], s3 offen lds
    buffer_load_dwordx4 v7, s[44:47], s3 offen offset:1024 lds
    s_add_u32 s62, s62, s63
    s_cmp_eq_u32 s61, 0
    s_cselect_b32 s3, s62, 1073741824
    buffer_load_dword v24, v22, s[96:99], s3 offen
    s_waitcnt vmcnt(9)
    s_waitcnt lgkmcnt(0)
    s_barrier
    ds_read_b128 v[144:147], v8
    ds_read_b128 v[148:151], v9
    ds_read_b128 v[152:155], v10
    ds_read_b128 v[156:159], v11
    v_add_u32 v8, 0x8000, v8
    v_add_u32 v9, 0x8000, v9
    v_add_u32 v10, 0x8000, v10
    v_add_u32 v11, 0x8000, v11
    s_add_u32 m0, s58, 98304
    s_movk_i32 s3, 384
    buffer_load_dwordx4 v2, s[40:43], s3 offen offset:0 lds
    buffer_load_dwordx4 v3, s[40:43], s3 offen offset:1024 lds
    buffer_load_dwordx4 v4, s[40:43], s3 offen offset:2048 lds
    buffer_load_dwordx4 v5, s[40:43], s3 offen offset:3072 lds
    s_add_u32 m0, s59, 114688
    s_add_u32 s3, s52, 1179648
    buffer_load_dwordx4 v6, s[44:47], s3 offen lds
    buffer_load_dwordx4 v7, s[44:47], s3 offen offset:1024 lds
    s_add_u32 m0, s59, 122880
    s_add_u32 s3, s53, 1179648
    buffer_load_dwordx4 v6, s[44:47], s3 offen lds
    buffer_load_dwordx4 v7, s[44:47], s3 offen offset:1024 lds
    s_cmp_eq_u32 s61, 1
    s_cselect_b32 s3, s62, 1073741824
    buffer_load_dword v24, v22, s[96:99], s3 offen
    s_waitcnt vmcnt(10)
    s_waitcnt lgkmcnt(0)
    s_barrier
    ds_read_b128 v[160:163], v8
    ds_read_b128 v[164:167], v9
    ds_read_b128 v[168:171], v10
    ds_read_b128 v[172:175], v11
    v_add_u32 v8, 0x8000, v8
    v_add_u32 v9, 0x8000, v9
    v_add_u32 v10, 0x8000, v10
    v_add_u32 v11, 0x8000, v11
    s_add_u32 m0, s58, 131072
    s_movk_i32 s3, 512
    buffer_load_dwordx4 v2, s[40:43], s3 offen offset:0 lds
    buffer_load_dwordx4 v3, s[40:43], s3 offen offset:1024 lds
    buffer_load_dwordx4 v4, s[40:43], s3 offen offset:2048 lds
    buffer_load_dwordx4 v5, s[40:43], s3 offen offset:3072 lds
    s_add_u32 m0, s59, 147456
    s_add_u32 s3, s52, 1572864
    buffer_load_dwordx4 v6, s[44:47], s3 offen lds
    buffer_load_dwordx4 v7, s[44:47], s3 offen offset:1024 lds
    s_add_u32 m0, s59, 155648
    s_add_u32 s3, s53, 1572864
    buffer_load_dwordx4 v6, s[44:47], s3 offen lds
    buffer_load_dwordx4 v7, s[44:47], s3 offen offset:1024 lds
    s_cmp_eq_u32 s61, 2
    s_cselect_b32 s3, s62, 1073741824
    buffer_load_dword v24, v22, s[96:99], s3 offen
    s_waitcnt vmcnt(10)
    s_waitcnt lgkmcnt(0)
    s_barrier
    ds_read_b128 v[176:179], v8
    ds_read_b128 v[180:183], v9
    ds_read_b128 v[184:187], v10
    ds_read_b128 v[188:191], v11
    v_add_u32 v8, 0x8000, v8
    v_add_u32 v9, 0x8000, v9
    v_add_u32 v10, 0x8000, v10
    v_add_u32 v11, 0x8000, v11
    s_add_u32 m0, s58, 0
    s_movk_i32 s3, 640
    buffer_load_dwordx4 v2, s[40:43], s3 offen offset:0 lds
    s_lshr_b32 s54, s26, 2
    s_lshr_b32 s55, s28, 1
    s_lshl_b32 s56, s27, 1
    s_and_b32 s100, s28, 1
    s_add_u32 s56, s56, s100
    s_lshl_b32 s56, s56, 2
    buffer_load_dwordx4 v3, s[40:43], s3 offen offset:1024 lds
    s_add_u32 s56, s56, s34
    s_lshl_b32 s100, s29, 2
    s_add_u32 s100, s100, s34
    s_lshl_b32 s100, s100, 4
    s_add_u32 s100, s100, s30
    s_lshl_b32 s100, s100, 1
    buffer_load_dwordx4 v4, s[40:43], s3 offen offset:2048 lds
    s_add_u32 s100, s100, s54
    s_lshl_b32 s77, s100, 11
    s_add_u32 s77, s77, 8388608
    s_lshl_b32 s78, s100, 3
    s_add_u32 s78, s78, 16883712
    s_lshr_b32 s92, s55, 1
    buffer_load_dwordx4 v5, s[40:43], s3 offen offset:3072 lds
    s_lshl_b32 s92, s92, 17
    s_and_b32 s100, s55, 1
    s_lshl_b32 s100, s100, 11
    s_add_u32 s92, s92, s100
    s_and_b32 s100, s34, 1
    s_lshl_b32 s100, s100, 8
    s_add_u32 m0, s59, 16384
    s_add_u32 s3, s52, 1966080
    buffer_load_dwordx4 v6, s[44:47], s3 offen lds
    s_add_u32 s92, s92, s100
    s_lshl_b32 s100, s54, 16
    s_add_u32 s92, s92, s100
    s_and_b32 s79, s56, 31
    s_lshl_b32 s79, s79, 8
    s_add_u32 s79, s79, 16842752
    buffer_load_dwordx4 v7, s[44:47], s3 offen offset:1024 lds
    s_lshl_b32 s80, s56, 6
    s_lshl_b32 s100, s54, 12
    s_add_u32 s80, s80, s100
    s_add_u32 s80, s80, 16777216
    s_xor_b32 s100, s54, s55
    s_bitcmp0_b32 s100, 0
    s_cselect_b32 s80, s80, 1073741824
    s_add_u32 m0, s59, 24576
    s_add_u32 s3, s53, 1966080
    buffer_load_dwordx4 v6, s[44:47], s3 offen lds
    s_lshl_b32 s81, s56, 13
    s_lshl_b32 s100, s54, 20
    s_add_u32 s81, s81, s100
    s_and_b32 s100, s55, 1
    s_lshl_b32 s100, s100, 19
    s_add_u32 s81, s81, s100
    buffer_load_dwordx4 v7, s[44:47], s3 offen offset:1024 lds
    s_add_u32 s81, s81, 12582912
    s_lshl_b32 s100, s54, 4
    s_add_u32 s100, s100, s55
    s_lshl_b32 s100, s100, 6
    s_add_u32 s100, s100, s56
    s_lshl_b32 s82, s100, 10
    s_cmp_eq_u32 s61, 3
    s_cselect_b32 s3, s62, 1073741824
    buffer_load_dword v24, v22, s[96:99], s3 offen
    s_add_u32 s82, s82, 14680064
    s_lshl_b32 s83, s100, 3
    s_add_u32 s83, s83, 16867328
    s_lshl_b32 s84, s56, 5
    s_add_u32 s84, s84, 16793600
    s_or_b32 s100, s55, s54
    s_cmp_eq_u32 s100, 0
    s_cselect_b32 s84, s84, 1073741824
    s_waitcnt vmcnt(10)
    s_waitcnt lgkmcnt(0)
    s_barrier
    ds_read_b128 v[192:195], v8
    ds_read_b128 v[196:199], v9
    ds_read_b128 v[200:203], v10
    ds_read_b128 v[204:207], v11
    v_add_u32 v8, 0xfffe0000, v8
    v_add_u32 v9, 0xfffe0000, v9
    v_add_u32 v10, 0xfffe0000, v10
    v_add_u32 v11, 0xfffe0000, v11
    s_add_u32 m0, s58, 32768
    s_movk_i32 s3, 768
    buffer_load_dwordx4 v2, s[40:43], s3 offen offset:0 lds
    s_andn2_b32 s57, s27, 1
    s_lshl_b32 s57, s57, 1
    s_and_b32 s100, s28, 3
    s_add_u32 s57, s57, s100
    s_lshl_b32 s57, s57, 1
    s_and_b32 s100, s27, 1
    buffer_load_dwordx4 v3, s[40:43], s3 offen offset:1024 lds
    s_add_u32 s57, s57, s100
    s_bfe_u32 s55, s26, 0x10001
    s_and_b32 s56, s26, 1
    s_lshr_b32 s93, s57, 1
    s_lshl_b32 s93, s93, 18
    s_and_b32 s100, s57, 1
    buffer_load_dwordx4 v4, s[40:43], s3 offen offset:2048 lds
    s_lshl_b32 s100, s100, 12
    s_add_u32 s93, s93, s100
    s_lshl_b32 s100, s55, 17
    s_add_u32 s93, s93, s100
    s_lshl_b32 s100, s56, 9
    s_add_u32 s93, s93, s100
    buffer_load_dwordx4 v5, s[40:43], s3 offen offset:3072 lds
    s_lshr_b32 s101, s28, 2
    s_lshl_b32 s101, s101, 1
    s_add_u32 s101, s101, s55
    s_lshl_b32 s100, s54, 4
    s_add_u32 s100, s100, s101
    s_lshl_b32 s100, s100, 1
    s_add_u32 m0, s59, 49152
    s_add_u32 s3, s52, 2359296
    buffer_load_dwordx4 v6, s[44:47], s3 offen lds
    s_and_b32 s101, s57, 1
    s_add_u32 s100, s100, s101
    s_lshl_b32 s100, s100, 1
    s_add_u32 s100, s100, s56
    s_lshl_b32 s85, s100, 14
    s_add_u32 s85, s85, 14680064
    buffer_load_dwordx4 v7, s[44:47], s3 offen offset:1024 lds
    s_lshl_b32 s86, s100, 7
    s_add_u32 s86, s86, 16867328
    s_lshr_b32 s94, s28, 2
    s_lshl_b32 s94, s94, 6
    s_lshl_b32 s101, s101, 9
    s_add_u32 s94, s94, s101
    s_add_u32 m0, s59, 57344
    s_add_u32 s3, s53, 2359296
    buffer_load_dwordx4 v6, s[44:47], s3 offen lds
    s_lshl_b32 s94, s94, 2
    s_lshl_b32 s95, s30, 1
    s_add_u32 s95, s95, s54
    s_lshl_b32 s95, s95, 8
    s_add_u32 s95, s95, 16850944
    v_lshrrev_b32 v32, 4, v0
    buffer_load_dwordx4 v7, s[44:47], s3 offen offset:1024 lds
    v_and_b32 v33, 15, v0
    v_xor_b32 v34, v33, v32
    v_lshlrev_b32 v34, 4, v34
    v_lshl_add_u32 v112, v33, 8, v34
    v_lshl_add_u32 v108, v32, 12, v34
    v_lshl_add_u32 v118, v32, 13, v34
    s_add_u32 s62, s62, s63
    s_cmp_eq_u32 s61, 0
    s_cselect_b32 s3, s62, 1073741824
    buffer_load_dword v24, v22, s[96:99], s3 offen
    v_lshlrev_b32 v124, 3, v33
    v_xor_b32 v109, 64, v108
    v_add_u32 v109, 15360, v109
    v_xor_b32 v119, 64, v118
    v_add_u32 v119, 31744, v119
    v_xor_b32 v110, 128, v108
    v_add_u32 v110, 30720, v110
    v_xor_b32 v120, 128, v118
    s_waitcnt vmcnt(10)
    s_waitcnt lgkmcnt(0)
    s_barrier
    ds_read_b128 v[208:211], v8
    ds_read_b128 v[212:215], v9
    ds_read_b128 v[216:219], v10
    ds_read_b128 v[220:223], v11
    v_add_u32 v8, 0x8000, v8
    v_add_u32 v9, 0x8000, v9
    v_add_u32 v10, 0x8000, v10
    v_add_u32 v11, 0x8000, v11
    s_add_u32 m0, s58, 65536
    s_movk_i32 s3, 896
    buffer_load_dwordx4 v2, s[40:43], s3 offen offset:0 lds
    v_add_u32 v120, 63488, v120
    v_xor_b32 v111, 192, v108
    v_add_u32 v111, 46080, v111
    v_xor_b32 v121, 192, v118
    v_add_u32 v121, 95232, v121
    s_lshl_b32 s100, s54, 14
    buffer_load_dwordx4 v3, s[40:43], s3 offen offset:1024 lds
    s_add_u32 s100, s100, 98304
    v_add_u32 v112, s100, v112
    v_xor_b32 v113, 64, v112
    v_xor_b32 v114, 128, v112
    v_xor_b32 v115, 192, v112
    v_and_b32 v32, 31, v0
    buffer_load_dwordx4 v4, s[40:43], s3 offen offset:2048 lds
    v_lshlrev_b32 v123, 3, v32
    v_lshlrev_b32 v125, 2, v32
    v_lshlrev_b32 v127, 3, v0
    v_add_u32 v127, 16867328, v127
    v_mov_b32 v122, 0
    s_lshl_b32 s100, s29, 1
    buffer_load_dwordx4 v5, s[40:43], s3 offen offset:3072 lds
    v_xor_b32 v32, s100, v0
    v_and_b32 v32, 31, v32
    v_lshrrev_b32 v33, 5, v0
    v_lshlrev_b32 v33, 13, v33
    v_lshl_add_u32 v32, v32, 3, v33
    v_add_u32 v104, s95, v32
    s_add_u32 m0, s59, 81920
    s_add_u32 s3, s52, 2752512
    buffer_load_dwordx4 v6, s[44:47], s3 offen lds
    buffer_load_dwordx4 v7, s[44:47], s3 offen offset:1024 lds
    s_add_u32 m0, s59, 90112
    s_add_u32 s3, s53, 2752512
    buffer_load_dwordx4 v6, s[44:47], s3 offen lds
    buffer_load_dwordx4 v7, s[44:47], s3 offen offset:1024 lds
    s_cmp_eq_u32 s61, 1
    s_cselect_b32 s3, s62, 1073741824
    buffer_load_dword v24, v22, s[96:99], s3 offen
    s_waitcnt vmcnt(10)
    s_waitcnt lgkmcnt(0)
    s_barrier
    ds_read_b128 v[224:227], v8
    ds_read_b128 v[228:231], v9
    ds_read_b128 v[232:235], v10
    ds_read_b128 v[236:239], v11
    v_add_u32 v8, 0x8000, v8
    v_add_u32 v9, 0x8000, v9
    v_add_u32 v10, 0x8000, v10
    v_add_u32 v11, 0x8000, v11
    s_add_u32 m0, s58, 98304
    s_movk_i32 s3, 1024
    buffer_load_dwordx4 v2, s[40:43], s3 offen offset:0 lds
    buffer_load_dwordx4 v3, s[40:43], s3 offen offset:1024 lds
    buffer_load_dwordx4 v4, s[40:43], s3 offen offset:2048 lds
    buffer_load_dwordx4 v5, s[40:43], s3 offen offset:3072 lds
    s_add_u32 m0, s59, 114688
    s_add_u32 s3, s52, 3145728
    buffer_load_dwordx4 v6, s[44:47], s3 offen lds
    buffer_load_dwordx4 v7, s[44:47], s3 offen offset:1024 lds
    s_add_u32 m0, s59, 122880
    s_add_u32 s3, s53, 3145728
    buffer_load_dwordx4 v6, s[44:47], s3 offen lds
    buffer_load_dwordx4 v7, s[44:47], s3 offen offset:1024 lds
    s_cmp_eq_u32 s61, 2
    s_cselect_b32 s3, s62, 1073741824
    buffer_load_dword v24, v22, s[96:99], s3 offen
    s_waitcnt vmcnt(10)
    s_waitcnt lgkmcnt(0)
    s_barrier
    ds_read_b128 v[240:243], v8
    ds_read_b128 v[244:247], v9
    ds_read_b128 v[248:251], v10
    ds_read_b128 v[252:255], v11
    v_add_u32 v8, 0x8000, v8
    v_add_u32 v9, 0x8000, v9
    v_add_u32 v10, 0x8000, v10
    v_add_u32 v11, 0x8000, v11
    s_add_u32 m0, s58, 131072
    s_movk_i32 s3, 1152
    buffer_load_dwordx4 v2, s[40:43], s3 offen offset:0 lds
    buffer_load_dwordx4 v3, s[40:43], s3 offen offset:1024 lds
    buffer_load_dwordx4 v4, s[40:43], s3 offen offset:2048 lds
    buffer_load_dwordx4 v5, s[40:43], s3 offen offset:3072 lds
    s_add_u32 m0, s59, 147456
    s_add_u32 s3, s52, 3538944
    buffer_load_dwordx4 v6, s[44:47], s3 offen lds
    buffer_load_dwordx4 v7, s[44:47], s3 offen offset:1024 lds
    s_add_u32 m0, s59, 155648
    s_add_u32 s3, s53, 3538944
    buffer_load_dwordx4 v6, s[44:47], s3 offen lds
    buffer_load_dwordx4 v7, s[44:47], s3 offen offset:1024 lds
    s_cmp_eq_u32 s61, 3
    s_cselect_b32 s3, s62, 1073741824
    buffer_load_dword v24, v22, s[96:99], s3 offen
    s_waitcnt vmcnt(10)
    s_waitcnt lgkmcnt(0)
    s_barrier
    s_add_u32 m0, s58, 0
    s_movk_i32 s3, 1280
    buffer_load_dwordx4 v2, s[40:43], s3 offen offset:0 lds
    buffer_load_dwordx4 v3, s[40:43], s3 offen offset:1024 lds
    buffer_load_dwordx4 v4, s[40:43], s3 offen offset:2048 lds
    buffer_load_dwordx4 v5, s[40:43], s3 offen offset:3072 lds
    s_add_u32 m0, s59, 16384
    s_add_u32 s3, s52, 3932160
    buffer_load_dwordx4 v6, s[44:47], s3 offen lds
    buffer_load_dwordx4 v7, s[44:47], s3 offen offset:1024 lds
    s_add_u32 m0, s59, 24576
    s_add_u32 s3, s53, 3932160
    buffer_load_dwordx4 v6, s[44:47], s3 offen lds
    buffer_load_dwordx4 v7, s[44:47], s3 offen offset:1024 lds
    s_add_u32 s62, s62, s63
    s_cmp_eq_u32 s61, 0
    s_cselect_b32 s3, s62, 1073741824
    buffer_load_dword v24, v22, s[96:99], s3 offen
    s_waitcnt vmcnt(10)
    s_barrier
    buffer_load_dwordx2 v[12:13], v16, s[48:51], 0 offen sc1
    s_add_u32 m0, s58, 32768
    s_movk_i32 s3, 1408
    buffer_load_dwordx4 v2, s[40:43], s3 offen offset:0 lds
    buffer_load_dwordx4 v3, s[40:43], s3 offen offset:1024 lds
    buffer_load_dwordx4 v4, s[40:43], s3 offen offset:2048 lds
    buffer_load_dwordx4 v5, s[40:43], s3 offen offset:3072 lds
    s_add_u32 m0, s59, 49152
    s_add_u32 s3, s52, 4325376
    buffer_load_dwordx4 v6, s[44:47], s3 offen lds
    buffer_load_dwordx4 v7, s[44:47], s3 offen offset:1024 lds
    s_add_u32 m0, s59, 57344
    s_add_u32 s3, s53, 4325376
    buffer_load_dwordx4 v6, s[44:47], s3 offen lds
    buffer_load_dwordx4 v7, s[44:47], s3 offen offset:1024 lds
    s_cmp_eq_u32 s61, 1
    s_cselect_b32 s3, s62, 1073741824
    buffer_load_dword v24, v22, s[96:99], s3 offen
    s_waitcnt vmcnt(11)
    s_barrier
    s_add_u32 m0, s58, 65536
    s_movk_i32 s3, 1536
    buffer_load_dwordx4 v2, s[40:43], s3 offen offset:0 lds
    buffer_load_dwordx4 v3, s[40:43], s3 offen offset:1024 lds
    buffer_load_dwordx4 v4, s[40:43], s3 offen offset:2048 lds
    buffer_load_dwordx4 v5, s[40:43], s3 offen offset:3072 lds
    s_add_u32 m0, s59, 81920
    s_add_u32 s3, s52, 4718592
    buffer_load_dwordx4 v6, s[44:47], s3 offen lds
    buffer_load_dwordx4 v7, s[44:47], s3 offen offset:1024 lds
    s_add_u32 m0, s59, 90112
    s_add_u32 s3, s53, 4718592
    buffer_load_dwordx4 v6, s[44:47], s3 offen lds
    buffer_load_dwordx4 v7, s[44:47], s3 offen offset:1024 lds
    s_cmp_eq_u32 s61, 2
    s_cselect_b32 s3, s62, 1073741824
    buffer_load_dword v24, v22, s[96:99], s3 offen
    s_waitcnt vmcnt(10)
    s_barrier
    s_add_u32 m0, s58, 98304
    s_movk_i32 s3, 1664
    buffer_load_dwordx4 v2, s[40:43], s3 offen offset:0 lds
    buffer_load_dwordx4 v3, s[40:43], s3 offen offset:1024 lds
    buffer_load_dwordx4 v4, s[40:43], s3 offen offset:2048 lds
    buffer_load_dwordx4 v5, s[40:43], s3 offen offset:3072 lds
    s_add_u32 m0, s59, 114688
    s_add_u32 s3, s52, 5111808
    buffer_load_dwordx4 v6, s[44:47], s3 offen lds
    buffer_load_dwordx4 v7, s[44:47], s3 offen offset:1024 lds
    s_add_u32 m0, s59, 122880
    s_add_u32 s3, s53, 5111808
    buffer_load_dwordx4 v6, s[44:47], s3 offen lds
    buffer_load_dwordx4 v7, s[44:47], s3 offen offset:1024 lds
    s_cmp_eq_u32 s61, 3
    s_cselect_b32 s3, s62, 1073741824
    buffer_load_dword v24, v22, s[96:99], s3 offen
    s_waitcnt vmcnt(10)
    s_barrier
    s_add_u32 m0, s58, 131072
    s_movk_i32 s3, 1792
    buffer_load_dwordx4 v2, s[40:43], s3 offen offset:0 lds
    s_lshl_b32 s65, s54, 18
    s_lshl_b32 s61, s27, 5
    s_add_u32 s61, s61, s28
    s_lshl_b32 s61, s61, 2
    s_add_u32 s61, s61, s34
    s_lshl_b32 s76, s61, 3
    buffer_load_dwordx4 v3, s[40:43], s3 offen offset:1024 lds
    s_add_u32 s76, s76, 16842752
    s_cmp_lt_u32 s26, 4
    s_cselect_b32 s76, 1073741824, s76
    s_lshr_b32 s99, s27, 1
    s_lshl_b32 s99, s99, 5
    s_add_u32 s99, s99, s28
    buffer_load_dwordx4 v4, s[40:43], s3 offen offset:2048 lds
    s_lshl_b32 s99, s99, 2
    s_add_u32 s99, s99, s34
    s_lshl_b32 s99, s99, 1
    s_and_b32 s100, s27, 1
    s_add_u32 s99, s99, s100
    s_lshl_b32 s100, s2, 3
    buffer_load_dwordx4 v5, s[40:43], s3 offen offset:3072 lds
    s_add_u32 s100, s100, s26
    s_cmp_eq_u32 s100, 4
    s_cselect_b32 s99, 0x400, s99
    s_cselect_b32 s100, 0, s26
    s_lshl_b32 s87, s99, 12
    s_cmp_lt_u32 s100, 4
    s_cselect_b32 s99, s99, 0x10000
    s_add_u32 m0, s59, 147456
    s_add_u32 s3, s52, 5505024
    buffer_load_dwordx4 v6, s[44:47], s3 offen lds
    s_and_b32 s88, s99, 1
    s_lshl_b32 s88, s88, 10
    s_add_u32 s88, s88, 16793600
    s_lshl_b32 s89, s99, 31
    s_lshr_b32 s89, s89, 1
    s_add_u32 s89, s89, 16787456
    buffer_load_dwordx4 v7, s[44:47], s3 offen offset:1024 lds
    s_lshl_b32 s63, s54, 1
    s_add_u32 s63, s63, s56
    s_and_b32 s64, s27, 1
    s_lshl_b32 s64, s64, 3
    s_lshr_b32 s100, s28, 3
    s_lshl_b32 s100, s100, 1
    s_add_u32 m0, s59, 155648
    s_add_u32 s3, s53, 5505024
    buffer_load_dwordx4 v6, s[44:47], s3 offen lds
    s_add_u32 s64, s64, s100
    s_bfe_u32 s100, s27, 0x10001
    s_add_u32 s64, s64, s100
    s_lshl_b32 s64, s64, 2
    s_add_u32 s64, s64, s34
    s_lshr_b32 s62, s27, 2
    buffer_load_dwordx4 v7, s[44:47], s3 offen offset:1024 lds
    s_lshl_b32 s62, s62, 3
    s_and_b32 s100, s28, 7
    s_add_u32 s62, s62, s100
    s_andn2_b32 s90, s28, 7
    s_add_u32 s90, s90, s26
    s_lshl_b32 s90, s90, 16
    s_lshl_b32 s100, s62, 7
    s_add_u32 s90, s90, s100
    s_lshl_b32 s75, s54, 20
    s_add_u32 s75, s75, s100
    s_lshl_b32 s100, s34, 16
    s_add_u32 s75, s75, s100
    s_lshl_b32 s91, s64, 1
    s_add_u32 s91, s91, s54
    s_waitcnt vmcnt(9)
    s_barrier
    s_add_u32 m0, s58, 0
    s_movk_i32 s3, 1920
    buffer_load_dwordx4 v2, s[40:43], s3 offen offset:0 lds
    s_lshl_b32 s91, s91, 7
    s_add_u32 s91, s91, 16883712
    s_lshl_b32 s98, s34, 12
    buffer_load_dwordx4 v3, s[40:43], s3 offen offset:1024 lds
    buffer_load_dwordx4 v4, s[40:43], s3 offen offset:2048 lds
    buffer_load_dwordx4 v5, s[40:43], s3 offen offset:3072 lds
    s_add_u32 m0, s59, 16384
    s_add_u32 s3, s52, 5898240
    buffer_load_dwordx4 v6, s[44:47], s3 offen lds
    buffer_load_dwordx4 v7, s[44:47], s3 offen offset:1024 lds
    s_add_u32 m0, s59, 24576
    s_add_u32 s3, s53, 5898240
    buffer_load_dwordx4 v6, s[44:47], s3 offen lds
    buffer_load_dwordx4 v7, s[44:47], s3 offen offset:1024 lds
SP3:
    v_readfirstlane_b32 s32, v12
    v_readfirstlane_b32 s33, v13
    s_cmp_lg_u32 s32, 0
    s_cbranch_scc1 SQ4
    s_sub_u32 s35, s35, 1
    s_cbranch_scc1 SQ4_t
    s_sleep 2
    buffer_load_dwordx2 v[12:13], v16, s[48:51], 0 offen sc1
    s_waitcnt vmcnt(0)
    s_branch SP3
SQ4_t:
    s_mov_b32 s35, 0
SQ4:
    s_waitcnt vmcnt(8)
    s_barrier
    s_add_u32 m0, s59, 32768
    s_add_u32 s3, s60, 0
    buffer_load_dwordx4 v6, s[44:47], s3 offen lds
    v_mov_b32 v116, s32
    v_mov_b32 v117, s33
    s_lshr_b32 s97, s61, 4
    s_lshl_b32 s97, s97, 1
    s_and_b32 s100, s61, 1
    s_add_u32 s100, s97, s100
    buffer_load_dwordx4 v7, s[44:47], s3 offen offset:1024 lds
    s_bfe_u32 s101, s61, 0x30001
    s_lshl_b32 s97, s100, 13
    v_bfe_u32 v93, v0, 2, 2
    v_lshrrev_b32 v92, 5, v0
    v_lshl_add_u32 v100, v92, 10, v93
    v_lshlrev_b32 v100, 11, v100
    s_add_u32 m0, s59, 40960
    s_add_u32 s3, s60, 393216
    buffer_load_dwordx4 v6, s[44:47], s3 offen lds
    v_add_u32 v100, s97, v100
    v_sub_u32 v92, 4194304, v100
    v_mov_b32 v102, 1073741824
    v_cmp_eq_u32 vcc, v100, v92
    s_nop 1
    v_cndmask_b32 v92, v92, v102, vcc
    s_lshl_b32 s97, s101, 6
    buffer_load_dwordx4 v7, s[44:47], s3 offen offset:1024 lds
    v_and_b32 v91, 3, v0
    v_lshl_add_u32 v91, v91, 4, s97
    v_and_b32 v101, 16, v0
    v_lshl_add_u32 v101, v101, 6, v91
    v_add_u32 v84, v100, v101
    v_add_u32 v85, v92, v101
    s_add_u32 m0, s59, 49152
    s_add_u32 s3, s60, 3145728
    buffer_load_dwordx4 v6, s[44:47], s3 offen lds
    s_mov_b32 s48, s4
    s_mov_b32 s49, s5
    s_mov_b32 s50, 4194304
    s_mov_b32 s51, 0x00020000
    v_sub_u32 v101, 2032, v101
    v_add_u32 v86, v100, v101
    buffer_load_dwordx4 v7, s[44:47], s3 offen offset:1024 lds
    v_add_u32 v87, v92, v101
    v_and_b32 v90, 48, v0
    v_lshl_add_u32 v90, v90, 5, v93
    v_lshlrev_b32 v90, 2, v90
    v_cmp_eq_u32 vcc, 0x1f0, v91
    s_nop 1
    v_cndmask_b32 v90, v102, v90, vcc
    s_add_u32 m0, s59, 57344
    s_add_u32 s3, s60, 3538944
    buffer_load_dwordx4 v6, s[44:47], s3 offen lds
    s_cmp_lg_u32 s101, 0
    s_cselect_b32 vcc_lo, 0x11111111, 0
    s_mov_b32 vcc_hi, vcc_lo
    v_add_u32 v101, 16, v101
    v_cndmask_b32 v101, v102, v101, vcc
    v_add_u32 v88, v100, v101
    buffer_load_dwordx4 v7, s[44:47], s3 offen offset:1024 lds
    v_add_u32 v89, v92, v101
    v_lshrrev_b32 v92, 5, v0
    v_bfe_u32 v91, v0, 4, 1
    v_lshl_add_u32 v92, v92, 2, v91
    v_and_b32 v91, 3, v0
    v_lshl_add_u32 v92, v92, 10, v93
    v_lshl_add_u32 v92, v92, 4, v91
    v_lshlrev_b32 v92, 4, v92
    v_lshl_add_u32 v91, v91, 2, v93
    v_and_or_b32 v91, v0, 48, v91
    v_lshlrev_b32 v91, 2, v91
    s_lshl_b32 s42, s30, 19
    s_add_u32 s40, s24, s42
    s_addc_u32 s41, s25, 0
    s_waitcnt vmcnt(8)
    s_barrier
    s_add_u32 m0, s59, 65536
    s_add_u32 s3, s60, 786432
    buffer_load_dwordx4 v6, s[44:47], s3 offen lds
    s_mov_b32 s42, 524288
    s_mov_b32 s43, 0x00020000
    v_add_u32 v4, s65, v1
    s_lshl_b32 s52, s34, 1
    s_add_u32 s52, s52, s54
    s_lshl_b32 s52, s52, 12
    buffer_load_dwordx4 v7, s[44:47], s3 offen offset:1024 lds
    s_lshl_b32 s31, s31, 14
    s_or_b32 s74, s98, s31
    v_lshrrev_b32 v2, 5, v0
    v_bfe_u32 v11, v0, 2, 2
    v_lshl_add_u32 v2, v2, 3, v11
    v_lshlrev_b32 v2, 7, v2
    s_add_u32 m0, s59, 73728
    s_add_u32 s3, s60, 1179648
    buffer_load_dwordx4 v6, s[44:47], s3 offen lds
    v_bfe_u32 v11, v0, 3, 1
    v_xor_b32 v11, 1, v11
    v_lshl_add_u32 v2, v11, 6, v2
    v_bfe_u32 v11, v0, 4, 1
    v_lshl_add_u32 v2, v11, 5, v2
    v_and_b32 v11, 3, v0
    buffer_load_dwordx4 v7, s[44:47], s3 offen offset:1024 lds
    v_lshl_add_u32 v2, v11, 3, v2
    v_add_u32 v2, 32768, v2
    v_xor_b32 v3, 64, v2
    s_add_u32 m0, s59, 81920
    s_add_u32 s3, s60, 3932160
    buffer_load_dwordx4 v6, s[44:47], s3 offen lds
    buffer_load_dwordx4 v7, s[44:47], s3 offen offset:1024 lds
    s_add_u32 m0, s59, 90112
    s_add_u32 s3, s60, 4325376
    buffer_load_dwordx4 v6, s[44:47], s3 offen lds
    buffer_load_dwordx4 v7, s[44:47], s3 offen offset:1024 lds
    s_waitcnt vmcnt(8)
    s_barrier
    s_add_u32 m0, s59, 98304
    s_add_u32 s3, s60, 1572864
    buffer_load_dwordx4 v6, s[44:47], s3 offen lds
    buffer_load_dwordx4 v7, s[44:47], s3 offen offset:1024 lds
    s_add_u32 m0, s59, 106496
    s_add_u32 s3, s60, 1966080
    buffer_load_dwordx4 v6, s[44:47], s3 offen lds
    buffer_load_dwordx4 v7, s[44:47], s3 offen offset:1024 lds
    s_add_u32 m0, s59, 114688
    s_add_u32 s3, s60, 4718592
    buffer_load_dwordx4 v6, s[44:47], s3 offen lds
    buffer_load_dwordx4 v7, s[44:47], s3 offen offset:1024 lds
    s_add_u32 m0, s59, 122880
    s_add_u32 s3, s60, 5111808
    buffer_load_dwordx4 v6, s[44:47], s3 offen lds
    buffer_load_dwordx4 v7, s[44:47], s3 offen offset:1024 lds
    s_add_u32 m0, s59, 131072
    s_add_u32 s3, s60, 2359296
    buffer_load_dwordx4 v6, s[44:47], s3 offen lds
    buffer_load_dwordx4 v7, s[44:47], s3 offen offset:1024 lds
    s_add_u32 m0, s59, 139264
    s_add_u32 s3, s60, 2752512
    buffer_load_dwordx4 v6, s[44:47], s3 offen lds
    buffer_load_dwordx4 v7, s[44:47], s3 offen offset:1024 lds
    s_add_u32 m0, s59, 147456
    s_add_u32 s3, s60, 5505024
    buffer_load_dwordx4 v6, s[44:47], s3 offen lds
    buffer_load_dwordx4 v7, s[44:47], s3 offen offset:1024 lds
    s_add_u32 m0, s59, 155648
    s_add_u32 s3, s60, 5898240
    buffer_load_dwordx4 v6, s[44:47], s3 offen lds
    buffer_load_dwordx4 v7, s[44:47], s3 offen offset:1024 lds
    ds_read_b64_tr_b16 v[8:9], v2 offset:0
    ds_read_b64_tr_b16 v[10:11], v2 offset:512
    ds_read_b64_tr_b16 v[12:13], v3 offset:0
    ds_read_b64_tr_b16 v[14:15], v3 offset:512
    ds_read_b64_tr_b16 v[16:17], v2 offset:2048
    ds_read_b64_tr_b16 v[18:19], v2 offset:2560
    ds_read_b64_tr_b16 v[20:21], v3 offset:2048
    ds_read_b64_tr_b16 v[22:23], v3 offset:2560
    s_waitcnt lgkmcnt(6)
    v_mfma_f32_32x32x16_bf16 v[32:47], v[8:11], v[128:131], 0
    ds_read_b64_tr_b16 v[24:25], v2 offset:4096
    ds_read_b64_tr_b16 v[26:27], v2 offset:4608
    s_waitcnt lgkmcnt(6)
    v_mfma_f32_32x32x16_bf16 v[48:63], v[12:15], v[128:131], 0
    ds_read_b64_tr_b16 v[28:29], v3 offset:4096
    ds_read_b64_tr_b16 v[30:31], v3 offset:4608
    buffer_load_dwordx4 v[64:67], v84, s[48:51], 0 offen
    buffer_load_dwordx4 v[68:71], v85, s[48:51], 0 offen
    buffer_load_dwordx4 v[72:75], v86, s[48:51], 0 offen
    buffer_load_dwordx4 v[76:79], v87, s[48:51], 0 offen
    buffer_load_ushort v80, v88, s[48:51], 0 offen
    buffer_load_ushort v81, v89, s[48:51], 0 offen
    s_cmp_lt_u32 s34, 2
    s_cselect_b32 s44, s10, s12
    s_cselect_b32 s45, s11, s13
    s_mov_b32 s46, 2097152
    s_mov_b32 s47, 0x00020000
    s_lshr_b32 s58, s28, 2
    s_lshl_b32 s58, s58, 1
    s_add_u32 s58, s58, s55
    s_lshl_b32 s59, s63, 1
    s_add_u32 s59, s59, s55
    s_lshl_b32 s59, s59, 12
    s_lshl_b32 s60, s64, 1
    s_add_u32 s60, s60, s54
    s_lshl_b32 s60, s60, 15
    s_add_u32 s60, s60, 8388608
    s_waitcnt lgkmcnt(6)
    v_mfma_f32_32x32x16_bf16 v[32:47], v[16:19], v[132:135], v[32:47]
    ds_read_b64_tr_b16 v[8:9], v2 offset:6144
    ds_read_b64_tr_b16 v[10:11], v2 offset:6656
    s_waitcnt lgkmcnt(6)
    v_mfma_f32_32x32x16_bf16 v[48:63], v[20:23], v[132:135], v[48:63]
    ds_read_b64_tr_b16 v[12:13], v3 offset:6144
    ds_read_b64_tr_b16 v[14:15], v3 offset:6656
    s_waitcnt lgkmcnt(6)
    v_mfma_f32_32x32x16_bf16 v[32:47], v[24:27], v[136:139], v[32:47]
    ds_read_b64_tr_b16 v[16:17], v2 offset:8192
    ds_read_b64_tr_b16 v[18:19], v2 offset:8704
    s_waitcnt lgkmcnt(6)
    v_mfma_f32_32x32x16_bf16 v[48:63], v[28:31], v[136:139], v[48:63]
    ds_read_b64_tr_b16 v[20:21], v3 offset:8192
    ds_read_b64_tr_b16 v[22:23], v3 offset:8704
    s_waitcnt lgkmcnt(6)
    v_mfma_f32_32x32x16_bf16 v[32:47], v[8:11], v[140:143], v[32:47]
    ds_read_b64_tr_b16 v[24:25], v2 offset:10240
    ds_read_b64_tr_b16 v[26:27], v2 offset:10752
    s_waitcnt lgkmcnt(6)
    v_mfma_f32_32x32x16_bf16 v[48:63], v[12:15], v[140:143], v[48:63]
    ds_read_b64_tr_b16 v[28:29], v3 offset:10240
    ds_read_b64_tr_b16 v[30:31], v3 offset:10752
    s_waitcnt lgkmcnt(6)
    v_mfma_f32_32x32x16_bf16 v[32:47], v[16:19], v[144:147], v[32:47]
    ds_read_b64_tr_b16 v[8:9], v2 offset:12288
    ds_read_b64_tr_b16 v[10:11], v2 offset:12800
    s_waitcnt lgkmcnt(6)
    v_mfma_f32_32x32x16_bf16 v[48:63], v[20:23], v[144:147], v[48:63]
    ds_read_b64_tr_b16 v[12:13], v3 offset:12288
    ds_read_b64_tr_b16 v[14:15], v3 offset:12800
    s_waitcnt lgkmcnt(6)
    v_mfma_f32_32x32x16_bf16 v[32:47], v[24:27], v[148:151], v[32:47]
    ds_read_b64_tr_b16 v[16:17], v2 offset:14336
    ds_read_b64_tr_b16 v[18:19], v2 offset:14848
    s_waitcnt lgkmcnt(6)
    v_mfma_f32_32x32x16_bf16 v[48:63], v[28:31], v[148:151], v[48:63]
    ds_read_b64_tr_b16 v[20:21], v3 offset:14336
    ds_read_b64_tr_b16 v[22:23], v3 offset:14848
    s_waitcnt vmcnt(22)
    s_barrier
    v_add_u32 v2, 0x8000, v2
    v_add_u32 v3, 0x8000, v3
    s_waitcnt lgkmcnt(6)
    v_mfma_f32_32x32x16_bf16 v[32:47], v[8:11], v[152:155], v[32:47]
    ds_read_b64_tr_b16 v[24:25], v2 offset:0
    ds_read_b64_tr_b16 v[26:27], v2 offset:512
    s_waitcnt lgkmcnt(6)
    v_mfma_f32_32x32x16_bf16 v[48:63], v[12:15], v[152:155], v[48:63]
    ds_read_b64_tr_b16 v[28:29], v3 offset:0
    ds_read_b64_tr_b16 v[30:31], v3 offset:512
    s_waitcnt lgkmcnt(6)
    v_mfma_f32_32x32x16_bf16 v[32:47], v[16:19], v[156:159], v[32:47]
    ds_read_b64_tr_b16 v[8:9], v2 offset:2048
    ds_read_b64_tr_b16 v[10:11], v2 offset:2560
    s_waitcnt lgkmcnt(6)
    v_mfma_f32_32x32x16_bf16 v[48:63], v[20:23], v[156:159], v[48:63]
    ds_read_b64_tr_b16 v[12:13], v3 offset:2048
    ds_read_b64_tr_b16 v[14:15], v3 offset:2560
    s_waitcnt lgkmcnt(6)
    v_mfma_f32_32x32x16_bf16 v[32:47], v[24:27], v[160:163], v[32:47]
    ds_read_b64_tr_b16 v[16:17], v2 offset:4096
    ds_read_b64_tr_b16 v[18:19], v2 offset:4608
    s_lshl_b32 s96, s63, 3
    v_xor_b32 v6, s96, v0
    v_lshrrev_b32 v7, 5, v6
    v_and_b32 v5, 15, v6
    s_waitcnt lgkmcnt(6)
    v_mfma_f32_32x32x16_bf16 v[48:63], v[28:31], v[160:163], v[48:63]
    ds_read_b64_tr_b16 v[20:21], v3 offset:4096
    ds_read_b64_tr_b16 v[22:23], v3 offset:4608
    v_xor_b32 v7, v7, v5
    v_lshlrev_b32 v7, 4, v7
    v_and_b32 v6, 31, v6
    v_lshl_add_u32 v156, v6, 8, v7
    s_waitcnt lgkmcnt(6)
    v_mfma_f32_32x32x16_bf16 v[32:47], v[8:11], v[164:167], v[32:47]
    ds_read_b64_tr_b16 v[24:25], v2 offset:6144
    ds_read_b64_tr_b16 v[26:27], v2 offset:6656
    s_lshl_b32 s96, s63, 13
    s_add_u32 s96, s96, 98304
    v_add_u32 v156, s96, v156
    v_xor_b32 v157, 32, v156
    s_waitcnt lgkmcnt(6)
    v_mfma_f32_32x32x16_bf16 v[48:63], v[12:15], v[164:167], v[48:63]
    ds_read_b64_tr_b16 v[28:29], v3 offset:6144
    ds_read_b64_tr_b16 v[30:31], v3 offset:6656
    v_xor_b32 v158, 64, v156
    v_xor_b32 v159, 96, v156
    v_xor_b32 v160, 128, v156
    v_xor_b32 v161, 160, v156
    s_waitcnt lgkmcnt(6)
    v_mfma_f32_32x32x16_bf16 v[32:47], v[16:19], v[168:171], v[32:47]
    ds_read_b64_tr_b16 v[8:9], v2 offset:8192
    ds_read_b64_tr_b16 v[10:11], v2 offset:8704
    v_xor_b32 v162, 192, v156
    v_xor_b32 v163, 224, v156
    s_waitcnt lgkmcnt(6)
    v_mfma_f32_32x32x16_bf16 v[48:63], v[20:23], v[168:171], v[48:63]
    ds_read_b64_tr_b16 v[12:13], v3 offset:8192
    ds_read_b64_tr_b16 v[14:15], v3 offset:8704
    v_mov_b32 v7, 0xbf803f80
    s_mov_b32 vcc_lo, 0x00020001
    s_mov_b32 vcc_hi, 0x00020001
    v_cndmask_b32 v164, 0, v7, vcc
    v_cndmask_b32 v165, 0, v7, vcc
    v_cndmask_b32 v166, 0, v7, vcc
    v_cndmask_b32 v167, 0, v7, vcc
    s_waitcnt lgkmcnt(6)
    v_mfma_f32_32x32x16_bf16 v[32:47], v[24:27], v[172:175], v[32:47]
    ds_read_b64_tr_b16 v[16:17], v2 offset:10240
    ds_read_b64_tr_b16 v[18:19], v2 offset:10752
    v_lshrrev_b32 v6, 3, v0
    v_and_b32 v7, 7, v0
    v_bfe_u32 v5, v0, 4, 1
    s_waitcnt lgkmcnt(6)
    v_mfma_f32_32x32x16_bf16 v[48:63], v[28:31], v[172:175], v[48:63]
    ds_read_b64_tr_b16 v[20:21], v3 offset:10240
    ds_read_b64_tr_b16 v[22:23], v3 offset:10752
    v_lshlrev_b32 v5, 2, v5
    v_xor_b32 v7, v7, v5
    v_lshlrev_b32 v7, 4, v7
    s_waitcnt lgkmcnt(6)
    v_mfma_f32_32x32x16_bf16 v[32:47], v[8:11], v[176:179], v[32:47]
    ds_read_b64_tr_b16 v[24:25], v2 offset:12288
    ds_read_b64_tr_b16 v[26:27], v2 offset:12800
    s_waitcnt lgkmcnt(6)
    v_mfma_f32_32x32x16_bf16 v[48:63], v[12:15], v[176:179], v[48:63]
    ds_read_b64_tr_b16 v[28:29], v3 offset:12288
    ds_read_b64_tr_b16 v[30:31], v3 offset:12800
    s_waitcnt lgkmcnt(6)
    v_mfma_f32_32x32x16_bf16 v[32:47], v[16:19], v[180:183], v[32:47]
    ds_read_b64_tr_b16 v[8:9], v2 offset:14336
    ds_read_b64_tr_b16 v[10:11], v2 offset:14848
    v_lshl_add_u32 v176, v6, 11, v7
    v_add_u32 v177, 15360, v176
    s_waitcnt lgkmcnt(6)
    v_mfma_f32_32x32x16_bf16 v[48:63], v[20:23], v[180:183], v[48:63]
    ds_read_b64_tr_b16 v[12:13], v3 offset:14336
    ds_read_b64_tr_b16 v[14:15], v3 offset:14848
    v_add_u32 v178, 30720, v176
    v_add_u32 v179, 46080, v176
    s_waitcnt vmcnt(14)
    s_barrier
    v_add_u32 v2, 0x8000, v2
    v_add_u32 v3, 0x8000, v3
    s_waitcnt lgkmcnt(6)
    v_mfma_f32_32x32x16_bf16 v[32:47], v[24:27], v[184:187], v[32:47]
    ds_read_b64_tr_b16 v[16:17], v2 offset:0
    ds_read_b64_tr_b16 v[18:19], v2 offset:512
    v_mov_b32 v180, -1
    v_mov_b32 v181, -1
    s_waitcnt lgkmcnt(6)
    v_mfma_f32_32x32x16_bf16 v[48:63], v[28:31], v[184:187], v[48:63]
    ds_read_b64_tr_b16 v[20:21], v3 offset:0
    ds_read_b64_tr_b16 v[22:23], v3 offset:512
    v_mov_b32 v182, -1
    v_mov_b32 v183, -1
    s_waitcnt lgkmcnt(6)
    v_mfma_f32_32x32x16_bf16 v[32:47], v[8:11], v[188:191], v[32:47]
    ds_read_b64_tr_b16 v[24:25], v2 offset:2048
    ds_read_b64_tr_b16 v[26:27], v2 offset:2560
    v_and_b32 v184, 48, v0
    v_lshrrev_b32 v185, 1, v184
    v_lshrrev_b32 v7, 5, v0
    v_lshl_add_u32 v186, v7, 2, v123
    s_waitcnt lgkmcnt(6)
    v_mfma_f32_32x32x16_bf16 v[48:63], v[12:15], v[188:191], v[48:63]
    ds_read_b64_tr_b16 v[28:29], v3 offset:2048
    ds_read_b64_tr_b16 v[30:31], v3 offset:2560
    v_add_u32 v186, s94, v186
    v_mov_b32 v7, 1073741824
    v_cmp_eq_u32 vcc, 0x800, v186
    s_nop 1
    v_cndmask_b32 v186, v186, v7, vcc
    s_waitcnt lgkmcnt(6)
    v_mfma_f32_32x32x16_bf16 v[32:47], v[16:19], v[192:195], v[32:47]
    ds_read_b64_tr_b16 v[8:9], v2 offset:4096
    ds_read_b64_tr_b16 v[10:11], v2 offset:4608
    v_add_u32 v186, 16785408, v186
    v_lshlrev_b32 v187, 9, v125
    v_cmp_eq_u32 vcc, 63, v0
    s_nop 1
    v_cndmask_b32 v189, v7, 0, vcc
    s_waitcnt lgkmcnt(6)
    v_mfma_f32_32x32x16_bf16 v[48:63], v[20:23], v[192:195], v[48:63]
    ds_read_b64_tr_b16 v[12:13], v3 offset:4096
    ds_read_b64_tr_b16 v[14:15], v3 offset:4608
    s_waitcnt vmcnt(0)
    s_mov_b32 vcc_lo, 0x11111111
    s_mov_b32 vcc_hi, 0x11111111
    v_cndmask_b32_dpp v80, v72, v80, vcc row_shr:1 row_mask:0xf bank_mask:0xf bound_ctrl:0
    v_cndmask_b32_dpp v81, v76, v81, vcc row_shr:1 row_mask:0xf bank_mask:0xf bound_ctrl:0
    v_lshlrev_b32 v102, 16, v72
    v_lshlrev_b32 v103, 16, v76
    v_add_f32 v152, v102, v103
    v_sub_f32 v153, v102, v103
    v_lshlrev_b32 v100, 16, v64
    v_lshlrev_b32 v101, 16, v68
    v_lshlrev_b32 v102, 16, v80
    v_lshlrev_b32 v103, 16, v81
    s_waitcnt lgkmcnt(6)
    v_mfma_f32_32x32x16_bf16 v[32:47], v[24:27], v[196:199], v[32:47]
    ds_read_b64_tr_b16 v[16:17], v2 offset:6144
    ds_read_b64_tr_b16 v[18:19], v2 offset:6656
    v_permlane32_swap_b32 v152, v153
    v_sub_f32 v82, v152, v153
    v_add_f32 v152, v152, v153
    s_waitcnt lgkmcnt(6)
    v_mfma_f32_32x32x16_bf16 v[48:63], v[28:31], v[196:199], v[48:63]
    ds_read_b64_tr_b16 v[20:21], v3 offset:6144
    ds_read_b64_tr_b16 v[22:23], v3 offset:6656
    v_add_f32 v100, v100, v103
    v_add_f32 v101, v101, v102
    v_add_f32 v128, v100, v101
    v_sub_f32 v136, v100, v101
    v_permlane16_swap_b32 v152, v82
    v_sub_f32 v153, v152, v82
    v_add_f32 v152, v152, v82
    s_waitcnt lgkmcnt(6)
    v_mfma_f32_32x32x16_bf16 v[32:47], v[8:11], v[200:203], v[32:47]
    ds_read_b64_tr_b16 v[24:25], v2 offset:8192
    ds_read_b64_tr_b16 v[26:27], v2 offset:8704
    v_and_b32 v100, 0xffff0000, v64
    v_and_b32 v101, 0xffff0000, v68
    v_and_b32 v102, 0xffff0000, v75
    v_and_b32 v103, 0xffff0000, v79
    s_waitcnt lgkmcnt(6)
    v_mfma_f32_32x32x16_bf16 v[48:63], v[12:15], v[200:203], v[48:63]
    ds_read_b64_tr_b16 v[28:29], v3 offset:8192
    ds_read_b64_tr_b16 v[30:31], v3 offset:8704
    v_permlane32_swap_b32 v128, v136
    v_sub_f32 v82, v128, v136
    v_add_f32 v128, v128, v136
    v_add_f32 v100, v100, v103
    v_add_f32 v101, v101, v102
    v_add_f32 v129, v100, v101
    v_sub_f32 v137, v100, v101
    s_waitcnt lgkmcnt(6)
    v_mfma_f32_32x32x16_bf16 v[32:47], v[16:19], v[204:207], v[32:47]
    ds_read_b64_tr_b16 v[8:9], v2 offset:10240
    ds_read_b64_tr_b16 v[10:11], v2 offset:10752
    v_permlane16_swap_b32 v128, v82
    v_sub_f32 v136, v128, v82
    v_add_f32 v128, v128, v82
    s_waitcnt lgkmcnt(6)
    v_mfma_f32_32x32x16_bf16 v[48:63], v[20:23], v[204:207], v[48:63]
    ds_read_b64_tr_b16 v[12:13], v3 offset:10240
    ds_read_b64_tr_b16 v[14:15], v3 offset:10752
    v_lshlrev_b32 v100, 16, v65
    v_lshlrev_b32 v101, 16, v69
    v_lshlrev_b32 v102, 16, v75
    v_lshlrev_b32 v103, 16, v79
    v_permlane32_swap_b32 v129, v137
    v_sub_f32 v83, v129, v137
    v_add_f32 v129, v129, v137
    s_waitcnt lgkmcnt(6)
    v_mfma_f32_32x32x16_bf16 v[32:47], v[24:27], v[208:211], v[32:47]
    ds_read_b64_tr_b16 v[16:17], v2 offset:12288
    ds_read_b64_tr_b16 v[18:19], v2 offset:12800
    v_add_f32 v100, v100, v103
    v_add_f32 v101, v101, v102
    v_add_f32 v130, v100, v101
    v_sub_f32 v138, v100, v101
    s_waitcnt lgkmcnt(6)
    v_mfma_f32_32x32x16_bf16 v[48:63], v[28:31], v[208:211], v[48:63]
    ds_read_b64_tr_b16 v[20:21], v3 offset:12288
    ds_read_b64_tr_b16 v[22:23], v3 offset:12800
    v_permlane16_swap_b32 v129, v83
    v_sub_f32 v137, v129, v83
    v_add_f32 v129, v129, v83
    v_and_b32 v100, 0xffff0000, v65
    v_and_b32 v101, 0xffff0000, v69
    v_and_b32 v102, 0xffff0000, v74
    v_and_b32 v103, 0xffff0000, v78
    s_waitcnt lgkmcnt(6)
    v_mfma_f32_32x32x16_bf16 v[32:47], v[8:11], v[212:215], v[32:47]
    ds_read_b64_tr_b16 v[24:25], v2 offset:14336
    ds_read_b64_tr_b16 v[26:27], v2 offset:14848
    v_permlane32_swap_b32 v130, v138
    v_sub_f32 v82, v130, v138
    v_add_f32 v130, v130, v138
    s_waitcnt lgkmcnt(6)
    v_mfma_f32_32x32x16_bf16 v[48:63], v[12:15], v[212:215], v[48:63]
    ds_read_b64_tr_b16 v[28:29], v3 offset:14336
    ds_read_b64_tr_b16 v[30:31], v3 offset:14848
    v_add_f32 v100, v100, v103
    v_add_f32 v101, v101, v102
    v_add_f32 v131, v100, v101
    v_sub_f32 v139, v100, v101
    v_permlane16_swap_b32 v130, v82
    v_sub_f32 v138, v130, v82
    v_add_f32 v130, v130, v82
    s_barrier
    v_add_u32 v2, 0x8000, v2
    v_add_u32 v3, 0x8000, v3
    s_waitcnt lgkmcnt(6)
    v_mfma_f32_32x32x16_bf16 v[32:47], v[16:19], v[216:219], v[32:47]
    ds_read_b64_tr_b16 v[8:9], v2 offset:0
    ds_read_b64_tr_b16 v[10:11], v2 offset:512
    v_lshlrev_b32 v100, 16, v66
    v_lshlrev_b32 v101, 16, v70
    v_lshlrev_b32 v102, 16, v74
    v_lshlrev_b32 v103, 16, v78
    s_waitcnt lgkmcnt(6)
    v_mfma_f32_32x32x16_bf16 v[48:63], v[20:23], v[216:219], v[48:63]
    ds_read_b64_tr_b16 v[12:13], v3 offset:0
    ds_read_b64_tr_b16 v[14:15], v3 offset:512
    v_permlane32_swap_b32 v131, v139
    v_sub_f32 v83, v131, v139
    v_add_f32 v131, v131, v139
    v_add_f32 v100, v100, v103
    v_add_f32 v101, v101, v102
    v_add_f32 v132, v100, v101
    v_sub_f32 v140, v100, v101
    s_waitcnt lgkmcnt(6)
    v_mfma_f32_32x32x16_bf16 v[32:47], v[24:27], v[220:223], v[32:47]
    ds_read_b64_tr_b16 v[16:17], v2 offset:2048
    ds_read_b64_tr_b16 v[18:19], v2 offset:2560
    v_permlane16_swap_b32 v131, v83
    v_sub_f32 v139, v131, v83
    v_add_f32 v131, v131, v83
    s_waitcnt lgkmcnt(6)
    v_mfma_f32_32x32x16_bf16 v[48:63], v[28:31], v[220:223], v[48:63]
    ds_read_b64_tr_b16 v[20:21], v3 offset:2048
    ds_read_b64_tr_b16 v[22:23], v3 offset:2560
    v_and_b32 v100, 0xffff0000, v66
    v_and_b32 v101, 0xffff0000, v70
    v_and_b32 v102, 0xffff0000, v73
    v_and_b32 v103, 0xffff0000, v77
    v_permlane32_swap_b32 v132, v140
    v_sub_f32 v82, v132, v140
    v_add_f32 v132, v132, v140
    s_waitcnt lgkmcnt(6)
    v_mfma_f32_32x32x16_bf16 v[32:47], v[8:11], v[224:227], v[32:47]
    ds_read_b64_tr_b16 v[24:25], v2 offset:4096
    ds_read_b64_tr_b16 v[26:27], v2 offset:4608
    v_add_f32 v100, v100, v103
    v_add_f32 v101, v101, v102
    v_add_f32 v133, v100, v101
    v_sub_f32 v141, v100, v101
    v_permlane16_swap_b32 v132, v82
    v_sub_f32 v140, v132, v82
    v_add_f32 v132, v132, v82
    s_waitcnt lgkmcnt(6)
    v_mfma_f32_32x32x16_bf16 v[48:63], v[12:15], v[224:227], v[48:63]
    ds_read_b64_tr_b16 v[28:29], v3 offset:4096
    ds_read_b64_tr_b16 v[30:31], v3 offset:4608
    v_lshlrev_b32 v100, 16, v67
    v_lshlrev_b32 v101, 16, v71
    v_lshlrev_b32 v102, 16, v73
    v_lshlrev_b32 v103, 16, v77
    buffer_load_dwordx2 v[106:107], v104, s[36:39], 0 offen sc1
    s_waitcnt lgkmcnt(6)
    v_mfma_f32_32x32x16_bf16 v[32:47], v[16:19], v[228:231], v[32:47]
    ds_read_b64_tr_b16 v[8:9], v2 offset:6144
    ds_read_b64_tr_b16 v[10:11], v2 offset:6656
    v_permlane32_swap_b32 v133, v141
    v_sub_f32 v83, v133, v141
    v_add_f32 v133, v133, v141
    s_waitcnt lgkmcnt(6)
    v_mfma_f32_32x32x16_bf16 v[48:63], v[20:23], v[228:231], v[48:63]
    ds_read_b64_tr_b16 v[12:13], v3 offset:6144
    ds_read_b64_tr_b16 v[14:15], v3 offset:6656
    v_add_f32 v100, v100, v103
    v_add_f32 v101, v101, v102
    v_add_f32 v134, v100, v101
    v_sub_f32 v142, v100, v101
    v_permlane16_swap_b32 v133, v83
    v_sub_f32 v141, v133, v83
    v_add_f32 v133, v133, v83
    s_waitcnt lgkmcnt(6)
    v_mfma_f32_32x32x16_bf16 v[32:47], v[24:27], v[232:235], v[32:47]
    ds_read_b64_tr_b16 v[16:17], v2 offset:8192
    ds_read_b64_tr_b16 v[18:19], v2 offset:8704
    v_and_b32 v100, 0xffff0000, v67
    v_and_b32 v101, 0xffff0000, v71
    v_and_b32 v102, 0xffff0000, v72
    v_and_b32 v103, 0xffff0000, v76
    s_waitcnt lgkmcnt(6)
    v_mfma_f32_32x32x16_bf16 v[48:63], v[28:31], v[232:235], v[48:63]
    ds_read_b64_tr_b16 v[20:21], v3 offset:8192
    ds_read_b64_tr_b16 v[22:23], v3 offset:8704
    v_permlane32_swap_b32 v134, v142
    v_sub_f32 v82, v134, v142
    v_add_f32 v134, v134, v142
    v_add_f32 v100, v100, v103
    v_add_f32 v101, v101, v102
    v_add_f32 v135, v100, v101
    v_sub_f32 v143, v100, v101
    s_waitcnt lgkmcnt(6)
    v_mfma_f32_32x32x16_bf16 v[32:47], v[8:11], v[236:239], v[32:47]
    ds_read_b64_tr_b16 v[24:25], v2 offset:10240
    ds_read_b64_tr_b16 v[26:27], v2 offset:10752
    v_permlane16_swap_b32 v134, v82
    v_sub_f32 v142, v134, v82
    v_add_f32 v134, v134, v82
    s_waitcnt lgkmcnt(6)
    v_mfma_f32_32x32x16_bf16 v[48:63], v[12:15], v[236:239], v[48:63]
    ds_read_b64_tr_b16 v[28:29], v3 offset:10240
    ds_read_b64_tr_b16 v[30:31], v3 offset:10752
    s_mov_b32 vcc_lo, -1
    s_mov_b32 vcc_hi, 0
    s_lshl_b32 s3, s100, 4
    s_add_u32 s3, s3, 16777216
    v_cndmask_b32 v152, v153, v152, vcc
    buffer_store_dword v152, v90, s[36:39], s3 offen sc1
    s_and_b32 s3, s100, 3
    s_lshl_b32 s3, s3, 6
    s_lshl_b32 s101, s101, 10
    s_add_u32 s3, s3, s101
    s_lshr_b32 s100, s100, 2
    s_lshl_b32 s100, s100, 13
    s_add_u32 s100, s100, s3
    s_add_u32 s101, s100, 13107200
    s_add_u32 s100, s100, 12582912
    v_permlane32_swap_b32 v135, v143
    v_sub_f32 v83, v135, v143
    v_add_f32 v135, v135, v143
    s_waitcnt lgkmcnt(6)
    v_mfma_f32_32x32x16_bf16 v[32:47], v[16:19], v[240:243], v[32:47]
    ds_read_b64_tr_b16 v[8:9], v2 offset:12288
    ds_read_b64_tr_b16 v[10:11], v2 offset:12800
    v_permlane16_swap_b32 v135, v83
    v_sub_f32 v143, v135, v83
    v_add_f32 v135, v135, v83
    s_waitcnt lgkmcnt(6)
    v_mfma_f32_32x32x16_bf16 v[48:63], v[20:23], v[240:243], v[48:63]
    ds_read_b64_tr_b16 v[12:13], v3 offset:12288
    ds_read_b64_tr_b16 v[14:15], v3 offset:12800
    v_cvt_pk_bf16_f32 v144, v128, v129
    v_cvt_pk_bf16_f32 v145, v130, v131
    v_cvt_pk_bf16_f32 v146, v132, v133
    v_cvt_pk_bf16_f32 v147, v134, v135
    ds_bpermute_b32 v144, v91, v144
    ds_bpermute_b32 v145, v91, v145
    ds_bpermute_b32 v146, v91, v146
    ds_bpermute_b32 v147, v91, v147
    v_cvt_pk_bf16_f32 v148, v136, v137
    v_cvt_pk_bf16_f32 v149, v138, v139
    v_cvt_pk_bf16_f32 v150, v140, v141
    v_cvt_pk_bf16_f32 v151, v142, v143
    ds_bpermute_b32 v148, v91, v148
    ds_bpermute_b32 v149, v91, v149
    ds_bpermute_b32 v150, v91, v150
    ds_bpermute_b32 v151, v91, v151
    s_waitcnt lgkmcnt(14)
    v_mfma_f32_32x32x16_bf16 v[32:47], v[24:27], v[244:247], v[32:47]
    ds_read_b64_tr_b16 v[16:17], v2 offset:14336
    ds_read_b64_tr_b16 v[18:19], v2 offset:14848
    s_waitcnt lgkmcnt(14)
    v_mfma_f32_32x32x16_bf16 v[48:63], v[28:31], v[244:247], v[48:63]
    ds_read_b64_tr_b16 v[20:21], v3 offset:14336
    ds_read_b64_tr_b16 v[22:23], v3 offset:14848
    s_waitcnt lgkmcnt(8)
    buffer_store_dwordx4 v[144:147], v92, s[36:39], s100 offen sc1
    s_barrier
    v_mfma_f32_32x32x16_bf16 v[32:47], v[8:11], v[248:251], v[32:47]
    v_mfma_f32_32x32x16_bf16 v[48:63], v[12:15], v[248:251], v[48:63]
    s_waitcnt lgkmcnt(4)
    buffer_store_dwordx4 v[148:151], v92, s[36:39], s101 offen sc1
    s_waitcnt lgkmcnt(0)
    v_mfma_f32_32x32x16_bf16 v[48:63], v[20:23], v[252:255], v[48:63]
    v_mfma_f32_32x32x16_bf16 v[32:47], v[16:19], v[252:255], v[32:47]
    s_waitcnt vmcnt(3)
F_ATT:
    s_lshl_b32 s3, s26, 12
    s_add_u32 s3, s3, 98304
    v_add_u32 v2, s3, v1
    v_xor_b32 v3, 0x4000, v2
SP5:
    v_cmp_eq_u64 vcc, s[32:33], v[106:107]
    s_and_b32 s53, vcc_lo, vcc_hi
    s_andn2_b32 s3, 28, s53
    s_cmp_eq_u32 s3, 0
    s_cbranch_scc1 SQ6
    s_sub_u32 s35, s35, 1
    s_cbranch_scc1 SQ6_t
    s_sleep 2
    buffer_load_dwordx2 v[106:107], v104, s[36:39], 0 offen sc1
    s_waitcnt vmcnt(0)
    s_branch SP5
SQ6_t:
    s_mov_b32 s35, 0
SQ6:
    s_cmp_lt_u32 s34, 2
    s_cbranch_scc1 A_N0
    s_add_u32 m0, s52, 0
    s_add_u32 s73, s98, 8192
    s_xor_b32 s73, s73, s31
    buffer_load_dwordx4 v4, s[40:43], s73 offen offset:0 sc1 lds
    buffer_load_dwordx4 v4, s[40:43], s73 offen offset:1024 sc1 lds
A_N0:
    ds_write_b128 v2, v[48:51] offset:0
    s_add_u32 m0, s52, 32768
    s_add_u32 s73, s98, 24576
    s_xor_b32 s73, s73, s31
    buffer_load_dwordx4 v4, s[40:43], s73 offen offset:0 sc1 lds
    ds_write_b128 v2, v[52:55] offset:1024
    buffer_load_dwordx4 v4, s[40:43], s73 offen offset:1024 sc1 lds
    ds_write_b128 v2, v[56:59] offset:2048
    s_xor_b32 s73, s74, 16384
    buffer_load_dwordx4 v4, s[40:43], s73 offen offset:2048 sc1 lds
    ds_write_b128 v2, v[60:63] offset:3072
    buffer_load_dwordx4 v4, s[40:43], s73 offen offset:3072 sc1 lds
    v_mov_b32 v5, 0xdddddddd
    v_and_b32 v6, 7, v0
    v_mov_b32 v7, 0x3f803f80
    v_cmp_eq_u32 vcc, 0, v6
    s_nop 1
    v_cndmask_b32 v8, 0, v7, vcc
    v_cndmask_b32 v9, 0, v7, vcc
    v_cmp_eq_u32 vcc, 4, v6
    s_nop 1
    v_cndmask_b32 v10, 0, v7, vcc
    v_cndmask_b32 v11, 0, v7, vcc
    v_mov_b32 v12, 0
    v_mov_b32 v13, 0
    v_mov_b32 v14, 0
    v_mov_b32 v15, 0
    s_waitcnt lgkmcnt(0)
    s_barrier
    ds_read_b128 v[64:67], v3 offset:0
    ds_read_b128 v[68:71], v3 offset:1024
    ds_read_b128 v[72:75], v3 offset:2048
    ds_read_b128 v[76:79], v3 offset:3072
    s_mov_b32 s3, 0x3e8293ee
    s_lshr_b32 s100, s65, 6
    v_add_u32 v2, s100, v1
    v_add_u32 v3, 0xc000, v2
    ds_read_b128 v[24:27], v3 offset:32768
    ds_read_b128 v[28:31], v3 offset:33792
    v_mov_b32 v6, s3
    v_pk_mul_f32 v[32:33], v[32:33], v[6:7] op_sel_hi:[1,0]
    v_pk_mul_f32 v[34:35], v[34:35], v[6:7] op_sel_hi:[1,0]
    v_pk_mul_f32 v[36:37], v[36:37], v[6:7] op_sel_hi:[1,0]
    v_pk_mul_f32 v[38:39], v[38:39], v[6:7] op_sel_hi:[1,0]
    v_pk_mul_f32 v[40:41], v[40:41], v[6:7] op_sel_hi:[1,0]
    v_pk_mul_f32 v[42:43], v[42:43], v[6:7] op_sel_hi:[1,0]
    v_pk_mul_f32 v[44:45], v[44:45], v[6:7] op_sel_hi:[1,0]
    v_pk_mul_f32 v[46:47], v[46:47], v[6:7] op_sel_hi:[1,0]
    s_waitcnt lgkmcnt(5)
    v_pk_fma_f32 v[32:33], v[64:65], v[6:7], v[32:33] op_sel_hi:[1,0,1]
    v_pk_fma_f32 v[34:35], v[66:67], v[6:7], v[34:35] op_sel_hi:[1,0,1]
    v_cvt_pk_bf16_f32 v16, v32, v33
    v_cvt_pk_bf16_f32 v17, v34, v35
    s_waitcnt lgkmcnt(4)
    v_pk_fma_f32 v[36:37], v[68:69], v[6:7], v[36:37] op_sel_hi:[1,0,1]
    v_pk_fma_f32 v[38:39], v[70:71], v[6:7], v[38:39] op_sel_hi:[1,0,1]
    v_cvt_pk_bf16_f32 v18, v36, v37
    v_cvt_pk_bf16_f32 v19, v38, v39
    s_waitcnt lgkmcnt(3)
    v_pk_fma_f32 v[40:41], v[72:73], v[6:7], v[40:41] op_sel_hi:[1,0,1]
    v_pk_fma_f32 v[42:43], v[74:75], v[6:7], v[42:43] op_sel_hi:[1,0,1]
    v_cvt_pk_bf16_f32 v20, v40, v41
    v_cvt_pk_bf16_f32 v21, v42, v43
    s_waitcnt lgkmcnt(2)
    v_pk_fma_f32 v[44:45], v[76:77], v[6:7], v[44:45] op_sel_hi:[1,0,1]
    v_pk_fma_f32 v[46:47], v[78:79], v[6:7], v[46:47] op_sel_hi:[1,0,1]
    v_cvt_pk_bf16_f32 v22, v44, v45
    v_cvt_pk_bf16_f32 v23, v46, v47
    s_mov_b32 s100, 0xc2b00000
    s_waitcnt lgkmcnt(1)
    v_mfma_f32_32x32x16_bf16 v[72:87], v[24:27], v[16:19], 0
    s_waitcnt lgkmcnt(0)
    v_mfma_f32_32x32x16_bf16 v[72:87], v[28:31], v[20:23], v[72:87]
    ds_read_b128 v[24:27], v3 offset:40960
    ds_read_b128 v[28:31], v3 offset:41984
    ds_read_b128 v[32:35], v2 offset:2048
    v_mov_b32 v56, 0
    v_mov_b32 v57, 0
    v_mov_b32 v58, 0
    v_mov_b32 v59, 0
    v_mov_b32 v60, 0
    v_mov_b32 v61, 0
    v_mov_b32 v62, 0
    v_mov_b32 v63, 0
    v_mov_b32 v64, 0
    v_mov_b32 v65, 0
    v_mov_b32 v66, 0
    v_mov_b32 v67, 0
    v_mov_b32 v68, 0
    v_mov_b32 v69, 0
    v_mov_b32 v70, 0
    v_mov_b32 v71, 0
    v_max3_f32 v6, v72, v73, v74
    v_max3_f32 v6, v6, v75, v76
    v_max3_f32 v6, v6, v77, v78
    v_max3_f32 v6, v6, v79, v80
    v_max3_f32 v6, v6, v81, v82
    v_max3_f32 v6, v6, v83, v84
    v_max3_f32 v6, v6, v85, v86
    v_max_f32 v6, v6, v87
    v_mov_b32 v7, v6
    s_nop 1
    v_permlane32_swap_b32 v6, v7
    v_max_f32 v6, v6, v7
    v_sub_f32 v6, s100, v6
    v_pk_add_f32 v[72:73], v[72:73], v[6:7] op_sel_hi:[1,0]
    v_pk_add_f32 v[74:75], v[74:75], v[6:7] op_sel_hi:[1,0]
    v_pk_add_f32 v[76:77], v[76:77], v[6:7] op_sel_hi:[1,0]
    v_pk_add_f32 v[78:79], v[78:79], v[6:7] op_sel_hi:[1,0]
    v_pk_add_f32 v[80:81], v[80:81], v[6:7] op_sel_hi:[1,0]
    v_pk_add_f32 v[82:83], v[82:83], v[6:7] op_sel_hi:[1,0]
    v_pk_add_f32 v[84:85], v[84:85], v[6:7] op_sel_hi:[1,0]
    v_pk_add_f32 v[86:87], v[86:87], v[6:7] op_sel_hi:[1,0]
    v_pk_mov_b32 v[40:41], v[6:7], v[6:7] op_sel:[0,0]
    v_pk_mov_b32 v[42:43], v[6:7], v[6:7] op_sel:[0,0]
    v_pk_mov_b32 v[44:45], v[6:7], v[6:7] op_sel:[0,0]
    v_pk_mov_b32 v[46:47], v[6:7], v[6:7] op_sel:[0,0]
    v_pk_mov_b32 v[48:49], v[6:7], v[6:7] op_sel:[0,0]
    v_pk_mov_b32 v[50:51], v[6:7], v[6:7] op_sel:[0,0]
    v_pk_mov_b32 v[52:53], v[6:7], v[6:7] op_sel:[0,0]
    v_pk_mov_b32 v[54:55], v[6:7], v[6:7] op_sel:[0,0]
    v_exp_f32 v72, v72
    buffer_load_dwordx2 v[106:107], v104, s[36:39], 0 offen sc1
    v_exp_f32 v73, v73
    s_setprio 3
    ds_read_b128 v[36:39], v2 offset:3072
    v_exp_f32 v74, v74
    v_exp_f32 v75, v75
    v_exp_f32 v76, v76
    v_exp_f32 v77, v77
    v_exp_f32 v78, v78
    s_waitcnt lgkmcnt(3)
    v_mfma_f32_32x32x16_bf16 v[88:103], v[24:27], v[16:19], v[40:55]
    ds_read_b128 v[24:27], v2 offset:0
    v_exp_f32 v79, v79
    v_exp_f32 v80, v80
    v_exp_f32 v81, v81
    s_waitcnt lgkmcnt(3)
    v_mfma_f32_32x32x16_bf16 v[88:103], v[28:31], v[20:23], v[88:103]
    ds_read_b128 v[28:31], v2 offset:1024
    v_exp_f32 v82, v82
    v_exp_f32 v83, v83
    s_waitcnt lgkmcnt(3)
    v_smfmac_f32_32x32x32_bf16 v[56:71], v[32:35], v[72:79], v5
    ds_read_b128 v[32:35], v2 offset:10240
    v_exp_f32 v84, v84
    v_exp_f32 v85, v85
    v_exp_f32 v86, v86
    v_smfmac_f32_16x16x64_bf16 v[12:15], v[8:11], v[72:79], v5
    v_exp_f32 v87, v87
    s_nop 0
    v_exp_f32 v88, v88
    v_exp_f32 v89, v89
    s_waitcnt lgkmcnt(3)
    v_smfmac_f32_32x32x32_bf16 v[56:71], v[36:39], v[80:87], v5
    s_setprio 2
    ds_read_b128 v[36:39], v2 offset:11264
    v_exp_f32 v90, v90
    v_exp_f32 v91, v91
    v_exp_f32 v92, v92
    v_smfmac_f32_16x16x64_bf16 v[12:15], v[8:11], v[80:87], v5
    v_exp_f32 v93, v93
    v_exp_f32 v94, v94
    s_waitcnt lgkmcnt(3)
    v_mfma_f32_32x32x16_bf16 v[72:87], v[24:27], v[16:19], v[40:55]
    ds_read_b128 v[24:27], v2 offset:8192
    v_exp_f32 v95, v95
    v_exp_f32 v96, v96
    v_exp_f32 v97, v97
    s_waitcnt lgkmcnt(3)
    v_mfma_f32_32x32x16_bf16 v[72:87], v[28:31], v[20:23], v[72:87]
    ds_read_b128 v[28:31], v2 offset:9216
    v_exp_f32 v98, v98
    v_exp_f32 v99, v99
    s_waitcnt lgkmcnt(3)
    v_smfmac_f32_32x32x32_bf16 v[56:71], v[32:35], v[88:95], v5
    ds_read_b128 v[32:35], v2 offset:18432
    v_exp_f32 v100, v100
    v_exp_f32 v101, v101
    v_exp_f32 v102, v102
    v_smfmac_f32_16x16x64_bf16 v[12:15], v[8:11], v[88:95], v5
    v_exp_f32 v103, v103
    s_nop 0
    v_exp_f32 v72, v72
    v_exp_f32 v73, v73
    s_waitcnt lgkmcnt(3)
    v_smfmac_f32_32x32x32_bf16 v[56:71], v[36:39], v[96:103], v5
    s_waitcnt vmcnt(5)
    s_waitcnt lgkmcnt(0)
    s_barrier
    s_setprio 1
    ds_read_b128 v[36:39], v2 offset:19456
    v_exp_f32 v74, v74
    buffer_store_dwordx2 v[116:117], v122, s[36:39], s76 offen sc1
    v_exp_f32 v75, v75
    v_exp_f32 v76, v76
    v_smfmac_f32_16x16x64_bf16 v[12:15], v[8:11], v[96:103], v5
    v_exp_f32 v77, v77
    s_add_u32 m0, s52, 98304
    s_nop 0
    buffer_load_dwordx4 v108, s[44:47], s92 offen offset:0 lds
    v_exp_f32 v78, v78
    v_mfma_f32_32x32x16_bf16 v[88:103], v[24:27], v[16:19], v[40:55]
    ds_read_b128 v[24:27], v2 offset:16384
    v_exp_f32 v79, v79
    v_exp_f32 v80, v80
    v_exp_f32 v81, v81
    buffer_load_dwordx4 v109, s[44:47], s92 offen offset:1024 lds
    v_mfma_f32_32x32x16_bf16 v[88:103], v[28:31], v[20:23], v[88:103]
    ds_read_b128 v[28:31], v2 offset:17408
    v_exp_f32 v82, v82
    v_exp_f32 v83, v83
    v_smfmac_f32_32x32x32_bf16 v[56:71], v[32:35], v[72:79], v5
    ds_read_b128 v[32:35], v2 offset:26624
    v_exp_f32 v84, v84
    buffer_load_dwordx4 v110, s[44:47], s92 offen offset:2048 lds
    v_exp_f32 v85, v85
    v_exp_f32 v86, v86
    v_smfmac_f32_16x16x64_bf16 v[12:15], v[8:11], v[72:79], v5
    v_exp_f32 v87, v87
    s_nop 0
    v_exp_f32 v88, v88
    s_waitcnt vmcnt(4)
    v_cmp_eq_u64 vcc, s[32:33], v[106:107]
    s_and_b32 s53, vcc_lo, vcc_hi
    s_andn2_b32 s3, 0x1fc, s53
    s_cbranch_scc1 KS1
KB1:
    v_exp_f32 v89, v89
    s_waitcnt lgkmcnt(3)
    v_smfmac_f32_32x32x32_bf16 v[56:71], v[36:39], v[80:87], v5
    s_setprio 0
    ds_read_b128 v[36:39], v2 offset:27648
    v_exp_f32 v90, v90
    v_exp_f32 v91, v91
    v_exp_f32 v92, v92
    v_smfmac_f32_16x16x64_bf16 v[12:15], v[8:11], v[80:87], v5
    v_exp_f32 v93, v93
    s_add_u32 m0, s52, 65536
    s_add_u32 s73, s98, 40960
    s_xor_b32 s73, s73, s31
    buffer_load_dwordx4 v4, s[40:43], s73 offen offset:0 sc1 lds
    buffer_load_dwordx4 v4, s[40:43], s73 offen offset:1024 sc1 lds
    v_exp_f32 v94, v94
    s_waitcnt lgkmcnt(3)
    v_mfma_f32_32x32x16_bf16 v[72:87], v[24:27], v[16:19], v[40:55]
    ds_read_b128 v[24:27], v2 offset:24576
    v_exp_f32 v95, v95
    v_exp_f32 v96, v96
    v_exp_f32 v97, v97
    s_waitcnt lgkmcnt(3)
    v_mfma_f32_32x32x16_bf16 v[72:87], v[28:31], v[20:23], v[72:87]
    ds_read_b128 v[28:31], v2 offset:25600
    v_exp_f32 v98, v98
    s_add_u32 m0, s52, 98304
    s_nop 0
    buffer_load_dwordx4 v111, s[44:47], s92 offen offset:3072 lds
    v_exp_f32 v99, v99
    s_waitcnt lgkmcnt(3)
    v_smfmac_f32_32x32x32_bf16 v[56:71], v[32:35], v[88:95], v5
    v_exp_f32 v100, v100
    v_exp_f32 v101, v101
    v_exp_f32 v102, v102
    v_smfmac_f32_16x16x64_bf16 v[12:15], v[8:11], v[88:95], v5
    v_exp_f32 v103, v103
    v_exp_f32 v72, v72
    v_exp_f32 v73, v73
    s_waitcnt lgkmcnt(2)
    v_smfmac_f32_32x32x32_bf16 v[56:71], v[36:39], v[96:103], v5
    s_waitcnt lgkmcnt(0)
    s_barrier
    s_setprio 3
    ds_read_b128 v[32:35], v2 offset:34816
    ds_read_b128 v[36:39], v2 offset:35840
    v_exp_f32 v74, v74
    buffer_load_dwordx2 v[106:107], v104, s[36:39], 0 offen sc1
    v_exp_f32 v75, v75
    v_exp_f32 v76, v76
    v_smfmac_f32_16x16x64_bf16 v[12:15], v[8:11], v[96:103], v5
    v_exp_f32 v77, v77
    v_exp_f32 v78, v78
    s_add_u32 m0, s52, 65536
    s_xor_b32 s73, s74, 32768
    buffer_load_dwordx4 v4, s[40:43], s73 offen offset:2048 sc1 lds
    v_mfma_f32_32x32x16_bf16 v[88:103], v[24:27], v[16:19], v[40:55]
    ds_read_b128 v[24:27], v2 offset:32768
    v_exp_f32 v79, v79
    v_exp_f32 v80, v80
    v_exp_f32 v81, v81
    v_mfma_f32_32x32x16_bf16 v[88:103], v[28:31], v[20:23], v[88:103]
    ds_read_b128 v[28:31], v2 offset:33792
    v_exp_f32 v82, v82
    v_exp_f32 v83, v83
    buffer_load_dwordx4 v4, s[40:43], s73 offen offset:3072 sc1 lds
    s_waitcnt lgkmcnt(3)
    v_smfmac_f32_32x32x32_bf16 v[56:71], v[32:35], v[72:79], v5
    ds_read_b128 v[32:35], v2 offset:43008
    v_exp_f32 v84, v84
    v_exp_f32 v85, v85
    v_exp_f32 v86, v86
    v_smfmac_f32_16x16x64_bf16 v[12:15], v[8:11], v[72:79], v5
    v_exp_f32 v87, v87
    v_exp_f32 v88, v88
    s_add_u32 m0, s52, 0
    s_add_u32 s73, s98, 57344
    s_xor_b32 s73, s73, s31
    buffer_load_dwordx4 v4, s[40:43], s73 offen offset:0 sc1 lds
    v_exp_f32 v89, v89
    s_waitcnt lgkmcnt(3)
    v_smfmac_f32_32x32x32_bf16 v[56:71], v[36:39], v[80:87], v5
    s_setprio 2
    ds_read_b128 v[36:39], v2 offset:44032
    v_exp_f32 v90, v90
    v_exp_f32 v91, v91
    v_exp_f32 v92, v92
    v_smfmac_f32_16x16x64_bf16 v[12:15], v[8:11], v[80:87], v5
    v_exp_f32 v93, v93
    s_cmp_lg_u32 s99, 0x10000
    s_cselect_b32 s48, s6, s8
    s_cselect_b32 s49, s7, s9
    s_mov_b32 s50, 8388608
    buffer_load_dwordx4 v[172:175], v1, s[48:51], s87 offen
    v_exp_f32 v94, v94
    s_waitcnt lgkmcnt(3)
    v_mfma_f32_32x32x16_bf16 v[72:87], v[24:27], v[16:19], v[40:55]
    ds_read_b128 v[24:27], v2 offset:40960
    v_exp_f32 v95, v95
    v_exp_f32 v96, v96
    v_exp_f32 v97, v97
    s_waitcnt lgkmcnt(3)
    v_mfma_f32_32x32x16_bf16 v[72:87], v[28:31], v[20:23], v[72:87]
    ds_read_b128 v[28:31], v2 offset:41984
    v_exp_f32 v98, v98
    s_cmp_eq_u32 s65, 0
    s_cselect_b32 s44, s6, s8
    s_cselect_b32 s45, s7, s9
    s_mov_b32 s46, 8388608
    v_exp_f32 v99, v99
    s_waitcnt lgkmcnt(3)
    v_smfmac_f32_32x32x32_bf16 v[56:71], v[32:35], v[88:95], v5
    ds_read_b128 v[32:35], v3 offset:2048
    v_exp_f32 v100, v100
    v_exp_f32 v101, v101
    v_exp_f32 v102, v102
    v_smfmac_f32_16x16x64_bf16 v[12:15], v[8:11], v[88:95], v5
    v_exp_f32 v103, v103
    v_exp_f32 v72, v72
    buffer_load_dwordx4 v4, s[40:43], s73 offen offset:1024 sc1 lds
    v_exp_f32 v73, v73
    s_waitcnt lgkmcnt(3)
    v_smfmac_f32_32x32x32_bf16 v[56:71], v[36:39], v[96:103], v5
    s_setprio 1
    ds_read_b128 v[36:39], v3 offset:3072
    v_exp_f32 v74, v74
    v_exp_f32 v75, v75
    v_exp_f32 v76, v76
    v_smfmac_f32_16x16x64_bf16 v[12:15], v[8:11], v[96:103], v5
    v_exp_f32 v77, v77
    v_exp_f32 v78, v78
    s_waitcnt lgkmcnt(3)
    v_mfma_f32_32x32x16_bf16 v[88:103], v[24:27], v[16:19], v[40:55]
    ds_read_b128 v[24:27], v3 offset:0
    v_exp_f32 v79, v79
    v_exp_f32 v80, v80
    v_exp_f32 v81, v81
    s_waitcnt lgkmcnt(3)
    v_mfma_f32_32x32x16_bf16 v[88:103], v[28:31], v[20:23], v[88:103]
    ds_read_b128 v[28:31], v3 offset:1024
    v_exp_f32 v82, v82
    v_exp_f32 v83, v83
    s_waitcnt lgkmcnt(3)
    v_smfmac_f32_32x32x32_bf16 v[56:71], v[32:35], v[72:79], v5
    ds_read_b128 v[32:35], v3 offset:10240
    v_exp_f32 v84, v84
    v_exp_f32 v85, v85
    v_exp_f32 v86, v86
    v_smfmac_f32_16x16x64_bf16 v[12:15], v[8:11], v[72:79], v5
    v_exp_f32 v87, v87
    s_nop 0
    v_exp_f32 v88, v88
    s_xor_b32 s73, s74, 49152
    buffer_load_dwordx4 v4, s[40:43], s73 offen offset:2048 sc1 lds
    v_exp_f32 v89, v89
    s_waitcnt lgkmcnt(3)
    v_smfmac_f32_32x32x32_bf16 v[56:71], v[36:39], v[80:87], v5
    s_setprio 0
    ds_read_b128 v[36:39], v3 offset:11264
    v_exp_f32 v90, v90
    v_exp_f32 v91, v91
    v_exp_f32 v92, v92
    v_smfmac_f32_16x16x64_bf16 v[12:15], v[8:11], v[80:87], v5
    v_exp_f32 v93, v93
    v_exp_f32 v94, v94
    s_waitcnt lgkmcnt(3)
    v_mfma_f32_32x32x16_bf16 v[72:87], v[24:27], v[16:19], v[40:55]
    ds_read_b128 v[24:27], v3 offset:8192
    v_exp_f32 v95, v95
    v_exp_f32 v96, v96
    buffer_load_dwordx4 v4, s[40:43], s73 offen offset:3072 sc1 lds
    v_exp_f32 v97, v97
    s_waitcnt lgkmcnt(3)
    v_mfma_f32_32x32x16_bf16 v[72:87], v[28:31], v[20:23], v[72:87]
    ds_read_b128 v[28:31], v3 offset:9216
    v_exp_f32 v98, v98
    v_exp_f32 v99, v99
    s_waitcnt lgkmcnt(3)
    v_smfmac_f32_32x32x32_bf16 v[56:71], v[32:35], v[88:95], v5
    v_exp_f32 v100, v100
    v_exp_f32 v101, v101
    v_exp_f32 v102, v102
    v_smfmac_f32_16x16x64_bf16 v[12:15], v[8:11], v[88:95], v5
    v_exp_f32 v103, v103
    s_nop 1
    v_exp_f32 v72, v72
    v_exp_f32 v73, v73
    s_waitcnt lgkmcnt(2)
    v_smfmac_f32_32x32x32_bf16 v[56:71], v[36:39], v[96:103], v5
    s_waitcnt vmcnt(7)
    v_cmp_eq_u64 vcc, s[32:33], v[106:107]
    s_and_b32 s53, vcc_lo, vcc_hi
    s_andn2_b32 s3, -1, s53
    s_cbranch_scc1 KS2
KB2:
    s_waitcnt vmcnt(5)
    s_waitcnt lgkmcnt(0)
    s_barrier
    s_setprio 3
    ds_read_b128 v[32:35], v3 offset:18432
    ds_read_b128 v[36:39], v3 offset:19456
    v_exp_f32 v74, v74
    buffer_load_dwordx2 v[190:191], v123, s[36:39], s79 offen sc1
    v_exp_f32 v75, v75
    v_exp_f32 v76, v76
    v_smfmac_f32_16x16x64_bf16 v[12:15], v[8:11], v[96:103], v5
    s_add_u32 m0, s52, 32768
    s_add_u32 s73, s98, 73728
    s_xor_b32 s73, s73, s31
    buffer_load_dwordx4 v4, s[40:43], s73 offen offset:0 sc1 lds
    v_exp_f32 v77, v77
    v_exp_f32 v78, v78
    v_mfma_f32_32x32x16_bf16 v[88:103], v[24:27], v[16:19], v[40:55]
    ds_read_b128 v[24:27], v3 offset:16384
    v_exp_f32 v79, v79
    v_exp_f32 v80, v80
    v_exp_f32 v81, v81
    v_mfma_f32_32x32x16_bf16 v[88:103], v[28:31], v[20:23], v[88:103]
    ds_read_b128 v[28:31], v3 offset:17408
    v_exp_f32 v82, v82
    v_exp_f32 v83, v83
    s_waitcnt lgkmcnt(3)
    v_smfmac_f32_32x32x32_bf16 v[56:71], v[32:35], v[72:79], v5
    ds_read_b128 v[32:35], v3 offset:26624
    v_exp_f32 v84, v84
    v_exp_f32 v85, v85
    v_exp_f32 v86, v86
    v_smfmac_f32_16x16x64_bf16 v[12:15], v[8:11], v[72:79], v5
    v_exp_f32 v87, v87
    s_nop 0
    v_exp_f32 v88, v88
    v_exp_f32 v89, v89
    s_waitcnt lgkmcnt(3)
    v_smfmac_f32_32x32x32_bf16 v[56:71], v[36:39], v[80:87], v5
    s_setprio 2
    ds_read_b128 v[36:39], v3 offset:27648
    v_exp_f32 v90, v90
    v_exp_f32 v91, v91
    v_exp_f32 v92, v92
    v_smfmac_f32_16x16x64_bf16 v[12:15], v[8:11], v[80:87], v5
    buffer_load_dwordx4 v4, s[40:43], s73 offen offset:1024 sc1 lds
    v_exp_f32 v93, v93
    v_exp_f32 v94, v94
    s_waitcnt lgkmcnt(3)
    v_mfma_f32_32x32x16_bf16 v[72:87], v[24:27], v[16:19], v[40:55]
    ds_read_b128 v[24:27], v3 offset:24576
    v_exp_f32 v95, v95
    v_exp_f32 v96, v96
    v_exp_f32 v97, v97
    s_waitcnt lgkmcnt(3)
    v_mfma_f32_32x32x16_bf16 v[72:87], v[28:31], v[20:23], v[72:87]
    ds_read_b128 v[28:31], v3 offset:25600
    v_exp_f32 v98, v98
    v_exp_f32 v99, v99
    s_waitcnt lgkmcnt(3)
    v_smfmac_f32_32x32x32_bf16 v[56:71], v[32:35], v[88:95], v5
    ds_read_b128 v[32:35], v3 offset:34816
    v_exp_f32 v100, v100
    v_exp_f32 v101, v101
    v_exp_f32 v102, v102
    v_smfmac_f32_16x16x64_bf16 v[12:15], v[8:11], v[88:95], v5
    v_exp_f32 v103, v103
    s_nop 0
    v_exp_f32 v72, v72
    s_waitcnt vmcnt(2)
    v_cmp_eq_u64 vcc, s[32:33], v[190:191]
    s_cmp_eq_u64 vcc, -1
    s_cbranch_scc0 CK1_O
CK1_B:
    v_exp_f32 v73, v73
    s_waitcnt lgkmcnt(3)
    v_smfmac_f32_32x32x32_bf16 v[56:71], v[36:39], v[96:103], v5
    s_setprio 1
    ds_read_b128 v[36:39], v3 offset:35840
    v_exp_f32 v74, v74
    v_exp_f32 v75, v75
    v_exp_f32 v76, v76
    v_smfmac_f32_16x16x64_bf16 v[12:15], v[8:11], v[96:103], v5
    s_xor_b32 s73, s74, 65536
    buffer_load_dwordx4 v4, s[40:43], s73 offen offset:2048 sc1 lds
    v_exp_f32 v77, v77
    buffer_load_dwordx4 v[236:239], v184, s[36:39], s80 offen sc1
    v_exp_f32 v78, v78
    s_waitcnt lgkmcnt(3)
    v_mfma_f32_32x32x16_bf16 v[88:103], v[24:27], v[16:19], v[40:55]
    ds_read_b128 v[24:27], v3 offset:32768
    v_exp_f32 v79, v79
    v_exp_f32 v80, v80
    v_exp_f32 v81, v81
    s_waitcnt lgkmcnt(3)
    v_mfma_f32_32x32x16_bf16 v[88:103], v[28:31], v[20:23], v[88:103]
    ds_read_b128 v[28:31], v3 offset:33792
    v_exp_f32 v82, v82
    buffer_load_dwordx4 v[192:195], v1, s[36:39], s81 offen offset:0 sc1
    v_exp_f32 v83, v83
    s_waitcnt lgkmcnt(3)
    v_smfmac_f32_32x32x32_bf16 v[56:71], v[32:35], v[72:79], v5
    ds_read_b128 v[32:35], v3 offset:43008
    v_exp_f32 v84, v84
    v_exp_f32 v85, v85
    v_exp_f32 v86, v86
    v_smfmac_f32_16x16x64_bf16 v[12:15], v[8:11], v[72:79], v5
    v_exp_f32 v87, v87
    v_exp_f32 v88, v88
    buffer_load_dwordx4 v[196:199], v1, s[36:39], s81 offen offset:1024 sc1
    v_exp_f32 v89, v89
    s_waitcnt lgkmcnt(3)
    v_smfmac_f32_32x32x32_bf16 v[56:71], v[36:39], v[80:87], v5
    s_setprio 0
    ds_read_b128 v[36:39], v3 offset:44032
    v_exp_f32 v90, v90
    v_exp_f32 v91, v91
    v_exp_f32 v92, v92
    v_smfmac_f32_16x16x64_bf16 v[12:15], v[8:11], v[80:87], v5
    buffer_load_dwordx4 v4, s[40:43], s73 offen offset:3072 sc1 lds
    v_exp_f32 v93, v93
    v_exp_f32 v94, v94
    s_waitcnt lgkmcnt(3)
    v_mfma_f32_32x32x16_bf16 v[72:87], v[24:27], v[16:19], v[40:55]
    ds_read_b128 v[24:27], v3 offset:40960
    v_exp_f32 v95, v95
    v_exp_f32 v96, v96
    buffer_load_dwordx4 v[200:203], v1, s[36:39], s81 offen offset:2048 sc1
    v_exp_f32 v97, v97
    s_waitcnt lgkmcnt(3)
    v_mfma_f32_32x32x16_bf16 v[72:87], v[28:31], v[20:23], v[72:87]
    ds_read_b128 v[28:31], v3 offset:41984
    v_exp_f32 v98, v98
    v_exp_f32 v99, v99
    s_waitcnt lgkmcnt(3)
    v_smfmac_f32_32x32x32_bf16 v[56:71], v[32:35], v[88:95], v5
    v_exp_f32 v100, v100
    v_exp_f32 v101, v101
    v_exp_f32 v102, v102
    v_smfmac_f32_16x16x64_bf16 v[12:15], v[8:11], v[88:95], v5
    v_exp_f32 v103, v103
    s_nop 1
    v_exp_f32 v72, v72
    v_exp_f32 v73, v73
    s_waitcnt lgkmcnt(2)
    v_smfmac_f32_32x32x32_bf16 v[56:71], v[36:39], v[96:103], v5
    s_waitcnt lgkmcnt(0)
    s_barrier
    s_setprio 3
    ds_read_b128 v[32:35], v2 offset:2048
    ds_read_b128 v[36:39], v2 offset:3072
    v_exp_f32 v74, v74
    buffer_load_dwordx4 v[204:207], v1, s[36:39], s81 offen offset:3072 sc1
    v_exp_f32 v75, v75
    v_exp_f32 v76, v76
    v_smfmac_f32_16x16x64_bf16 v[12:15], v[8:11], v[96:103], v5
    s_add_u32 m0, s52, 65536
    s_add_u32 s73, s98, 90112
    s_xor_b32 s73, s73, s31
    buffer_load_dwordx4 v4, s[40:43], s73 offen offset:0 sc1 lds
    v_exp_f32 v77, v77
    s_add_u32 s81, s81, 4096
    buffer_load_dwordx4 v[208:211], v1, s[36:39], s81 offen offset:0 sc1
    v_exp_f32 v78, v78
    v_mfma_f32_32x32x16_bf16 v[88:103], v[24:27], v[16:19], v[40:55]
    ds_read_b128 v[24:27], v2 offset:0
    v_exp_f32 v79, v79
    v_exp_f32 v80, v80
    v_exp_f32 v81, v81
    ds_read_b128 v[128:131], v112 offset:0
    ds_read_b128 v[132:135], v112 offset:4096
    v_mfma_f32_32x32x16_bf16 v[88:103], v[28:31], v[20:23], v[88:103]
    ds_read_b128 v[28:31], v2 offset:1024
    v_exp_f32 v82, v82
    v_exp_f32 v83, v83
    s_waitcnt lgkmcnt(5)
    v_smfmac_f32_32x32x32_bf16 v[56:71], v[32:35], v[72:79], v5
    ds_read_b128 v[32:35], v2 offset:10240
    v_exp_f32 v84, v84
    ds_read_b128 v[136:139], v113 offset:0
    ds_read_b128 v[140:143], v113 offset:4096
    v_exp_f32 v85, v85
    v_exp_f32 v86, v86
    v_smfmac_f32_16x16x64_bf16 v[12:15], v[8:11], v[72:79], v5
    v_exp_f32 v87, v87
    v_exp_f32 v88, v88
    buffer_load_dwordx4 v[212:215], v1, s[36:39], s81 offen offset:1024 sc1
    v_exp_f32 v89, v89
    s_waitcnt lgkmcnt(7)
    v_smfmac_f32_32x32x32_bf16 v[56:71], v[36:39], v[80:87], v5
    s_setprio 2
    ds_read_b128 v[36:39], v2 offset:11264
    v_exp_f32 v90, v90
    v_exp_f32 v91, v91
    v_exp_f32 v92, v92
    v_smfmac_f32_16x16x64_bf16 v[12:15], v[8:11], v[80:87], v5
    buffer_load_dwordx4 v4, s[40:43], s73 offen offset:1024 sc1 lds
    v_exp_f32 v93, v93
    buffer_load_dwordx4 v[216:219], v1, s[36:39], s81 offen offset:2048 sc1
    v_exp_f32 v94, v94
    s_waitcnt lgkmcnt(7)
    v_mfma_f32_32x32x16_bf16 v[72:87], v[24:27], v[16:19], v[40:55]
    ds_read_b128 v[24:27], v2 offset:8192
    v_exp_f32 v95, v95
    v_exp_f32 v96, v96
    v_exp_f32 v97, v97
    s_waitcnt lgkmcnt(5)
    v_mfma_f32_32x32x16_bf16 v[72:87], v[28:31], v[20:23], v[72:87]
    ds_read_b128 v[28:31], v2 offset:9216
    v_exp_f32 v98, v98
    s_waitcnt vmcnt(10)
    v_lshlrev_b32 v6, 31, v0
    v_xor_b32 v232, v6, v236
    v_xor_b32 v233, v6, v237
    v_xor_b32 v234, v6, v238
    v_xor_b32 v235, v6, v239
    v_exp_f32 v99, v99
    s_waitcnt lgkmcnt(5)
    v_smfmac_f32_32x32x32_bf16 v[56:71], v[32:35], v[88:95], v5
    ds_read_b128 v[32:35], v2 offset:18432
    v_exp_f32 v100, v100
    v_exp_f32 v101, v101
    v_exp_f32 v102, v102
    v_smfmac_f32_16x16x64_bf16 v[12:15], v[8:11], v[88:95], v5
    v_exp_f32 v103, v103
    v_exp_f32 v72, v72
    buffer_load_dwordx4 v[220:223], v1, s[36:39], s81 offen offset:3072 sc1
    v_exp_f32 v73, v73
    s_waitcnt lgkmcnt(3)
    v_smfmac_f32_32x32x32_bf16 v[56:71], v[36:39], v[96:103], v5
    s_setprio 1
    ds_read_b128 v[36:39], v2 offset:19456
    v_exp_f32 v74, v74
    v_exp_f32 v75, v75
    v_exp_f32 v76, v76
    v_smfmac_f32_16x16x64_bf16 v[12:15], v[8:11], v[96:103], v5
    s_xor_b32 s73, s74, 81920
    buffer_load_dwordx4 v4, s[40:43], s73 offen offset:2048 sc1 lds
    v_exp_f32 v77, v77
    v_exp_f32 v78, v78
    s_waitcnt lgkmcnt(3)
    v_mfma_f32_32x32x16_bf16 v[88:103], v[24:27], v[16:19], v[40:55]
    ds_read_b128 v[24:27], v2 offset:16384
    v_exp_f32 v79, v79
    v_exp_f32 v80, v80
    v_exp_f32 v81, v81
    s_waitcnt lgkmcnt(3)
    v_mfma_f32_32x32x16_bf16 v[88:103], v[28:31], v[20:23], v[88:103]
    ds_read_b128 v[28:31], v2 offset:17408
    v_exp_f32 v82, v82
    v_exp_f32 v83, v83
    s_waitcnt lgkmcnt(3)
    v_smfmac_f32_32x32x32_bf16 v[56:71], v[32:35], v[72:79], v5
    ds_read_b128 v[32:35], v2 offset:26624
    v_exp_f32 v84, v84
    v_exp_f32 v85, v85
    v_exp_f32 v86, v86
    v_smfmac_f32_16x16x64_bf16 v[12:15], v[8:11], v[72:79], v5
    s_waitcnt vmcnt(11)
    v_mfma_f32_16x16x32_bf16 v[224:227], v[192:195], v[128:131], v[232:235]
    v_mfma_f32_16x16x32_bf16 v[228:231], v[192:195], v[132:135], v[232:235]
    ds_read_b128 v[144:147], v114 offset:0
    ds_read_b128 v[148:151], v114 offset:4096
    v_exp_f32 v87, v87
    v_exp_f32 v88, v88
    v_exp_f32 v89, v89
    s_waitcnt lgkmcnt(5)
    v_smfmac_f32_32x32x32_bf16 v[56:71], v[36:39], v[80:87], v5
    s_setprio 0
    ds_read_b128 v[36:39], v2 offset:27648
    v_exp_f32 v90, v90
    v_exp_f32 v91, v91
    v_exp_f32 v92, v92
    v_smfmac_f32_16x16x64_bf16 v[12:15], v[8:11], v[80:87], v5
    buffer_load_dwordx4 v4, s[40:43], s73 offen offset:3072 sc1 lds
    v_exp_f32 v93, v93
    v_exp_f32 v94, v94
    s_waitcnt lgkmcnt(5)
    v_mfma_f32_32x32x16_bf16 v[72:87], v[24:27], v[16:19], v[40:55]
    ds_read_b128 v[24:27], v2 offset:24576
    v_exp_f32 v95, v95
    v_exp_f32 v96, v96
    v_exp_f32 v97, v97
    s_waitcnt lgkmcnt(5)
    v_mfma_f32_32x32x16_bf16 v[72:87], v[28:31], v[20:23], v[72:87]
    ds_read_b128 v[28:31], v2 offset:25600
    v_exp_f32 v98, v98
    v_exp_f32 v99, v99
    s_waitcnt lgkmcnt(5)
    v_smfmac_f32_32x32x32_bf16 v[56:71], v[32:35], v[88:95], v5
    v_exp_f32 v100, v100
    v_exp_f32 v101, v101
    v_exp_f32 v102, v102
    v_smfmac_f32_16x16x64_bf16 v[12:15], v[8:11], v[88:95], v5
    s_waitcnt vmcnt(11)
    v_mfma_f32_16x16x32_bf16 v[224:227], v[196:199], v[136:139], v[224:227]
    v_mfma_f32_16x16x32_bf16 v[228:231], v[196:199], v[140:143], v[228:231]
    ds_read_b128 v[128:131], v115 offset:0
    ds_read_b128 v[132:135], v115 offset:4096
    v_exp_f32 v103, v103
    v_exp_f32 v72, v72
    v_exp_f32 v73, v73
    s_waitcnt lgkmcnt(4)
    v_smfmac_f32_32x32x32_bf16 v[56:71], v[36:39], v[96:103], v5
    s_waitcnt vmcnt(10)
    s_waitcnt lgkmcnt(0)
    s_barrier
    s_setprio 3
    ds_read_b128 v[32:35], v2 offset:34816
    ds_read_b128 v[36:39], v2 offset:35840
    v_exp_f32 v74, v74
    buffer_store_dwordx4 v[180:183], v1, s[36:39], s77 offen offset:0 sc1
    buffer_store_dwordx4 v[180:183], v1, s[36:39], s77 offen offset:1024 sc1
    v_exp_f32 v75, v75
    v_exp_f32 v76, v76
    v_smfmac_f32_16x16x64_bf16 v[12:15], v[8:11], v[96:103], v5
    s_add_u32 m0, s52, 0
    s_add_u32 s73, s98, 106496
    s_xor_b32 s73, s73, s31
    buffer_load_dwordx4 v4, s[40:43], s73 offen offset:0 sc1 lds
    v_exp_f32 v77, v77
    v_exp_f32 v78, v78
    v_mfma_f32_32x32x16_bf16 v[88:103], v[24:27], v[16:19], v[40:55]
    ds_read_b128 v[24:27], v2 offset:32768
    v_exp_f32 v79, v79
    v_exp_f32 v80, v80
    v_exp_f32 v81, v81
    v_mfma_f32_32x32x16_bf16 v[88:103], v[28:31], v[20:23], v[88:103]
    ds_read_b128 v[28:31], v2 offset:33792
    v_exp_f32 v82, v82
    v_exp_f32 v83, v83
    s_waitcnt lgkmcnt(3)
    v_smfmac_f32_32x32x32_bf16 v[56:71], v[32:35], v[72:79], v5
    ds_read_b128 v[32:35], v2 offset:43008
    v_exp_f32 v84, v84
    v_exp_f32 v85, v85
    v_exp_f32 v86, v86
    v_smfmac_f32_16x16x64_bf16 v[12:15], v[8:11], v[72:79], v5
    s_waitcnt vmcnt(12)
    v_mfma_f32_16x16x32_bf16 v[224:227], v[200:203], v[144:147], v[224:227]
    v_mfma_f32_16x16x32_bf16 v[228:231], v[200:203], v[148:151], v[228:231]
    ds_read_b128 v[136:139], v112 offset:8192
    ds_read_b128 v[140:143], v112 offset:12288
    v_exp_f32 v87, v87
    v_exp_f32 v88, v88
    v_exp_f32 v89, v89
    s_waitcnt lgkmcnt(5)
    v_smfmac_f32_32x32x32_bf16 v[56:71], v[36:39], v[80:87], v5
    s_setprio 2
    ds_read_b128 v[36:39], v2 offset:44032
    v_exp_f32 v90, v90
    v_exp_f32 v91, v91
    v_exp_f32 v92, v92
    v_smfmac_f32_16x16x64_bf16 v[12:15], v[8:11], v[80:87], v5
    buffer_load_dwordx4 v4, s[40:43], s73 offen offset:1024 sc1 lds
    v_exp_f32 v93, v93
    v_exp_f32 v94, v94
    s_waitcnt lgkmcnt(5)
    v_mfma_f32_32x32x16_bf16 v[72:87], v[24:27], v[16:19], v[40:55]
    ds_read_b128 v[24:27], v2 offset:40960
    v_exp_f32 v95, v95
    v_exp_f32 v96, v96
    v_exp_f32 v97, v97
    s_waitcnt lgkmcnt(5)
    v_mfma_f32_32x32x16_bf16 v[72:87], v[28:31], v[20:23], v[72:87]
    ds_read_b128 v[28:31], v2 offset:41984
    v_exp_f32 v98, v98
    v_exp_f32 v99, v99
    s_waitcnt lgkmcnt(5)
    v_smfmac_f32_32x32x32_bf16 v[56:71], v[32:35], v[88:95], v5
    ds_read_b128 v[32:35], v3 offset:2048
    v_exp_f32 v100, v100
    v_exp_f32 v101, v101
    v_exp_f32 v102, v102
    v_smfmac_f32_16x16x64_bf16 v[12:15], v[8:11], v[88:95], v5
    s_waitcnt vmcnt(12)
    v_mfma_f32_16x16x32_bf16 v[224:227], v[204:207], v[128:131], v[224:227]
    v_mfma_f32_16x16x32_bf16 v[228:231], v[204:207], v[132:135], v[228:231]
    ds_read_b128 v[144:147], v113 offset:8192
    ds_read_b128 v[148:151], v113 offset:12288
    v_exp_f32 v103, v103
    v_exp_f32 v72, v72
    v_exp_f32 v73, v73
    s_waitcnt lgkmcnt(5)
    v_smfmac_f32_32x32x32_bf16 v[56:71], v[36:39], v[96:103], v5
    s_setprio 1
    ds_read_b128 v[36:39], v3 offset:3072
    v_exp_f32 v74, v74
    v_exp_f32 v75, v75
    v_exp_f32 v76, v76
    v_smfmac_f32_16x16x64_bf16 v[12:15], v[8:11], v[96:103], v5
    s_xor_b32 s73, s74, 98304
    buffer_load_dwordx4 v4, s[40:43], s73 offen offset:2048 sc1 lds
    v_exp_f32 v77, v77
    v_exp_f32 v78, v78
    s_waitcnt lgkmcnt(5)
    v_mfma_f32_32x32x16_bf16 v[88:103], v[24:27], v[16:19], v[40:55]
    ds_read_b128 v[24:27], v3 offset:0
    v_exp_f32 v79, v79
    v_exp_f32 v80, v80
    v_exp_f32 v81, v81
    s_waitcnt lgkmcnt(5)
    v_mfma_f32_32x32x16_bf16 v[88:103], v[28:31], v[20:23], v[88:103]
    ds_read_b128 v[28:31], v3 offset:1024
    v_exp_f32 v82, v82
    v_exp_f32 v83, v83
    s_waitcnt lgkmcnt(5)
    v_smfmac_f32_32x32x32_bf16 v[56:71], v[32:35], v[72:79], v5
    ds_read_b128 v[32:35], v3 offset:10240
    v_exp_f32 v84, v84
    v_exp_f32 v85, v85
    v_exp_f32 v86, v86
    v_smfmac_f32_16x16x64_bf16 v[12:15], v[8:11], v[72:79], v5
    s_waitcnt vmcnt(11)
    v_mfma_f32_16x16x32_bf16 v[224:227], v[208:211], v[136:139], v[224:227]
    v_mfma_f32_16x16x32_bf16 v[228:231], v[208:211], v[140:143], v[228:231]
    ds_read_b128 v[128:131], v114 offset:8192
    ds_read_b128 v[132:135], v114 offset:12288
    v_exp_f32 v87, v87
    v_exp_f32 v88, v88
    v_exp_f32 v89, v89
    s_waitcnt lgkmcnt(5)
    v_smfmac_f32_32x32x32_bf16 v[56:71], v[36:39], v[80:87], v5
    s_setprio 0
    ds_read_b128 v[36:39], v3 offset:11264
    v_exp_f32 v90, v90
    v_exp_f32 v91, v91
    v_exp_f32 v92, v92
    v_smfmac_f32_16x16x64_bf16 v[12:15], v[8:11], v[80:87], v5
    buffer_load_dwordx4 v4, s[40:43], s73 offen offset:3072 sc1 lds
    v_exp_f32 v93, v93
    v_exp_f32 v94, v94
    s_waitcnt lgkmcnt(5)
    v_mfma_f32_32x32x16_bf16 v[72:87], v[24:27], v[16:19], v[40:55]
    ds_read_b128 v[24:27], v3 offset:8192
    v_exp_f32 v95, v95
    v_exp_f32 v96, v96
    v_exp_f32 v97, v97
    s_waitcnt lgkmcnt(5)
    v_mfma_f32_32x32x16_bf16 v[72:87], v[28:31], v[20:23], v[72:87]
    ds_read_b128 v[28:31], v3 offset:9216
    v_exp_f32 v98, v98
    v_exp_f32 v99, v99
    s_waitcnt lgkmcnt(5)
    v_smfmac_f32_32x32x32_bf16 v[56:71], v[32:35], v[88:95], v5
    v_exp_f32 v100, v100
    v_exp_f32 v101, v101
    v_exp_f32 v102, v102
    v_smfmac_f32_16x16x64_bf16 v[12:15], v[8:11], v[88:95], v5
    s_waitcnt vmcnt(11)
    v_mfma_f32_16x16x32_bf16 v[224:227], v[212:215], v[144:147], v[224:227]
    v_mfma_f32_16x16x32_bf16 v[228:231], v[212:215], v[148:151], v[228:231]
    ds_read_b128 v[136:139], v115 offset:8192
    ds_read_b128 v[140:143], v115 offset:12288
    v_exp_f32 v103, v103
    v_exp_f32 v72, v72
    v_exp_f32 v73, v73
    s_waitcnt lgkmcnt(4)
    v_smfmac_f32_32x32x32_bf16 v[56:71], v[36:39], v[96:103], v5
    s_waitcnt vmcnt(6)
    s_waitcnt lgkmcnt(0)
    s_barrier
    s_setprio 3
    ds_read_b128 v[32:35], v3 offset:18432
    ds_read_b128 v[36:39], v3 offset:19456
    v_exp_f32 v74, v74
    v_exp_f32 v75, v75
    v_exp_f32 v76, v76
    v_smfmac_f32_16x16x64_bf16 v[12:15], v[8:11], v[96:103], v5
    s_add_u32 m0, s52, 32768
    s_add_u32 s73, s98, 122880
    s_xor_b32 s73, s73, s31
    buffer_load_dwordx4 v4, s[40:43], s73 offen offset:0 sc1 lds
    v_exp_f32 v77, v77
    v_exp_f32 v78, v78
    v_mfma_f32_32x32x16_bf16 v[88:103], v[24:27], v[16:19], v[40:55]
    ds_read_b128 v[24:27], v3 offset:16384
    v_exp_f32 v79, v79
    v_exp_f32 v80, v80
    v_exp_f32 v81, v81
    v_mfma_f32_32x32x16_bf16 v[88:103], v[28:31], v[20:23], v[88:103]
    ds_read_b128 v[28:31], v3 offset:17408
    v_exp_f32 v82, v82
    v_exp_f32 v83, v83
    s_waitcnt lgkmcnt(3)
    v_smfmac_f32_32x32x32_bf16 v[56:71], v[32:35], v[72:79], v5
    ds_read_b128 v[32:35], v3 offset:26624
    v_exp_f32 v84, v84
    v_exp_f32 v85, v85
    v_exp_f32 v86, v86
    v_smfmac_f32_16x16x64_bf16 v[12:15], v[8:11], v[72:79], v5
    v_mfma_f32_16x16x32_bf16 v[224:227], v[216:219], v[128:131], v[224:227]
    v_mfma_f32_16x16x32_bf16 v[228:231], v[216:219], v[132:135], v[228:231]
    v_exp_f32 v87, v87
    v_exp_f32 v88, v88
    v_exp_f32 v89, v89
    s_waitcnt lgkmcnt(3)
    v_smfmac_f32_32x32x32_bf16 v[56:71], v[36:39], v[80:87], v5
    s_setprio 2
    ds_read_b128 v[36:39], v3 offset:27648
    v_exp_f32 v90, v90
    v_exp_f32 v91, v91
    v_exp_f32 v92, v92
    v_smfmac_f32_16x16x64_bf16 v[12:15], v[8:11], v[80:87], v5
    buffer_load_dwordx4 v4, s[40:43], s73 offen offset:1024 sc1 lds
    v_exp_f32 v93, v93
    v_exp_f32 v94, v94
    s_waitcnt lgkmcnt(3)
    v_mfma_f32_32x32x16_bf16 v[72:87], v[24:27], v[16:19], v[40:55]
    ds_read_b128 v[24:27], v3 offset:24576
    v_exp_f32 v95, v95
    v_exp_f32 v96, v96
    v_exp_f32 v97, v97
    s_waitcnt lgkmcnt(3)
    v_mfma_f32_32x32x16_bf16 v[72:87], v[28:31], v[20:23], v[72:87]
    ds_read_b128 v[28:31], v3 offset:25600
    v_exp_f32 v98, v98
    v_exp_f32 v99, v99
    s_waitcnt lgkmcnt(3)
    v_smfmac_f32_32x32x32_bf16 v[56:71], v[32:35], v[88:95], v5
    ds_read_b128 v[32:35], v3 offset:34816
    v_exp_f32 v100, v100
    v_exp_f32 v101, v101
    v_exp_f32 v102, v102
    v_smfmac_f32_16x16x64_bf16 v[12:15], v[8:11], v[88:95], v5
    v_mfma_f32_16x16x32_bf16 v[224:227], v[220:223], v[136:139], v[224:227]
    v_mfma_f32_16x16x32_bf16 v[228:231], v[220:223], v[140:143], v[228:231]
    v_exp_f32 v103, v103
    v_exp_f32 v72, v72
    s_nop 4
    v_cvt_pk_bf16_f32 v232, v224, v225
    v_cvt_pk_bf16_f32 v233, v226, v227
    v_cvt_pk_bf16_f32 v234, v228, v229
    v_cvt_pk_bf16_f32 v235, v230, v231
    s_nop 0
    v_permlane16_swap_b32 v232, v234
    v_permlane16_swap_b32 v233, v235
    buffer_store_dwordx4 v[232:235], v1, s[36:39], s82 offen sc1
    v_exp_f32 v73, v73
    s_waitcnt lgkmcnt(3)
    v_smfmac_f32_32x32x32_bf16 v[56:71], v[36:39], v[96:103], v5
    s_setprio 1
    ds_read_b128 v[36:39], v3 offset:35840
    v_exp_f32 v74, v74
    v_exp_f32 v75, v75
    v_exp_f32 v76, v76
    v_smfmac_f32_16x16x64_bf16 v[12:15], v[8:11], v[96:103], v5
    s_xor_b32 s73, s74, 114688
    buffer_load_dwordx4 v4, s[40:43], s73 offen offset:2048 sc1 lds
    v_exp_f32 v77, v77
    v_exp_f32 v78, v78
    s_waitcnt lgkmcnt(3)
    v_mfma_f32_32x32x16_bf16 v[88:103], v[24:27], v[16:19], v[40:55]
    ds_read_b128 v[24:27], v3 offset:32768
    v_exp_f32 v79, v79
    v_exp_f32 v80, v80
    s_cmp_eq_u32 s84, 1073741824
    s_cbranch_scc1 C_NOC
    v_mov_b32 v128, 0xbf803f80
    v_mov_b32 v129, 0xbf803f80
    v_mov_b32 v130, 0xbf803f80
    v_mov_b32 v131, 0xbf803f80
    s_nop 1
    v_mfma_f32_16x16x32_bf16 v[236:239], v[192:195], v[128:131], v[236:239]
    v_mfma_f32_16x16x32_bf16 v[236:239], v[196:199], v[128:131], v[236:239]
    v_mfma_f32_16x16x32_bf16 v[236:239], v[200:203], v[128:131], v[236:239]
    v_mfma_f32_16x16x32_bf16 v[236:239], v[204:207], v[128:131], v[236:239]
    v_mfma_f32_16x16x32_bf16 v[236:239], v[208:211], v[128:131], v[236:239]
    v_mfma_f32_16x16x32_bf16 v[236:239], v[212:215], v[128:131], v[236:239]
    v_mfma_f32_16x16x32_bf16 v[236:239], v[216:219], v[128:131], v[236:239]
    v_mfma_f32_16x16x32_bf16 v[236:239], v[220:223], v[128:131], v[236:239]
    s_nop 7
    v_cvt_pk_bf16_f32 v236, v236, v237
    v_cvt_pk_bf16_f32 v237, v238, v239
C_NOC:
    buffer_store_dwordx2 v[236:237], v185, s[36:39], s84 offen sc1
    v_exp_f32 v81, v81
    s_waitcnt lgkmcnt(3)
    v_mfma_f32_32x32x16_bf16 v[88:103], v[28:31], v[20:23], v[88:103]
    ds_read_b128 v[28:31], v3 offset:33792
    v_exp_f32 v82, v82
    v_exp_f32 v83, v83
    s_waitcnt lgkmcnt(3)
    v_smfmac_f32_32x32x32_bf16 v[56:71], v[32:35], v[72:79], v5
    ds_read_b128 v[32:35], v3 offset:43008
    v_exp_f32 v84, v84
    v_exp_f32 v85, v85
    v_exp_f32 v86, v86
    v_smfmac_f32_16x16x64_bf16 v[12:15], v[8:11], v[72:79], v5
    v_exp_f32 v87, v87
    s_nop 0
    v_exp_f32 v88, v88
    v_exp_f32 v89, v89
    s_waitcnt lgkmcnt(3)
    v_smfmac_f32_32x32x32_bf16 v[56:71], v[36:39], v[80:87], v5
    s_setprio 0
    ds_read_b128 v[36:39], v3 offset:44032
    v_exp_f32 v90, v90
    v_exp_f32 v91, v91
    v_exp_f32 v92, v92
    v_smfmac_f32_16x16x64_bf16 v[12:15], v[8:11], v[80:87], v5
    buffer_load_dwordx4 v4, s[40:43], s73 offen offset:3072 sc1 lds
    v_exp_f32 v93, v93
    v_exp_f32 v94, v94
    s_waitcnt lgkmcnt(3)
    v_mfma_f32_32x32x16_bf16 v[72:87], v[24:27], v[16:19], v[40:55]
    ds_read_b128 v[24:27], v3 offset:40960
    v_exp_f32 v95, v95
    v_exp_f32 v96, v96
    v_exp_f32 v97, v97
    s_waitcnt lgkmcnt(3)
    v_mfma_f32_32x32x16_bf16 v[72:87], v[28:31], v[20:23], v[72:87]
    ds_read_b128 v[28:31], v3 offset:41984
    v_exp_f32 v98, v98
    v_exp_f32 v99, v99
    s_waitcnt lgkmcnt(3)
    v_smfmac_f32_32x32x32_bf16 v[56:71], v[32:35], v[88:95], v5
    v_exp_f32 v100, v100
    v_exp_f32 v101, v101
    v_exp_f32 v102, v102
    v_smfmac_f32_16x16x64_bf16 v[12:15], v[8:11], v[88:95], v5
    v_exp_f32 v103, v103
    s_nop 1
    v_exp_f32 v72, v72
    v_exp_f32 v73, v73
    s_waitcnt lgkmcnt(2)
    v_smfmac_f32_32x32x32_bf16 v[56:71], v[36:39], v[96:103], v5
    s_waitcnt vmcnt(6)
    s_waitcnt lgkmcnt(0)
    s_barrier
    s_setprio 3
    ds_read_b128 v[32:35], v2 offset:2048
    ds_read_b128 v[36:39], v2 offset:3072
    v_exp_f32 v74, v74
    s_add_u32 m0, s59, 98304
    s_nop 0
    buffer_load_dwordx4 v118, s[44:47], s93 offen offset:0 lds
    v_exp_f32 v75, v75
    v_exp_f32 v76, v76
    v_smfmac_f32_16x16x64_bf16 v[12:15], v[8:11], v[96:103], v5
    s_add_u32 m0, s52, 65536
    s_add_u32 s73, s98, 139264
    s_xor_b32 s73, s73, s31
    buffer_load_dwordx4 v4, s[40:43], s73 offen offset:0 sc1 lds
    v_exp_f32 v77, v77
    v_exp_f32 v78, v78
    v_mfma_f32_32x32x16_bf16 v[88:103], v[24:27], v[16:19], v[40:55]
    ds_read_b128 v[24:27], v2 offset:0
    v_exp_f32 v79, v79
    v_exp_f32 v80, v80
    v_exp_f32 v81, v81
    s_add_u32 m0, s59, 98304
    s_nop 0
    buffer_load_dwordx4 v119, s[44:47], s93 offen offset:1024 lds
    v_mfma_f32_32x32x16_bf16 v[88:103], v[28:31], v[20:23], v[88:103]
    ds_read_b128 v[28:31], v2 offset:1024
    v_exp_f32 v82, v82
    v_exp_f32 v83, v83
    s_waitcnt lgkmcnt(3)
    v_smfmac_f32_32x32x32_bf16 v[56:71], v[32:35], v[72:79], v5
    ds_read_b128 v[32:35], v2 offset:10240
    v_exp_f32 v84, v84
    v_exp_f32 v85, v85
    v_exp_f32 v86, v86
    v_smfmac_f32_16x16x64_bf16 v[12:15], v[8:11], v[72:79], v5
    v_exp_f32 v87, v87
    s_nop 0
    v_exp_f32 v88, v88
    s_waitcnt vmcnt(4)
    buffer_store_dwordx2 v[116:117], v122, s[36:39], s83 offen sc1
    v_exp_f32 v89, v89
    s_waitcnt lgkmcnt(3)
    v_smfmac_f32_32x32x32_bf16 v[56:71], v[36:39], v[80:87], v5
    s_setprio 2
    ds_read_b128 v[36:39], v2 offset:11264
    v_exp_f32 v90, v90
    v_exp_f32 v91, v91
    v_exp_f32 v92, v92
    v_smfmac_f32_16x16x64_bf16 v[12:15], v[8:11], v[80:87], v5
    s_add_u32 m0, s52, 65536
    s_nop 0
    buffer_load_dwordx4 v4, s[40:43], s73 offen offset:1024 sc1 lds
    v_exp_f32 v93, v93
    s_add_u32 m0, s59, 98304
    s_nop 0
    buffer_load_dwordx4 v120, s[44:47], s93 offen offset:2048 lds
    v_exp_f32 v94, v94
    s_waitcnt lgkmcnt(3)
    v_mfma_f32_32x32x16_bf16 v[72:87], v[24:27], v[16:19], v[40:55]
    ds_read_b128 v[24:27], v2 offset:8192
    v_exp_f32 v95, v95
    v_exp_f32 v96, v96
    v_exp_f32 v97, v97
    s_waitcnt lgkmcnt(3)
    v_mfma_f32_32x32x16_bf16 v[72:87], v[28:31], v[20:23], v[72:87]
    ds_read_b128 v[28:31], v2 offset:9216
    v_exp_f32 v98, v98
    buffer_load_dwordx4 v121, s[44:47], s93 offen offset:3072 lds
    v_exp_f32 v99, v99
    s_waitcnt lgkmcnt(3)
    v_smfmac_f32_32x32x32_bf16 v[56:71], v[32:35], v[88:95], v5
    ds_read_b128 v[32:35], v2 offset:18432
    v_exp_f32 v100, v100
    v_exp_f32 v101, v101
    v_exp_f32 v102, v102
    v_smfmac_f32_16x16x64_bf16 v[12:15], v[8:11], v[88:95], v5
    v_exp_f32 v103, v103
    v_exp_f32 v72, v72
    s_add_u32 m0, s59, 130816
    s_nop 0
    buffer_load_dwordx4 v118, s[44:47], s93 offen offset:256 lds
    v_exp_f32 v73, v73
    s_waitcnt lgkmcnt(3)
    v_smfmac_f32_32x32x32_bf16 v[56:71], v[36:39], v[96:103], v5
    s_setprio 1
    ds_read_b128 v[36:39], v2 offset:19456
    v_exp_f32 v74, v74
    v_exp_f32 v75, v75
    v_exp_f32 v76, v76
    v_smfmac_f32_16x16x64_bf16 v[12:15], v[8:11], v[96:103], v5
    s_add_u32 m0, s52, 65536
    s_xor_b32 s73, s74, 131072
    buffer_load_dwordx4 v4, s[40:43], s73 offen offset:2048 sc1 lds
    v_exp_f32 v77, v77
    s_add_u32 m0, s59, 130816
    s_nop 0
    buffer_load_dwordx4 v119, s[44:47], s93 offen offset:1280 lds
    v_exp_f32 v78, v78
    s_waitcnt lgkmcnt(3)
    v_mfma_f32_32x32x16_bf16 v[88:103], v[24:27], v[16:19], v[40:55]
    ds_read_b128 v[24:27], v2 offset:16384
    v_exp_f32 v79, v79
    v_exp_f32 v80, v80
    v_exp_f32 v81, v81
    s_waitcnt lgkmcnt(3)
    v_mfma_f32_32x32x16_bf16 v[88:103], v[28:31], v[20:23], v[88:103]
    ds_read_b128 v[28:31], v2 offset:17408
    v_exp_f32 v82, v82
    buffer_store_dwordx2 v[116:117], v122, s[36:39], s78 offen sc1
    v_exp_f32 v83, v83
    s_waitcnt lgkmcnt(3)
    v_smfmac_f32_32x32x32_bf16 v[56:71], v[32:35], v[72:79], v5
    ds_read_b128 v[32:35], v2 offset:26624
    v_exp_f32 v84, v84
    v_exp_f32 v85, v85
    v_exp_f32 v86, v86
    v_smfmac_f32_16x16x64_bf16 v[12:15], v[8:11], v[72:79], v5
    v_exp_f32 v87, v87
    v_exp_f32 v88, v88
    buffer_load_dwordx4 v120, s[44:47], s93 offen offset:2304 lds
    v_exp_f32 v89, v89
    s_waitcnt lgkmcnt(3)
    v_smfmac_f32_32x32x32_bf16 v[56:71], v[36:39], v[80:87], v5
    s_setprio 0
    ds_read_b128 v[36:39], v2 offset:27648
    v_exp_f32 v90, v90
    v_exp_f32 v91, v91
    v_exp_f32 v92, v92
    v_smfmac_f32_16x16x64_bf16 v[12:15], v[8:11], v[80:87], v5
    s_add_u32 m0, s52, 65536
    s_nop 0
    buffer_load_dwordx4 v4, s[40:43], s73 offen offset:3072 sc1 lds
    v_exp_f32 v93, v93
    v_exp_f32 v94, v94
    s_waitcnt lgkmcnt(3)
    v_mfma_f32_32x32x16_bf16 v[72:87], v[24:27], v[16:19], v[40:55]
    ds_read_b128 v[24:27], v2 offset:24576
    v_exp_f32 v95, v95
    v_exp_f32 v96, v96
    s_add_u32 m0, s59, 130816
    s_nop 0
    buffer_load_dwordx4 v121, s[44:47], s93 offen offset:3328 lds
    v_exp_f32 v97, v97
    s_waitcnt lgkmcnt(3)
    v_mfma_f32_32x32x16_bf16 v[72:87], v[28:31], v[20:23], v[72:87]
    ds_read_b128 v[28:31], v2 offset:25600
    v_exp_f32 v98, v98
    v_exp_f32 v99, v99
    s_waitcnt lgkmcnt(3)
    v_smfmac_f32_32x32x32_bf16 v[56:71], v[32:35], v[88:95], v5
    v_exp_f32 v100, v100
    v_exp_f32 v101, v101
    v_exp_f32 v102, v102
    v_smfmac_f32_16x16x64_bf16 v[12:15], v[8:11], v[88:95], v5
    v_exp_f32 v103, v103
    s_nop 1
    v_exp_f32 v72, v72
    v_exp_f32 v73, v73
    s_waitcnt lgkmcnt(2)
    v_smfmac_f32_32x32x32_bf16 v[56:71], v[36:39], v[96:103], v5
    s_waitcnt vmcnt(14)
    s_waitcnt lgkmcnt(0)
    s_barrier
    s_setprio 3
    ds_read_b128 v[32:35], v2 offset:34816
    ds_read_b128 v[36:39], v2 offset:35840
    v_exp_f32 v74, v74
    s_or_b32 s53, s57, s54
    v_exp_f32 v75, v75
    v_exp_f32 v76, v76
    v_smfmac_f32_16x16x64_bf16 v[12:15], v[8:11], v[96:103], v5
    s_add_u32 m0, s52, 0
    s_add_u32 s73, s98, 155648
    s_xor_b32 s73, s73, s31
    buffer_load_dwordx4 v4, s[40:43], s73 offen offset:0 sc1 lds
    v_exp_f32 v77, v77
    v_exp_f32 v78, v78
    v_mfma_f32_32x32x16_bf16 v[88:103], v[24:27], v[16:19], v[40:55]
    ds_read_b128 v[24:27], v2 offset:32768
    v_exp_f32 v79, v79
    v_exp_f32 v80, v80
    v_exp_f32 v81, v81
    buffer_load_dwordx2 v[106:107], v124, s[36:39], s86 offen sc1
    v_mfma_f32_32x32x16_bf16 v[88:103], v[28:31], v[20:23], v[88:103]
    ds_read_b128 v[28:31], v2 offset:33792
    v_exp_f32 v82, v82
    v_exp_f32 v83, v83
    s_waitcnt lgkmcnt(3)
    v_smfmac_f32_32x32x32_bf16 v[56:71], v[32:35], v[72:79], v5
    ds_read_b128 v[32:35], v2 offset:43008
    v_exp_f32 v84, v84
    v_exp_f32 v85, v85
    v_exp_f32 v86, v86
    v_smfmac_f32_16x16x64_bf16 v[12:15], v[8:11], v[72:79], v5
    v_exp_f32 v87, v87
    s_nop 0
    v_exp_f32 v88, v88
    v_exp_f32 v89, v89
    s_waitcnt lgkmcnt(3)
    v_smfmac_f32_32x32x32_bf16 v[56:71], v[36:39], v[80:87], v5
    s_setprio 2
    ds_read_b128 v[36:39], v2 offset:44032
    v_exp_f32 v90, v90
    v_exp_f32 v91, v91
    v_exp_f32 v92, v92
    v_smfmac_f32_16x16x64_bf16 v[12:15], v[8:11], v[80:87], v5
    buffer_load_dwordx4 v4, s[40:43], s73 offen offset:1024 sc1 lds
    v_exp_f32 v93, v93
    v_exp_f32 v94, v94
    s_waitcnt lgkmcnt(3)
    v_mfma_f32_32x32x16_bf16 v[72:87], v[24:27], v[16:19], v[40:55]
    ds_read_b128 v[24:27], v2 offset:40960
    v_exp_f32 v95, v95
    v_exp_f32 v96, v96
    v_exp_f32 v97, v97
    s_waitcnt lgkmcnt(3)
    v_mfma_f32_32x32x16_bf16 v[72:87], v[28:31], v[20:23], v[72:87]
    ds_read_b128 v[28:31], v2 offset:41984
    v_exp_f32 v98, v98
    v_exp_f32 v99, v99
    s_waitcnt lgkmcnt(3)
    v_smfmac_f32_32x32x32_bf16 v[56:71], v[32:35], v[88:95], v5
    ds_read_b128 v[32:35], v3 offset:2048
    v_exp_f32 v100, v100
    v_exp_f32 v101, v101
    v_exp_f32 v102, v102
    v_smfmac_f32_16x16x64_bf16 v[12:15], v[8:11], v[88:95], v5
    v_exp_f32 v103, v103
    s_nop 0
    v_exp_f32 v72, v72
    v_exp_f32 v73, v73
    s_waitcnt lgkmcnt(3)
    v_smfmac_f32_32x32x32_bf16 v[56:71], v[36:39], v[96:103], v5
    s_setprio 1
    ds_read_b128 v[36:39], v3 offset:3072
    v_exp_f32 v74, v74
    v_exp_f32 v75, v75
    v_exp_f32 v76, v76
    v_smfmac_f32_16x16x64_bf16 v[12:15], v[8:11], v[96:103], v5
    s_xor_b32 s73, s74, 147456
    buffer_load_dwordx4 v4, s[40:43], s73 offen offset:2048 sc1 lds
    v_exp_f32 v77, v77
    v_exp_f32 v78, v78
    s_waitcnt lgkmcnt(3)
    v_mfma_f32_32x32x16_bf16 v[88:103], v[24:27], v[16:19], v[40:55]
    ds_read_b128 v[24:27], v3 offset:0
    v_exp_f32 v79, v79
    v_exp_f32 v80, v80
    v_exp_f32 v81, v81
    s_waitcnt lgkmcnt(3)
    v_mfma_f32_32x32x16_bf16 v[88:103], v[28:31], v[20:23], v[88:103]
    ds_read_b128 v[28:31], v3 offset:1024
    v_exp_f32 v82, v82
    v_exp_f32 v83, v83
    s_waitcnt lgkmcnt(3)
    v_smfmac_f32_32x32x32_bf16 v[56:71], v[32:35], v[72:79], v5
    ds_read_b128 v[32:35], v3 offset:10240
    v_exp_f32 v84, v84
    v_exp_f32 v85, v85
    v_exp_f32 v86, v86
    v_smfmac_f32_16x16x64_bf16 v[12:15], v[8:11], v[72:79], v5
    v_exp_f32 v87, v87
    s_nop 0
    v_exp_f32 v88, v88
    s_waitcnt vmcnt(2)
    v_cmp_eq_u64 vcc, s[32:33], v[106:107]
    s_cmp_eq_u64 vcc, -1
    s_cbranch_scc0 CK2_O
CK2_B:
    v_exp_f32 v89, v89
    s_waitcnt lgkmcnt(3)
    v_smfmac_f32_32x32x32_bf16 v[56:71], v[36:39], v[80:87], v5
    s_setprio 0
    ds_read_b128 v[36:39], v3 offset:11264
    v_exp_f32 v90, v90
    v_exp_f32 v91, v91
    v_exp_f32 v92, v92
    v_smfmac_f32_16x16x64_bf16 v[12:15], v[8:11], v[80:87], v5
    buffer_load_dwordx4 v4, s[40:43], s73 offen offset:3072 sc1 lds
    v_exp_f32 v93, v93
    buffer_load_dwordx4 v[192:195], v1, s[36:39], s85 offen offset:0 sc1
    v_exp_f32 v94, v94
    s_waitcnt lgkmcnt(3)
    v_mfma_f32_32x32x16_bf16 v[72:87], v[24:27], v[16:19], v[40:55]
    ds_read_b128 v[24:27], v3 offset:8192
    v_exp_f32 v95, v95
    v_exp_f32 v96, v96
    v_exp_f32 v97, v97
    s_waitcnt lgkmcnt(3)
    v_mfma_f32_32x32x16_bf16 v[72:87], v[28:31], v[20:23], v[72:87]
    ds_read_b128 v[28:31], v3 offset:9216
    v_exp_f32 v98, v98
    buffer_load_dwordx4 v[196:199], v1, s[36:39], s85 offen offset:1024 sc1
    v_exp_f32 v99, v99
    s_waitcnt lgkmcnt(3)
    v_smfmac_f32_32x32x32_bf16 v[56:71], v[32:35], v[88:95], v5
    v_exp_f32 v100, v100
    v_exp_f32 v101, v101
    v_exp_f32 v102, v102
    v_smfmac_f32_16x16x64_bf16 v[12:15], v[8:11], v[88:95], v5
    v_exp_f32 v103, v103
    s_nop 0
    v_exp_f32 v72, v72
    v_exp_f32 v73, v73
    s_waitcnt lgkmcnt(2)
    v_smfmac_f32_32x32x32_bf16 v[56:71], v[36:39], v[96:103], v5
    s_waitcnt lgkmcnt(0)
    s_barrier
    s_setprio 3
    ds_read_b128 v[32:35], v3 offset:18432
    ds_read_b128 v[36:39], v3 offset:19456
    v_exp_f32 v74, v74
    buffer_load_dwordx4 v[200:203], v1, s[36:39], s85 offen offset:2048 sc1
    v_exp_f32 v75, v75
    v_exp_f32 v76, v76
    v_smfmac_f32_16x16x64_bf16 v[12:15], v[8:11], v[96:103], v5
    s_add_u32 m0, s52, 32768
    s_add_u32 s73, s98, 172032
    s_xor_b32 s73, s73, s31
    buffer_load_dwordx4 v4, s[40:43], s73 offen offset:0 sc1 lds
    v_exp_f32 v77, v77
    v_exp_f32 v78, v78
    v_mfma_f32_32x32x16_bf16 v[88:103], v[24:27], v[16:19], v[40:55]
    ds_read_b128 v[24:27], v3 offset:16384
    v_exp_f32 v79, v79
    v_exp_f32 v80, v80
    v_exp_f32 v81, v81
    buffer_load_dwordx4 v[204:207], v1, s[36:39], s85 offen offset:3072 sc1
    v_mfma_f32_32x32x16_bf16 v[88:103], v[28:31], v[20:23], v[88:103]
    ds_read_b128 v[28:31], v3 offset:17408
    v_exp_f32 v82, v82
    v_exp_f32 v83, v83
    s_waitcnt lgkmcnt(3)
    v_smfmac_f32_32x32x32_bf16 v[56:71], v[32:35], v[72:79], v5
    ds_read_b128 v[32:35], v3 offset:26624
    v_exp_f32 v84, v84
    v_exp_f32 v85, v85
    v_exp_f32 v86, v86
    v_smfmac_f32_16x16x64_bf16 v[12:15], v[8:11], v[72:79], v5
    v_exp_f32 v87, v87
    s_nop 0
    v_exp_f32 v88, v88
    s_add_u32 s85, s85, 4096
    buffer_load_dwordx4 v[208:211], v1, s[36:39], s85 offen offset:0 sc1
    v_exp_f32 v89, v89
    s_waitcnt lgkmcnt(3)
    v_smfmac_f32_32x32x32_bf16 v[56:71], v[36:39], v[80:87], v5
    s_setprio 2
    ds_read_b128 v[36:39], v3 offset:27648
    v_exp_f32 v90, v90
    v_exp_f32 v91, v91
    v_exp_f32 v92, v92
    v_smfmac_f32_16x16x64_bf16 v[12:15], v[8:11], v[80:87], v5
    buffer_load_dwordx4 v4, s[40:43], s73 offen offset:1024 sc1 lds
    v_exp_f32 v93, v93
    v_exp_f32 v94, v94
    s_waitcnt lgkmcnt(3)
    v_mfma_f32_32x32x16_bf16 v[72:87], v[24:27], v[16:19], v[40:55]
    ds_read_b128 v[24:27], v3 offset:24576
    v_exp_f32 v95, v95
    v_exp_f32 v96, v96
    buffer_load_dwordx4 v[212:215], v1, s[36:39], s85 offen offset:1024 sc1
    v_exp_f32 v97, v97
    s_waitcnt lgkmcnt(3)
    v_mfma_f32_32x32x16_bf16 v[72:87], v[28:31], v[20:23], v[72:87]
    ds_read_b128 v[28:31], v3 offset:25600
    v_exp_f32 v98, v98
    v_exp_f32 v99, v99
    s_waitcnt lgkmcnt(3)
    v_smfmac_f32_32x32x32_bf16 v[56:71], v[32:35], v[88:95], v5
    ds_read_b128 v[32:35], v3 offset:34816
    v_exp_f32 v100, v100
    v_exp_f32 v101, v101
    v_exp_f32 v102, v102
    v_smfmac_f32_16x16x64_bf16 v[12:15], v[8:11], v[88:95], v5
    v_exp_f32 v103, v103
    s_nop 0
    v_exp_f32 v72, v72
    buffer_load_dwordx4 v[216:219], v1, s[36:39], s85 offen offset:2048 sc1
    v_exp_f32 v73, v73
    s_waitcnt lgkmcnt(3)
    v_smfmac_f32_32x32x32_bf16 v[56:71], v[36:39], v[96:103], v5
    s_setprio 1
    ds_read_b128 v[36:39], v3 offset:35840
    v_exp_f32 v74, v74
    v_exp_f32 v75, v75
    v_exp_f32 v76, v76
    v_smfmac_f32_16x16x64_bf16 v[12:15], v[8:11], v[96:103], v5
    s_xor_b32 s73, s74, 163840
    buffer_load_dwordx4 v4, s[40:43], s73 offen offset:2048 sc1 lds
    v_exp_f32 v77, v77
    v_exp_f32 v78, v78
    s_waitcnt lgkmcnt(3)
    v_mfma_f32_32x32x16_bf16 v[88:103], v[24:27], v[16:19], v[40:55]
    ds_read_b128 v[24:27], v3 offset:32768
    v_exp_f32 v79, v79
    v_exp_f32 v80, v80
    buffer_load_dwordx4 v[220:223], v1, s[36:39], s85 offen offset:3072 sc1
    v_exp_f32 v81, v81
    s_waitcnt lgkmcnt(3)
    v_mfma_f32_32x32x16_bf16 v[88:103], v[28:31], v[20:23], v[88:103]
    ds_read_b128 v[28:31], v3 offset:33792
    v_exp_f32 v82, v82
    v_exp_f32 v83, v83
    s_waitcnt lgkmcnt(3)
    v_smfmac_f32_32x32x32_bf16 v[56:71], v[32:35], v[72:79], v5
    ds_read_b128 v[32:35], v3 offset:43008
    v_exp_f32 v84, v84
    v_exp_f32 v85, v85
    v_exp_f32 v86, v86
    v_smfmac_f32_16x16x64_bf16 v[12:15], v[8:11], v[72:79], v5
    v_exp_f32 v87, v87
    s_nop 0
    v_exp_f32 v88, v88
    s_add_u32 s85, s85, 4096
    buffer_load_dwordx4 v[224:227], v1, s[36:39], s85 offen offset:0 sc1
    v_exp_f32 v89, v89
    s_waitcnt lgkmcnt(3)
    v_smfmac_f32_32x32x32_bf16 v[56:71], v[36:39], v[80:87], v5
    s_setprio 0
    ds_read_b128 v[36:39], v3 offset:44032
    v_exp_f32 v90, v90
    v_exp_f32 v91, v91
    v_exp_f32 v92, v92
    v_smfmac_f32_16x16x64_bf16 v[12:15], v[8:11], v[80:87], v5
    buffer_load_dwordx4 v4, s[40:43], s73 offen offset:3072 sc1 lds
    v_exp_f32 v93, v93
    v_exp_f32 v94, v94
    s_waitcnt lgkmcnt(3)
    v_mfma_f32_32x32x16_bf16 v[72:87], v[24:27], v[16:19], v[40:55]
    ds_read_b128 v[24:27], v3 offset:40960
    v_exp_f32 v95, v95
    v_exp_f32 v96, v96
    buffer_load_dwordx4 v[228:231], v1, s[36:39], s85 offen offset:1024 sc1
    v_exp_f32 v97, v97
    s_waitcnt lgkmcnt(3)
    v_mfma_f32_32x32x16_bf16 v[72:87], v[28:31], v[20:23], v[72:87]
    ds_read_b128 v[28:31], v3 offset:41984
    v_exp_f32 v98, v98
    v_exp_f32 v99, v99
    s_waitcnt lgkmcnt(3)
    v_smfmac_f32_32x32x32_bf16 v[56:71], v[32:35], v[88:95], v5
    v_exp_f32 v100, v100
    v_exp_f32 v101, v101
    v_exp_f32 v102, v102
    v_smfmac_f32_16x16x64_bf16 v[12:15], v[8:11], v[88:95], v5
    v_exp_f32 v103, v103
    s_nop 1
    v_exp_f32 v72, v72
    v_exp_f32 v73, v73
    s_waitcnt lgkmcnt(2)
    v_smfmac_f32_32x32x32_bf16 v[56:71], v[36:39], v[96:103], v5
    s_waitcnt vmcnt(14)
    s_waitcnt lgkmcnt(0)
    s_barrier
    s_setprio 3
    ds_read_b128 v[32:35], v2 offset:2048
    ds_read_b128 v[36:39], v2 offset:3072
    v_exp_f32 v74, v74
    ds_read_b128 v[144:147], v156 offset:0
    v_exp_f32 v75, v75
    v_exp_f32 v76, v76
    v_smfmac_f32_16x16x64_bf16 v[12:15], v[8:11], v[96:103], v5
    s_add_u32 m0, s52, 65536
    s_add_u32 s73, s98, 188416
    s_xor_b32 s73, s73, s31
    buffer_load_dwordx4 v4, s[40:43], s73 offen offset:0 sc1 lds
    v_exp_f32 v77, v77
    ds_read_b128 v[148:151], v157 offset:0
    v_exp_f32 v78, v78
    v_mfma_f32_32x32x16_bf16 v[88:103], v[24:27], v[16:19], v[40:55]
    ds_read_b128 v[24:27], v2 offset:0
    v_exp_f32 v79, v79
    v_exp_f32 v80, v80
    v_exp_f32 v81, v81
    buffer_load_dwordx4 v[232:235], v1, s[36:39], s85 offen offset:2048 sc1
    v_mfma_f32_32x32x16_bf16 v[88:103], v[28:31], v[20:23], v[88:103]
    ds_read_b128 v[28:31], v2 offset:1024
    v_exp_f32 v82, v82
    v_exp_f32 v83, v83
    s_waitcnt lgkmcnt(5)
    v_smfmac_f32_32x32x32_bf16 v[56:71], v[32:35], v[72:79], v5
    ds_read_b128 v[32:35], v2 offset:10240
    v_exp_f32 v84, v84
    buffer_load_dwordx4 v[236:239], v1, s[36:39], s85 offen offset:3072 sc1
    v_exp_f32 v85, v85
    v_exp_f32 v86, v86
    v_smfmac_f32_16x16x64_bf16 v[12:15], v[8:11], v[72:79], v5
    s_waitcnt lgkmcnt(4)
    s_waitcnt vmcnt(16)
    v_mfma_f32_32x32x16_bf16 v[128:143], v[144:147], v[192:195], 0
    ds_read_b128 v[152:155], v158 offset:0
    v_exp_f32 v87, v87
    v_exp_f32 v88, v88
    buffer_load_dwordx2 v[190:191], v127, s[36:39], 0 offen sc1
    v_exp_f32 v89, v89
    v_smfmac_f32_32x32x32_bf16 v[56:71], v[36:39], v[80:87], v5
    s_setprio 2
    ds_read_b128 v[36:39], v2 offset:11264
    v_exp_f32 v90, v90
    v_exp_f32 v91, v91
    v_exp_f32 v92, v92
    v_smfmac_f32_16x16x64_bf16 v[12:15], v[8:11], v[80:87], v5
    buffer_load_dwordx4 v4, s[40:43], s73 offen offset:1024 sc1 lds
    v_exp_f32 v93, v93
    s_add_u32 s85, s85, 4096
    buffer_load_dwordx4 v[240:243], v1, s[36:39], s85 offen offset:0 sc1
    v_exp_f32 v94, v94
    s_waitcnt lgkmcnt(4)
    v_mfma_f32_32x32x16_bf16 v[72:87], v[24:27], v[16:19], v[40:55]
    ds_read_b128 v[24:27], v2 offset:8192
    v_exp_f32 v95, v95
    v_exp_f32 v96, v96
    v_exp_f32 v97, v97
    s_waitcnt lgkmcnt(4)
    v_mfma_f32_32x32x16_bf16 v[72:87], v[28:31], v[20:23], v[72:87]
    ds_read_b128 v[28:31], v2 offset:9216
    v_exp_f32 v98, v98
    buffer_load_dwordx4 v[244:247], v1, s[36:39], s85 offen offset:1024 sc1
    v_exp_f32 v99, v99
    s_waitcnt lgkmcnt(4)
    v_smfmac_f32_32x32x32_bf16 v[56:71], v[32:35], v[88:95], v5
    ds_read_b128 v[32:35], v2 offset:18432
    v_exp_f32 v100, v100
    v_exp_f32 v101, v101
    v_exp_f32 v102, v102
    v_smfmac_f32_16x16x64_bf16 v[12:15], v[8:11], v[88:95], v5
    s_waitcnt vmcnt(19)
    v_mfma_f32_32x32x16_bf16 v[128:143], v[148:151], v[196:199], v[128:143]
    ds_read_b128 v[144:147], v159 offset:0
    v_exp_f32 v103, v103
    v_exp_f32 v72, v72
    buffer_load_dwordx4 v[248:251], v1, s[36:39], s85 offen offset:2048 sc1
    v_exp_f32 v73, v73
    s_waitcnt lgkmcnt(4)
    v_smfmac_f32_32x32x32_bf16 v[56:71], v[36:39], v[96:103], v5
    s_setprio 1
    ds_read_b128 v[36:39], v2 offset:19456
    v_exp_f32 v74, v74
    v_exp_f32 v75, v75
    v_exp_f32 v76, v76
    v_smfmac_f32_16x16x64_bf16 v[12:15], v[8:11], v[96:103], v5
    s_xor_b32 s73, s74, 180224
    buffer_load_dwordx4 v4, s[40:43], s73 offen offset:2048 sc1 lds
    v_exp_f32 v77, v77
    v_exp_f32 v78, v78
    s_waitcnt lgkmcnt(4)
    v_mfma_f32_32x32x16_bf16 v[88:103], v[24:27], v[16:19], v[40:55]
    ds_read_b128 v[24:27], v2 offset:16384
    v_exp_f32 v79, v79
    v_exp_f32 v80, v80
    buffer_load_dwordx4 v[252:255], v1, s[36:39], s85 offen offset:3072 sc1
    v_exp_f32 v81, v81
    s_waitcnt lgkmcnt(4)
    v_mfma_f32_32x32x16_bf16 v[88:103], v[28:31], v[20:23], v[88:103]
    ds_read_b128 v[28:31], v2 offset:17408
    v_exp_f32 v82, v82
    v_exp_f32 v83, v83
    s_waitcnt lgkmcnt(4)
    v_smfmac_f32_32x32x32_bf16 v[56:71], v[32:35], v[72:79], v5
    ds_read_b128 v[32:35], v2 offset:26624
    v_exp_f32 v84, v84
    v_exp_f32 v85, v85
    v_exp_f32 v86, v86
    v_smfmac_f32_16x16x64_bf16 v[12:15], v[8:11], v[72:79], v5
    s_waitcnt vmcnt(21)
    v_mfma_f32_32x32x16_bf16 v[128:143], v[152:155], v[200:203], v[128:143]
    ds_read_b128 v[148:151], v160 offset:0
    v_exp_f32 v87, v87
    v_exp_f32 v88, v88
    v_exp_f32 v89, v89
    s_waitcnt lgkmcnt(4)
    v_smfmac_f32_32x32x32_bf16 v[56:71], v[36:39], v[80:87], v5
    s_setprio 0
    ds_read_b128 v[36:39], v2 offset:27648
    v_exp_f32 v90, v90
    v_exp_f32 v91, v91
    v_exp_f32 v92, v92
    v_smfmac_f32_16x16x64_bf16 v[12:15], v[8:11], v[80:87], v5
    buffer_load_dwordx4 v4, s[40:43], s73 offen offset:3072 sc1 lds
    v_exp_f32 v93, v93
    v_exp_f32 v94, v94
    s_waitcnt lgkmcnt(4)
    v_mfma_f32_32x32x16_bf16 v[72:87], v[24:27], v[16:19], v[40:55]
    ds_read_b128 v[24:27], v2 offset:24576
    v_exp_f32 v95, v95
    v_exp_f32 v96, v96
    v_exp_f32 v97, v97
    s_waitcnt lgkmcnt(4)
    v_mfma_f32_32x32x16_bf16 v[72:87], v[28:31], v[20:23], v[72:87]
    ds_read_b128 v[28:31], v2 offset:25600
    v_exp_f32 v98, v98
    v_exp_f32 v99, v99
    s_waitcnt lgkmcnt(4)
    v_smfmac_f32_32x32x32_bf16 v[56:71], v[32:35], v[88:95], v5
    v_exp_f32 v100, v100
    v_exp_f32 v101, v101
    v_exp_f32 v102, v102
    v_smfmac_f32_16x16x64_bf16 v[12:15], v[8:11], v[88:95], v5
    s_waitcnt vmcnt(20)
    v_mfma_f32_32x32x16_bf16 v[128:143], v[144:147], v[204:207], v[128:143]
    ds_read_b128 v[152:155], v161 offset:0
    v_exp_f32 v103, v103
    v_exp_f32 v72, v72
    v_exp_f32 v73, v73
    s_waitcnt lgkmcnt(3)
    v_smfmac_f32_32x32x32_bf16 v[56:71], v[36:39], v[96:103], v5
    s_waitcnt vmcnt(12)
    s_waitcnt lgkmcnt(0)
    s_barrier
    s_setprio 3
    ds_read_b128 v[32:35], v2 offset:34816
    ds_read_b128 v[36:39], v2 offset:35840
    v_exp_f32 v74, v74
    v_exp_f32 v75, v75
    v_exp_f32 v76, v76
    v_smfmac_f32_16x16x64_bf16 v[12:15], v[8:11], v[96:103], v5
    s_add_u32 m0, s52, 0
    s_add_u32 s73, s98, 204800
    s_xor_b32 s73, s73, s31
    buffer_load_dwordx4 v4, s[40:43], s73 offen offset:0 sc1 lds
    v_exp_f32 v77, v77
    v_exp_f32 v78, v78
    v_mfma_f32_32x32x16_bf16 v[88:103], v[24:27], v[16:19], v[40:55]
    ds_read_b128 v[24:27], v2 offset:32768
    v_exp_f32 v79, v79
    v_exp_f32 v80, v80
    v_exp_f32 v81, v81
    v_mfma_f32_32x32x16_bf16 v[88:103], v[28:31], v[20:23], v[88:103]
    ds_read_b128 v[28:31], v2 offset:33792
    v_exp_f32 v82, v82
    v_exp_f32 v83, v83
    s_waitcnt lgkmcnt(3)
    v_smfmac_f32_32x32x32_bf16 v[56:71], v[32:35], v[72:79], v5
    ds_read_b128 v[32:35], v2 offset:43008
    v_exp_f32 v84, v84
    v_exp_f32 v85, v85
    v_exp_f32 v86, v86
    v_smfmac_f32_16x16x64_bf16 v[12:15], v[8:11], v[72:79], v5
    v_mfma_f32_32x32x16_bf16 v[128:143], v[148:151], v[208:211], v[128:143]
    ds_read_b128 v[144:147], v162 offset:0
    v_exp_f32 v87, v87
    v_exp_f32 v88, v88
    v_exp_f32 v89, v89
    s_waitcnt lgkmcnt(4)
    v_smfmac_f32_32x32x32_bf16 v[56:71], v[36:39], v[80:87], v5
    s_setprio 2
    ds_read_b128 v[36:39], v2 offset:44032
    v_exp_f32 v90, v90
    v_exp_f32 v91, v91
    v_exp_f32 v92, v92
    v_smfmac_f32_16x16x64_bf16 v[12:15], v[8:11], v[80:87], v5
    buffer_load_dwordx4 v4, s[40:43], s73 offen offset:1024 sc1 lds
    v_exp_f32 v93, v93
    v_exp_f32 v94, v94
    s_waitcnt lgkmcnt(4)
    v_mfma_f32_32x32x16_bf16 v[72:87], v[24:27], v[16:19], v[40:55]
    ds_read_b128 v[24:27], v2 offset:40960
    v_exp_f32 v95, v95
    v_exp_f32 v96, v96
    v_exp_f32 v97, v97
    s_waitcnt lgkmcnt(4)
    v_mfma_f32_32x32x16_bf16 v[72:87], v[28:31], v[20:23], v[72:87]
    ds_read_b128 v[28:31], v2 offset:41984
    v_exp_f32 v98, v98
    v_exp_f32 v99, v99
    s_waitcnt lgkmcnt(4)
    v_smfmac_f32_32x32x32_bf16 v[56:71], v[32:35], v[88:95], v5
    ds_read_b128 v[32:35], v3 offset:2048
    v_exp_f32 v100, v100
    v_exp_f32 v101, v101
    v_exp_f32 v102, v102
    v_smfmac_f32_16x16x64_bf16 v[12:15], v[8:11], v[88:95], v5
    v_mfma_f32_32x32x16_bf16 v[128:143], v[152:155], v[212:215], v[128:143]
    ds_read_b128 v[148:151], v163 offset:0
    v_exp_f32 v103, v103
    v_exp_f32 v72, v72
    s_waitcnt vmcnt(9)
    v_cmp_eq_u64 vcc, s[32:33], v[190:191]
    s_cmp_eq_u64 vcc, -1
    s_cbranch_scc0 CK3_O
CK3_B:
    v_exp_f32 v73, v73
    s_waitcnt lgkmcnt(4)
    v_smfmac_f32_32x32x32_bf16 v[56:71], v[36:39], v[96:103], v5
    s_setprio 1
    ds_read_b128 v[36:39], v3 offset:3072
    v_exp_f32 v74, v74
    v_exp_f32 v75, v75
    v_exp_f32 v76, v76
    v_smfmac_f32_16x16x64_bf16 v[12:15], v[8:11], v[96:103], v5
    s_xor_b32 s73, s74, 196608
    buffer_load_dwordx4 v4, s[40:43], s73 offen offset:2048 sc1 lds
    v_exp_f32 v77, v77
    buffer_load_dwordx4 v[180:183], v1, s[36:39], s88 offen sc1
    buffer_load_dword v188, v122, s[36:39], s89 offen sc1
    v_exp_f32 v78, v78
    s_waitcnt lgkmcnt(4)
    v_mfma_f32_32x32x16_bf16 v[88:103], v[24:27], v[16:19], v[40:55]
    ds_read_b128 v[24:27], v3 offset:0
    v_exp_f32 v79, v79
    v_exp_f32 v80, v80
    v_exp_f32 v81, v81
    s_waitcnt lgkmcnt(4)
    v_mfma_f32_32x32x16_bf16 v[88:103], v[28:31], v[20:23], v[88:103]
    ds_read_b128 v[28:31], v3 offset:1024
    v_exp_f32 v82, v82
    buffer_load_dword v105, v186, s[36:39], 0 offen sc1
    v_exp_f32 v83, v83
    s_waitcnt lgkmcnt(4)
    v_smfmac_f32_32x32x32_bf16 v[56:71], v[32:35], v[72:79], v5
    ds_read_b128 v[32:35], v3 offset:10240
    v_exp_f32 v84, v84
    v_exp_f32 v85, v85
    v_exp_f32 v86, v86
    v_smfmac_f32_16x16x64_bf16 v[12:15], v[8:11], v[72:79], v5
    v_mfma_f32_32x32x16_bf16 v[128:143], v[144:147], v[216:219], v[128:143]
    v_exp_f32 v87, v87
    v_exp_f32 v88, v88
    s_mov_b32 s48, s18
    s_mov_b32 s49, s19
    s_mov_b32 s50, 2097152
    buffer_load_dword v126, v187, s[48:51], s90 offen
    v_exp_f32 v89, v89
    s_waitcnt lgkmcnt(3)
    v_smfmac_f32_32x32x32_bf16 v[56:71], v[36:39], v[80:87], v5
    s_setprio 0
    ds_read_b128 v[36:39], v3 offset:11264
    v_exp_f32 v90, v90
    v_exp_f32 v91, v91
    v_exp_f32 v92, v92
    v_smfmac_f32_16x16x64_bf16 v[12:15], v[8:11], v[80:87], v5
    buffer_load_dwordx4 v4, s[40:43], s73 offen offset:3072 sc1 lds
    v_exp_f32 v93, v93
    v_exp_f32 v94, v94
    s_waitcnt lgkmcnt(3)
    v_mfma_f32_32x32x16_bf16 v[72:87], v[24:27], v[16:19], v[40:55]
    ds_read_b128 v[24:27], v3 offset:8192
    v_exp_f32 v95, v95
    v_exp_f32 v96, v96
    v_exp_f32 v97, v97
    s_waitcnt lgkmcnt(3)
    v_mfma_f32_32x32x16_bf16 v[72:87], v[28:31], v[20:23], v[72:87]
    ds_read_b128 v[28:31], v3 offset:9216
    v_exp_f32 v98, v98
    v_exp_f32 v99, v99
    s_waitcnt lgkmcnt(3)
    v_smfmac_f32_32x32x32_bf16 v[56:71], v[32:35], v[88:95], v5
    v_exp_f32 v100, v100
    v_exp_f32 v101, v101
    v_exp_f32 v102, v102
    v_smfmac_f32_16x16x64_bf16 v[12:15], v[8:11], v[88:95], v5
    v_mfma_f32_32x32x16_bf16 v[128:143], v[148:151], v[220:223], v[128:143]
    s_cmp_lg_u32 s53, 0
    s_cbranch_scc1 G2_NR0
    v_mfma_f32_16x16x32_bf16 v[168:171], v[164:167], v[192:195], 0
    v_mfma_f32_16x16x32_bf16 v[168:171], v[164:167], v[196:199], v[168:171]
    v_mfma_f32_16x16x32_bf16 v[168:171], v[164:167], v[200:203], v[168:171]
    v_mfma_f32_16x16x32_bf16 v[168:171], v[164:167], v[204:207], v[168:171]
    v_mfma_f32_16x16x32_bf16 v[168:171], v[164:167], v[208:211], v[168:171]
    v_mfma_f32_16x16x32_bf16 v[168:171], v[164:167], v[212:215], v[168:171]
    v_mfma_f32_16x16x32_bf16 v[168:171], v[164:167], v[216:219], v[168:171]
    v_mfma_f32_16x16x32_bf16 v[168:171], v[164:167], v[220:223], v[168:171]
G2_NR0:
    v_exp_f32 v103, v103
    v_exp_f32 v72, v72
    v_exp_f32 v73, v73
    s_waitcnt lgkmcnt(2)
    v_smfmac_f32_32x32x32_bf16 v[56:71], v[36:39], v[96:103], v5
    s_waitcnt vmcnt(8)
    s_waitcnt lgkmcnt(0)
    s_barrier
    s_setprio 3
    ds_read_b128 v[32:35], v3 offset:18432
    ds_read_b128 v[36:39], v3 offset:19456
    v_exp_f32 v74, v74
    ds_read_b128 v[152:155], v156 offset:32768
    v_exp_f32 v75, v75
    v_exp_f32 v76, v76
    v_smfmac_f32_16x16x64_bf16 v[12:15], v[8:11], v[96:103], v5
    s_add_u32 m0, s52, 32768
    s_add_u32 s73, s98, 221184
    s_xor_b32 s73, s73, s31
    buffer_load_dwordx4 v4, s[40:43], s73 offen offset:0 sc1 lds
    v_exp_f32 v77, v77
    v_exp_f32 v78, v78
    v_mfma_f32_32x32x16_bf16 v[88:103], v[24:27], v[16:19], v[40:55]
    ds_read_b128 v[24:27], v3 offset:16384
    v_exp_f32 v79, v79
    v_exp_f32 v80, v80
    v_exp_f32 v81, v81
    ds_read_b128 v[144:147], v157 offset:32768
    v_mfma_f32_32x32x16_bf16 v[88:103], v[28:31], v[20:23], v[88:103]
    ds_read_b128 v[28:31], v3 offset:17408
    v_exp_f32 v82, v82
    v_exp_f32 v83, v83
    s_waitcnt lgkmcnt(5)
    v_smfmac_f32_32x32x32_bf16 v[56:71], v[32:35], v[72:79], v5
    ds_read_b128 v[32:35], v3 offset:26624
    v_exp_f32 v84, v84
    v_exp_f32 v85, v85
    v_exp_f32 v86, v86
    v_smfmac_f32_16x16x64_bf16 v[12:15], v[8:11], v[72:79], v5
    s_waitcnt lgkmcnt(4)
    v_mfma_f32_32x32x16_bf16 v[128:143], v[152:155], v[224:227], v[128:143]
    ds_read_b128 v[148:151], v158 offset:32768
    v_exp_f32 v87, v87
    v_exp_f32 v88, v88
    buffer_load_dwordx2 v[106:107], v124, s[36:39], s91 offen sc1
    v_exp_f32 v89, v89
    v_smfmac_f32_32x32x32_bf16 v[56:71], v[36:39], v[80:87], v5
    s_setprio 2
    ds_read_b128 v[36:39], v3 offset:27648
    v_exp_f32 v90, v90
    v_exp_f32 v91, v91
    v_exp_f32 v92, v92
    v_smfmac_f32_16x16x64_bf16 v[12:15], v[8:11], v[80:87], v5
    buffer_load_dwordx4 v4, s[40:43], s73 offen offset:1024 sc1 lds
    v_exp_f32 v93, v93
    v_exp_f32 v94, v94
    s_waitcnt lgkmcnt(5)
    v_mfma_f32_32x32x16_bf16 v[72:87], v[24:27], v[16:19], v[40:55]
    ds_read_b128 v[24:27], v3 offset:24576
    v_exp_f32 v95, v95
    v_exp_f32 v96, v96
    v_exp_f32 v97, v97
    s_waitcnt lgkmcnt(4)
    v_mfma_f32_32x32x16_bf16 v[72:87], v[28:31], v[20:23], v[72:87]
    ds_read_b128 v[28:31], v3 offset:25600
    v_exp_f32 v98, v98
    v_exp_f32 v99, v99
    s_waitcnt lgkmcnt(4)
    v_smfmac_f32_32x32x32_bf16 v[56:71], v[32:35], v[88:95], v5
    ds_read_b128 v[32:35], v3 offset:34816
    v_exp_f32 v100, v100
    v_exp_f32 v101, v101
    v_exp_f32 v102, v102
    v_smfmac_f32_16x16x64_bf16 v[12:15], v[8:11], v[88:95], v5
    v_mfma_f32_32x32x16_bf16 v[128:143], v[144:147], v[228:231], v[128:143]
    ds_read_b128 v[152:155], v159 offset:32768
    v_exp_f32 v103, v103
    v_exp_f32 v72, v72
    s_waitcnt vmcnt(6)
    s_cmp_eq_u32 s99, 0x10000
    s_cbranch_scc1 CJ0
    s_lshr_b32 s3, s99, 1
    s_lshl_b32 s3, s3, 31
    v_xor_b32 v188, s3, v188
    v_mov_b32 v190, 0
    v_dot2_f32_bf16 v190, v172, v180, v190
    v_dot2_f32_bf16 v190, v173, v181, v190
    v_dot2_f32_bf16 v190, v174, v182, v190
    v_dot2_f32_bf16 v190, v175, v183, v190
    s_nop 2
    v_add_f32_dpp v190, v190, v190 row_shr:1 row_mask:0xf bank_mask:0xf bound_ctrl:0
    s_nop 1
    v_add_f32_dpp v190, v190, v190 row_shr:2 row_mask:0xf bank_mask:0xf bound_ctrl:0
    s_nop 1
    v_add_f32_dpp v190, v190, v190 row_shr:4 row_mask:0xf bank_mask:0xf bound_ctrl:0
    s_nop 1
    v_add_f32_dpp v190, v190, v190 row_shr:8 row_mask:0xf bank_mask:0xf bound_ctrl:0
    s_nop 1
    v_add_f32_dpp v190, v190, v190 row_bcast:15 row_mask:0xa bank_mask:0xf
    s_nop 1
    v_add_f32_dpp v190, v190, v190 row_bcast:31 row_mask:0xc bank_mask:0xf
    v_add_f32 v190, v190, v188
    v_cvt_pk_bf16_f32 v190, v190, v190
CJ0:
    s_mov_b32 s48, s20
    s_mov_b32 s49, s21
    s_mov_b32 s50, 8388608
    s_lshl_b32 s3, s99, 12
    s_add_u32 s100, s3, 1024
    s_sub_u32 s3, 8389632, s3
    buffer_store_short v190, v189, s[48:51], s100 offen
    buffer_store_short v190, v189, s[48:51], s3 offen
    v_exp_f32 v73, v73
    s_waitcnt lgkmcnt(4)
    v_smfmac_f32_32x32x32_bf16 v[56:71], v[36:39], v[96:103], v5
    s_setprio 1
    ds_read_b128 v[36:39], v3 offset:35840
    v_exp_f32 v74, v74
    v_exp_f32 v75, v75
    v_exp_f32 v76, v76
    v_smfmac_f32_16x16x64_bf16 v[12:15], v[8:11], v[96:103], v5
    s_xor_b32 s73, s74, 212992
    buffer_load_dwordx4 v4, s[40:43], s73 offen offset:2048 sc1 lds
    v_exp_f32 v77, v77
    v_exp_f32 v78, v78
    s_waitcnt lgkmcnt(4)
    v_mfma_f32_32x32x16_bf16 v[88:103], v[24:27], v[16:19], v[40:55]
    ds_read_b128 v[24:27], v3 offset:32768
    v_exp_f32 v79, v79
    v_exp_f32 v80, v80
    s_mov_b32 s44, s18
    s_mov_b32 s45, s19
    s_mov_b32 s46, 2097152
    s_lshl_b32 s59, s26, 12
    v_exp_f32 v81, v81
    s_waitcnt lgkmcnt(4)
    v_mfma_f32_32x32x16_bf16 v[88:103], v[28:31], v[20:23], v[88:103]
    ds_read_b128 v[28:31], v3 offset:33792
    v_exp_f32 v82, v82
    v_exp_f32 v83, v83
    s_waitcnt lgkmcnt(4)
    v_smfmac_f32_32x32x32_bf16 v[56:71], v[32:35], v[72:79], v5
    ds_read_b128 v[32:35], v3 offset:43008
    v_exp_f32 v84, v84
    v_exp_f32 v85, v85
    v_exp_f32 v86, v86
    v_smfmac_f32_16x16x64_bf16 v[12:15], v[8:11], v[72:79], v5
    v_mfma_f32_32x32x16_bf16 v[128:143], v[148:151], v[232:235], v[128:143]
    ds_read_b128 v[144:147], v160 offset:32768
    v_exp_f32 v87, v87
    v_exp_f32 v88, v88
    v_exp_f32 v89, v89
    s_waitcnt lgkmcnt(4)
    v_smfmac_f32_32x32x32_bf16 v[56:71], v[36:39], v[80:87], v5
    s_setprio 0
    ds_read_b128 v[36:39], v3 offset:44032
    v_exp_f32 v90, v90
    v_exp_f32 v91, v91
    v_exp_f32 v92, v92
    v_smfmac_f32_16x16x64_bf16 v[12:15], v[8:11], v[80:87], v5
    buffer_load_dwordx4 v4, s[40:43], s73 offen offset:3072 sc1 lds
    v_exp_f32 v93, v93
    v_exp_f32 v94, v94
    s_waitcnt lgkmcnt(4)
    v_mfma_f32_32x32x16_bf16 v[72:87], v[24:27], v[16:19], v[40:55]
    ds_read_b128 v[24:27], v3 offset:40960
    v_exp_f32 v95, v95
    v_exp_f32 v96, v96
    v_exp_f32 v97, v97
    s_waitcnt lgkmcnt(4)
    v_mfma_f32_32x32x16_bf16 v[72:87], v[28:31], v[20:23], v[72:87]
    ds_read_b128 v[28:31], v3 offset:41984
    v_exp_f32 v98, v98
    v_exp_f32 v99, v99
    s_waitcnt lgkmcnt(4)
    v_smfmac_f32_32x32x32_bf16 v[56:71], v[32:35], v[88:95], v5
    v_exp_f32 v100, v100
    v_exp_f32 v101, v101
    v_exp_f32 v102, v102
    v_smfmac_f32_16x16x64_bf16 v[12:15], v[8:11], v[88:95], v5
    v_mfma_f32_32x32x16_bf16 v[128:143], v[152:155], v[236:239], v[128:143]
    ds_read_b128 v[148:151], v161 offset:32768
    v_exp_f32 v103, v103
    v_exp_f32 v72, v72
    v_exp_f32 v73, v73
    s_waitcnt lgkmcnt(3)
    v_smfmac_f32_32x32x32_bf16 v[56:71], v[36:39], v[96:103], v5
    s_waitcnt vmcnt(7)
    s_waitcnt lgkmcnt(0)
    s_barrier
    s_setprio 3
    ds_read_b128 v[32:35], v2 offset:2048
    ds_read_b128 v[36:39], v2 offset:3072
    v_exp_f32 v74, v74
    s_add_u32 m0, s59, 98304
    s_nop 0
    buffer_load_dwordx4 v176, s[44:47], s75 offen offset:0 lds
    v_exp_f32 v75, v75
    v_exp_f32 v76, v76
    v_smfmac_f32_16x16x64_bf16 v[12:15], v[8:11], v[96:103], v5
    s_add_u32 m0, s52, 65536
    s_add_u32 s73, s98, 237568
    s_xor_b32 s73, s73, s31
    buffer_load_dwordx4 v4, s[40:43], s73 offen offset:0 sc1 lds
    v_exp_f32 v77, v77
    v_exp_f32 v78, v78
    v_mfma_f32_32x32x16_bf16 v[88:103], v[24:27], v[16:19], v[40:55]
    ds_read_b128 v[24:27], v2 offset:0
    v_exp_f32 v79, v79
    v_exp_f32 v80, v80
    v_exp_f32 v81, v81
    s_add_u32 m0, s59, 98304
    s_nop 0
    buffer_load_dwordx4 v177, s[44:47], s75 offen offset:1024 lds
    v_mfma_f32_32x32x16_bf16 v[88:103], v[28:31], v[20:23], v[88:103]
    ds_read_b128 v[28:31], v2 offset:1024
    v_exp_f32 v82, v82
    v_exp_f32 v83, v83
    s_waitcnt lgkmcnt(3)
    v_smfmac_f32_32x32x32_bf16 v[56:71], v[32:35], v[72:79], v5
    ds_read_b128 v[32:35], v2 offset:10240
    v_exp_f32 v84, v84
    v_exp_f32 v85, v85
    v_exp_f32 v86, v86
    v_smfmac_f32_16x16x64_bf16 v[12:15], v[8:11], v[72:79], v5
    v_mfma_f32_32x32x16_bf16 v[128:143], v[144:147], v[240:243], v[128:143]
    ds_read_b128 v[152:155], v162 offset:32768
    v_exp_f32 v87, v87
    v_exp_f32 v88, v88
    buffer_load_dwordx4 v178, s[44:47], s75 offen offset:2048 lds
    v_exp_f32 v89, v89
    s_waitcnt lgkmcnt(4)
    v_smfmac_f32_32x32x32_bf16 v[56:71], v[36:39], v[80:87], v5
    s_setprio 2
    ds_read_b128 v[36:39], v2 offset:11264
    v_exp_f32 v90, v90
    v_exp_f32 v91, v91
    v_exp_f32 v92, v92
    v_smfmac_f32_16x16x64_bf16 v[12:15], v[8:11], v[80:87], v5
    s_add_u32 m0, s52, 65536
    s_nop 0
    buffer_load_dwordx4 v4, s[40:43], s73 offen offset:1024 sc1 lds
    v_exp_f32 v93, v93
    v_exp_f32 v94, v94
    s_waitcnt lgkmcnt(4)
    v_mfma_f32_32x32x16_bf16 v[72:87], v[24:27], v[16:19], v[40:55]
    ds_read_b128 v[24:27], v2 offset:8192
    v_exp_f32 v95, v95
    v_exp_f32 v96, v96
    s_add_u32 m0, s59, 98304
    s_nop 0
    buffer_load_dwordx4 v179, s[44:47], s75 offen offset:3072 lds
    v_exp_f32 v97, v97
    s_waitcnt lgkmcnt(4)
    v_mfma_f32_32x32x16_bf16 v[72:87], v[28:31], v[20:23], v[72:87]
    ds_read_b128 v[28:31], v2 offset:9216
    v_exp_f32 v98, v98
    v_exp_f32 v99, v99
    s_waitcnt lgkmcnt(4)
    v_smfmac_f32_32x32x32_bf16 v[56:71], v[32:35], v[88:95], v5
    ds_read_b128 v[32:35], v2 offset:18432
    v_exp_f32 v100, v100
    v_exp_f32 v101, v101
    v_exp_f32 v102, v102
    v_smfmac_f32_16x16x64_bf16 v[12:15], v[8:11], v[88:95], v5
    v_mfma_f32_32x32x16_bf16 v[128:143], v[148:151], v[244:247], v[128:143]
    ds_read_b128 v[144:147], v163 offset:32768
    v_exp_f32 v103, v103
    v_exp_f32 v72, v72
    s_waitcnt vmcnt(11)
    v_cmp_eq_u64 vcc, s[32:33], v[106:107]
    s_cmp_eq_u64 vcc, -1
    s_cbranch_scc0 CK4_O
CK4_B:
    v_exp_f32 v73, v73
    s_waitcnt lgkmcnt(4)
    v_smfmac_f32_32x32x32_bf16 v[56:71], v[36:39], v[96:103], v5
    s_setprio 1
    ds_read_b128 v[36:39], v2 offset:19456
    v_exp_f32 v74, v74
    v_exp_f32 v75, v75
    v_exp_f32 v76, v76
    v_smfmac_f32_16x16x64_bf16 v[12:15], v[8:11], v[96:103], v5
    s_add_u32 m0, s52, 65536
    s_xor_b32 s73, s74, 229376
    buffer_load_dwordx4 v4, s[40:43], s73 offen offset:2048 sc1 lds
    v_exp_f32 v77, v77
    v_exp_f32 v78, v78
    s_waitcnt lgkmcnt(4)
    v_mfma_f32_32x32x16_bf16 v[88:103], v[24:27], v[16:19], v[40:55]
    ds_read_b128 v[24:27], v2 offset:16384
    v_exp_f32 v79, v79
    v_exp_f32 v80, v80
    v_exp_f32 v81, v81
    s_waitcnt lgkmcnt(4)
    v_mfma_f32_32x32x16_bf16 v[88:103], v[28:31], v[20:23], v[88:103]
    ds_read_b128 v[28:31], v2 offset:17408
    v_exp_f32 v82, v82
    v_exp_f32 v83, v83
    s_waitcnt lgkmcnt(4)
    v_smfmac_f32_32x32x32_bf16 v[56:71], v[32:35], v[72:79], v5
    ds_read_b128 v[32:35], v2 offset:26624
    v_exp_f32 v84, v84
    v_exp_f32 v85, v85
    v_exp_f32 v86, v86
    v_smfmac_f32_16x16x64_bf16 v[12:15], v[8:11], v[72:79], v5
    v_mfma_f32_32x32x16_bf16 v[128:143], v[152:155], v[248:251], v[128:143]
    v_exp_f32 v87, v87
    v_exp_f32 v88, v88
    v_exp_f32 v89, v89
    s_waitcnt lgkmcnt(3)
    v_smfmac_f32_32x32x32_bf16 v[56:71], v[36:39], v[80:87], v5
    s_setprio 0
    ds_read_b128 v[36:39], v2 offset:27648
    v_exp_f32 v90, v90
    v_exp_f32 v91, v91
    v_exp_f32 v92, v92
    v_smfmac_f32_16x16x64_bf16 v[12:15], v[8:11], v[80:87], v5
    buffer_load_dwordx4 v4, s[40:43], s73 offen offset:3072 sc1 lds
    v_exp_f32 v93, v93
    v_exp_f32 v94, v94
    s_waitcnt lgkmcnt(3)
    v_mfma_f32_32x32x16_bf16 v[72:87], v[24:27], v[16:19], v[40:55]
    ds_read_b128 v[24:27], v2 offset:24576
    v_exp_f32 v95, v95
    v_exp_f32 v96, v96
    v_exp_f32 v97, v97
    s_waitcnt lgkmcnt(3)
    v_mfma_f32_32x32x16_bf16 v[72:87], v[28:31], v[20:23], v[72:87]
    ds_read_b128 v[28:31], v2 offset:25600
    v_exp_f32 v98, v98
    v_exp_f32 v99, v99
    s_waitcnt lgkmcnt(3)
    v_smfmac_f32_32x32x32_bf16 v[56:71], v[32:35], v[88:95], v5
    v_exp_f32 v100, v100
    v_exp_f32 v101, v101
    v_exp_f32 v102, v102
    v_smfmac_f32_16x16x64_bf16 v[12:15], v[8:11], v[88:95], v5
    v_mfma_f32_32x32x16_bf16 v[128:143], v[144:147], v[252:255], v[128:143]
    s_cmp_lg_u32 s53, 0
    s_cbranch_scc1 G2_NR1
    v_mfma_f32_16x16x32_bf16 v[168:171], v[164:167], v[224:227], v[168:171]
    v_mfma_f32_16x16x32_bf16 v[168:171], v[164:167], v[228:231], v[168:171]
    v_mfma_f32_16x16x32_bf16 v[168:171], v[164:167], v[232:235], v[168:171]
    v_mfma_f32_16x16x32_bf16 v[168:171], v[164:167], v[236:239], v[168:171]
    v_mfma_f32_16x16x32_bf16 v[168:171], v[164:167], v[240:243], v[168:171]
    v_mfma_f32_16x16x32_bf16 v[168:171], v[164:167], v[244:247], v[168:171]
    v_mfma_f32_16x16x32_bf16 v[168:171], v[164:167], v[248:251], v[168:171]
    v_mfma_f32_16x16x32_bf16 v[168:171], v[164:167], v[252:255], v[168:171]
G2_NR1:
    v_exp_f32 v103, v103
    v_exp_f32 v72, v72
    v_exp_f32 v73, v73
    s_waitcnt lgkmcnt(2)
    v_smfmac_f32_32x32x32_bf16 v[56:71], v[36:39], v[96:103], v5
    s_waitcnt vmcnt(8)
    s_waitcnt lgkmcnt(0)
    s_barrier
    s_setprio 3
    ds_read_b128 v[32:35], v2 offset:34816
    ds_read_b128 v[36:39], v2 offset:35840
    v_exp_f32 v74, v74
    s_add_u32 m0, s59, 131072
    s_add_u32 s75, s75, 0x40000
    buffer_load_dwordx4 v176, s[44:47], s75 offen offset:0 lds
    v_exp_f32 v75, v75
    v_exp_f32 v76, v76
    v_smfmac_f32_16x16x64_bf16 v[12:15], v[8:11], v[96:103], v5
    s_add_u32 m0, s52, 0
    s_add_u32 s73, s98, 253952
    s_xor_b32 s73, s73, s31
    buffer_load_dwordx4 v4, s[40:43], s73 offen offset:0 sc1 lds
    v_exp_f32 v77, v77
    v_exp_f32 v78, v78
    v_mfma_f32_32x32x16_bf16 v[88:103], v[24:27], v[16:19], v[40:55]
    ds_read_b128 v[24:27], v2 offset:32768
    v_exp_f32 v79, v79
    v_exp_f32 v80, v80
    v_exp_f32 v81, v81
    s_add_u32 m0, s59, 131072
    s_nop 0
    buffer_load_dwordx4 v177, s[44:47], s75 offen offset:1024 lds
    v_mfma_f32_32x32x16_bf16 v[88:103], v[28:31], v[20:23], v[88:103]
    ds_read_b128 v[28:31], v2 offset:33792
    v_exp_f32 v82, v82
    v_exp_f32 v83, v83
    s_waitcnt lgkmcnt(3)
    v_smfmac_f32_32x32x32_bf16 v[56:71], v[32:35], v[72:79], v5
    ds_read_b128 v[32:35], v2 offset:43008
    v_exp_f32 v84, v84
    v_exp_f32 v85, v85
    v_exp_f32 v86, v86
    v_smfmac_f32_16x16x64_bf16 v[12:15], v[8:11], v[72:79], v5
    v_exp_f32 v87, v87
    s_nop 0
    v_exp_f32 v88, v88
    buffer_load_dwordx4 v178, s[44:47], s75 offen offset:2048 lds
    v_exp_f32 v89, v89
    s_waitcnt lgkmcnt(3)
    v_smfmac_f32_32x32x32_bf16 v[56:71], v[36:39], v[80:87], v5
    s_setprio 2
    ds_read_b128 v[36:39], v2 offset:44032
    v_exp_f32 v90, v90
    v_exp_f32 v91, v91
    v_exp_f32 v92, v92
    v_smfmac_f32_16x16x64_bf16 v[12:15], v[8:11], v[80:87], v5
    s_add_u32 m0, s52, 0
    s_nop 0
    buffer_load_dwordx4 v4, s[40:43], s73 offen offset:1024 sc1 lds
    v_exp_f32 v93, v93
    v_exp_f32 v94, v94
    s_waitcnt lgkmcnt(3)
    v_mfma_f32_32x32x16_bf16 v[72:87], v[24:27], v[16:19], v[40:55]
    ds_read_b128 v[24:27], v2 offset:40960
    v_exp_f32 v95, v95
    v_exp_f32 v96, v96
    s_add_u32 m0, s59, 131072
    s_nop 0
    buffer_load_dwordx4 v179, s[44:47], s75 offen offset:3072 lds
    v_exp_f32 v97, v97
    s_waitcnt lgkmcnt(3)
    v_mfma_f32_32x32x16_bf16 v[72:87], v[28:31], v[20:23], v[72:87]
    ds_read_b128 v[28:31], v2 offset:41984
    v_exp_f32 v98, v98
    v_exp_f32 v99, v99
    s_waitcnt lgkmcnt(3)
    v_smfmac_f32_32x32x32_bf16 v[56:71], v[32:35], v[88:95], v5
    ds_read_b128 v[32:35], v3 offset:2048
    v_exp_f32 v100, v100
    v_exp_f32 v101, v101
    v_exp_f32 v102, v102
    v_smfmac_f32_16x16x64_bf16 v[12:15], v[8:11], v[88:95], v5
    v_exp_f32 v103, v103
    s_nop 0
    v_exp_f32 v72, v72
    v_exp_f32 v73, v73
    s_waitcnt lgkmcnt(3)
    v_smfmac_f32_32x32x32_bf16 v[56:71], v[36:39], v[96:103], v5
    s_setprio 1
    ds_read_b128 v[36:39], v3 offset:3072
    v_exp_f32 v74, v74
    v_exp_f32 v75, v75
    v_exp_f32 v76, v76
    v_smfmac_f32_16x16x64_bf16 v[12:15], v[8:11], v[96:103], v5
    s_add_u32 m0, s52, 0
    s_xor_b32 s73, s74, 245760
    buffer_load_dwordx4 v4, s[40:43], s73 offen offset:2048 sc1 lds
    v_exp_f32 v77, v77
    v_exp_f32 v78, v78
    s_waitcnt lgkmcnt(3)
    v_mfma_f32_32x32x16_bf16 v[88:103], v[24:27], v[16:19], v[40:55]
    ds_read_b128 v[24:27], v3 offset:0
    v_exp_f32 v79, v79
    v_exp_f32 v80, v80
    v_exp_f32 v81, v81
    s_waitcnt lgkmcnt(3)
    v_mfma_f32_32x32x16_bf16 v[88:103], v[28:31], v[20:23], v[88:103]
    ds_read_b128 v[28:31], v3 offset:1024
    v_exp_f32 v82, v82
    v_exp_f32 v83, v83
    s_waitcnt lgkmcnt(3)
    v_smfmac_f32_32x32x32_bf16 v[56:71], v[32:35], v[72:79], v5
    ds_read_b128 v[32:35], v3 offset:10240
    v_exp_f32 v84, v84
    v_exp_f32 v85, v85
    v_exp_f32 v86, v86
    v_smfmac_f32_16x16x64_bf16 v[12:15], v[8:11], v[72:79], v5
    v_exp_f32 v87, v87
    s_nop 0
    v_exp_f32 v88, v88
    v_exp_f32 v89, v89
    s_waitcnt lgkmcnt(3)
    v_smfmac_f32_32x32x32_bf16 v[56:71], v[36:39], v[80:87], v5
    s_setprio 0
    ds_read_b128 v[36:39], v3 offset:11264
    v_exp_f32 v90, v90
    v_exp_f32 v91, v91
    v_exp_f32 v92, v92
    v_smfmac_f32_16x16x64_bf16 v[12:15], v[8:11], v[80:87], v5
    buffer_load_dwordx4 v4, s[40:43], s73 offen offset:3072 sc1 lds
    v_exp_f32 v93, v93
    v_exp_f32 v94, v94
    s_waitcnt lgkmcnt(3)
    v_mfma_f32_32x32x16_bf16 v[72:87], v[24:27], v[16:19], v[40:55]
    ds_read_b128 v[24:27], v3 offset:8192
    v_exp_f32 v95, v95
    v_exp_f32 v96, v96
    v_exp_f32 v97, v97
    s_waitcnt lgkmcnt(3)
    v_mfma_f32_32x32x16_bf16 v[72:87], v[28:31], v[20:23], v[72:87]
    ds_read_b128 v[28:31], v3 offset:9216
    v_exp_f32 v98, v98
    v_exp_f32 v99, v99
    s_waitcnt lgkmcnt(3)
    v_smfmac_f32_32x32x32_bf16 v[56:71], v[32:35], v[88:95], v5
    v_exp_f32 v100, v100
    v_exp_f32 v101, v101
    v_exp_f32 v102, v102
    v_smfmac_f32_16x16x64_bf16 v[12:15], v[8:11], v[88:95], v5
    v_exp_f32 v103, v103
    s_nop 1
    v_exp_f32 v72, v72
    v_exp_f32 v73, v73
    s_waitcnt lgkmcnt(2)
    v_smfmac_f32_32x32x32_bf16 v[56:71], v[36:39], v[96:103], v5
    s_waitcnt vmcnt(8)
    s_waitcnt lgkmcnt(0)
    s_barrier
    s_setprio 3
    ds_read_b128 v[32:35], v3 offset:18432
    ds_read_b128 v[36:39], v3 offset:19456
    v_exp_f32 v74, v74
    s_add_u32 m0, s59, 32768
    s_add_u32 s75, s75, 0x40000
    buffer_load_dwordx4 v176, s[44:47], s75 offen offset:0 lds
    v_exp_f32 v75, v75
    v_exp_f32 v76, v76
    v_smfmac_f32_16x16x64_bf16 v[12:15], v[8:11], v[96:103], v5
    v_exp_f32 v77, v77
    v_exp_f32 v78, v78
    v_mfma_f32_32x32x16_bf16 v[88:103], v[24:27], v[16:19], v[40:55]
    ds_read_b128 v[24:27], v3 offset:16384
    v_exp_f32 v79, v79
    v_exp_f32 v80, v80
    v_exp_f32 v81, v81
    buffer_load_dwordx4 v177, s[44:47], s75 offen offset:1024 lds
    v_mfma_f32_32x32x16_bf16 v[88:103], v[28:31], v[20:23], v[88:103]
    ds_read_b128 v[28:31], v3 offset:17408
    v_exp_f32 v82, v82
    v_exp_f32 v83, v83
    s_waitcnt lgkmcnt(3)
    v_smfmac_f32_32x32x32_bf16 v[56:71], v[32:35], v[72:79], v5
    ds_read_b128 v[32:35], v3 offset:26624
    v_exp_f32 v84, v84
    v_exp_f32 v85, v85
    v_exp_f32 v86, v86
    v_smfmac_f32_16x16x64_bf16 v[12:15], v[8:11], v[72:79], v5
    v_exp_f32 v87, v87
    s_nop 0
    v_exp_f32 v88, v88
    buffer_load_dwordx4 v178, s[44:47], s75 offen offset:2048 lds
    v_exp_f32 v89, v89
    s_waitcnt lgkmcnt(3)
    v_smfmac_f32_32x32x32_bf16 v[56:71], v[36:39], v[80:87], v5
    s_setprio 2
    ds_read_b128 v[36:39], v3 offset:27648
    v_exp_f32 v90, v90
    v_exp_f32 v91, v91
    v_exp_f32 v92, v92
    v_smfmac_f32_16x16x64_bf16 v[12:15], v[8:11], v[80:87], v5
    v_exp_f32 v93, v93
    v_exp_f32 v94, v94
    s_waitcnt lgkmcnt(3)
    v_mfma_f32_32x32x16_bf16 v[72:87], v[24:27], v[16:19], v[40:55]
    ds_read_b128 v[24:27], v3 offset:24576
    v_exp_f32 v95, v95
    v_exp_f32 v96, v96
    buffer_load_dwordx4 v179, s[44:47], s75 offen offset:3072 lds
    v_exp_f32 v97, v97
    s_waitcnt lgkmcnt(3)
    v_mfma_f32_32x32x16_bf16 v[72:87], v[28:31], v[20:23], v[72:87]
    ds_read_b128 v[28:31], v3 offset:25600
    v_exp_f32 v98, v98
    v_exp_f32 v99, v99
    s_waitcnt lgkmcnt(3)
    v_smfmac_f32_32x32x32_bf16 v[56:71], v[32:35], v[88:95], v5
    ds_read_b128 v[32:35], v3 offset:34816
    v_exp_f32 v100, v100
    v_exp_f32 v101, v101
    v_exp_f32 v102, v102
    v_smfmac_f32_16x16x64_bf16 v[12:15], v[8:11], v[88:95], v5
    v_exp_f32 v103, v103
    s_nop 0
    v_exp_f32 v72, v72
    v_exp_f32 v73, v73
    s_waitcnt lgkmcnt(3)
    v_smfmac_f32_32x32x32_bf16 v[56:71], v[36:39], v[96:103], v5
    s_setprio 1
    ds_read_b128 v[36:39], v3 offset:35840
    v_exp_f32 v74, v74
    v_exp_f32 v75, v75
    v_exp_f32 v76, v76
    v_smfmac_f32_16x16x64_bf16 v[12:15], v[8:11], v[96:103], v5
    v_exp_f32 v77, v77
    v_exp_f32 v78, v78
    s_waitcnt lgkmcnt(3)
    v_mfma_f32_32x32x16_bf16 v[88:103], v[24:27], v[16:19], v[40:55]
    ds_read_b128 v[24:27], v3 offset:32768
    v_exp_f32 v79, v79
    v_exp_f32 v80, v80
    v_exp_f32 v81, v81
    s_waitcnt lgkmcnt(3)
    v_mfma_f32_32x32x16_bf16 v[88:103], v[28:31], v[20:23], v[88:103]
    ds_read_b128 v[28:31], v3 offset:33792
    v_exp_f32 v82, v82
    v_exp_f32 v83, v83
    s_waitcnt lgkmcnt(3)
    v_smfmac_f32_32x32x32_bf16 v[56:71], v[32:35], v[72:79], v5
    ds_read_b128 v[32:35], v3 offset:43008
    v_exp_f32 v84, v84
    v_exp_f32 v85, v85
    v_exp_f32 v86, v86
    v_smfmac_f32_16x16x64_bf16 v[12:15], v[8:11], v[72:79], v5
    v_exp_f32 v87, v87
    s_nop 0
    v_exp_f32 v88, v88
    v_exp_f32 v89, v89
    s_waitcnt lgkmcnt(3)
    v_smfmac_f32_32x32x32_bf16 v[56:71], v[36:39], v[80:87], v5
    s_setprio 0
    ds_read_b128 v[36:39], v3 offset:44032
    v_exp_f32 v90, v90
    v_exp_f32 v91, v91
    v_exp_f32 v92, v92
    v_smfmac_f32_16x16x64_bf16 v[12:15], v[8:11], v[80:87], v5
    v_exp_f32 v93, v93
    v_exp_f32 v94, v94
    s_waitcnt lgkmcnt(3)
    v_mfma_f32_32x32x16_bf16 v[72:87], v[24:27], v[16:19], v[40:55]
    ds_read_b128 v[24:27], v3 offset:40960
    v_exp_f32 v95, v95
    v_exp_f32 v96, v96
    v_exp_f32 v97, v97
    s_waitcnt lgkmcnt(3)
    v_mfma_f32_32x32x16_bf16 v[72:87], v[28:31], v[20:23], v[72:87]
    ds_read_b128 v[28:31], v3 offset:41984
    v_exp_f32 v98, v98
    v_exp_f32 v99, v99
    s_waitcnt lgkmcnt(3)
    v_smfmac_f32_32x32x32_bf16 v[56:71], v[32:35], v[88:95], v5
    v_exp_f32 v100, v100
    v_exp_f32 v101, v101
    v_exp_f32 v102, v102
    v_smfmac_f32_16x16x64_bf16 v[12:15], v[8:11], v[88:95], v5
    v_exp_f32 v103, v103
    s_nop 1
    v_exp_f32 v72, v72
    v_exp_f32 v73, v73
    s_waitcnt lgkmcnt(2)
    v_smfmac_f32_32x32x32_bf16 v[56:71], v[36:39], v[96:103], v5
    s_waitcnt vmcnt(4)
    s_waitcnt lgkmcnt(0)
    s_barrier
    s_setprio 3
    ds_read_b128 v[32:35], v2 offset:2048
    ds_read_b128 v[36:39], v2 offset:3072
    v_exp_f32 v74, v74
    s_add_u32 m0, s59, 65536
    s_add_u32 s75, s75, 0x40000
    buffer_load_dwordx4 v176, s[44:47], s75 offen offset:0 lds
    v_exp_f32 v75, v75
    v_exp_f32 v76, v76
    v_smfmac_f32_16x16x64_bf16 v[12:15], v[8:11], v[96:103], v5
    v_exp_f32 v77, v77
    v_exp_f32 v78, v78
    v_mfma_f32_32x32x16_bf16 v[88:103], v[24:27], v[16:19], v[40:55]
    ds_read_b128 v[24:27], v2 offset:0
    v_exp_f32 v79, v79
    v_exp_f32 v80, v80
    v_exp_f32 v81, v81
    buffer_load_dwordx4 v177, s[44:47], s75 offen offset:1024 lds
    v_mfma_f32_32x32x16_bf16 v[88:103], v[28:31], v[20:23], v[88:103]
    ds_read_b128 v[28:31], v2 offset:1024
    v_exp_f32 v82, v82
    v_exp_f32 v83, v83
    s_waitcnt lgkmcnt(3)
    v_smfmac_f32_32x32x32_bf16 v[56:71], v[32:35], v[72:79], v5
    ds_read_b128 v[32:35], v2 offset:10240
    v_exp_f32 v84, v84
    v_exp_f32 v85, v85
    v_exp_f32 v86, v86
    v_smfmac_f32_16x16x64_bf16 v[12:15], v[8:11], v[72:79], v5
    v_exp_f32 v87, v87
    s_nop 0
    v_exp_f32 v88, v88
    buffer_load_dwordx4 v178, s[44:47], s75 offen offset:2048 lds
    v_exp_f32 v89, v89
    s_waitcnt lgkmcnt(3)
    v_smfmac_f32_32x32x32_bf16 v[56:71], v[36:39], v[80:87], v5
    s_setprio 2
    ds_read_b128 v[36:39], v2 offset:11264
    v_exp_f32 v90, v90
    v_exp_f32 v91, v91
    v_exp_f32 v92, v92
    v_smfmac_f32_16x16x64_bf16 v[12:15], v[8:11], v[80:87], v5
    v_exp_f32 v93, v93
    v_exp_f32 v94, v94
    s_waitcnt lgkmcnt(3)
    v_mfma_f32_32x32x16_bf16 v[72:87], v[24:27], v[16:19], v[40:55]
    ds_read_b128 v[24:27], v2 offset:8192
    v_exp_f32 v95, v95
    v_exp_f32 v96, v96
    buffer_load_dwordx4 v179, s[44:47], s75 offen offset:3072 lds
    v_exp_f32 v97, v97
    s_waitcnt lgkmcnt(3)
    v_mfma_f32_32x32x16_bf16 v[72:87], v[28:31], v[20:23], v[72:87]
    ds_read_b128 v[28:31], v2 offset:9216
    v_exp_f32 v98, v98
    v_exp_f32 v99, v99
    s_waitcnt lgkmcnt(3)
    v_smfmac_f32_32x32x32_bf16 v[56:71], v[32:35], v[88:95], v5
    ds_read_b128 v[32:35], v2 offset:18432
    v_exp_f32 v100, v100
    v_exp_f32 v101, v101
    v_exp_f32 v102, v102
    v_smfmac_f32_16x16x64_bf16 v[12:15], v[8:11], v[88:95], v5
    v_exp_f32 v103, v103
    s_nop 0
    v_exp_f32 v72, v72
    v_exp_f32 v73, v73
    s_waitcnt lgkmcnt(3)
    v_smfmac_f32_32x32x32_bf16 v[56:71], v[36:39], v[96:103], v5
    s_setprio 1
    ds_read_b128 v[36:39], v2 offset:19456
    v_exp_f32 v74, v74
    v_exp_f32 v75, v75
    v_exp_f32 v76, v76
    v_smfmac_f32_16x16x64_bf16 v[12:15], v[8:11], v[96:103], v5
    v_exp_f32 v77, v77
    v_exp_f32 v78, v78
    s_waitcnt lgkmcnt(3)
    v_mfma_f32_32x32x16_bf16 v[88:103], v[24:27], v[16:19], v[40:55]
    v_exp_f32 v79, v79
    v_exp_f32 v80, v80
    v_exp_f32 v81, v81
    s_waitcnt lgkmcnt(2)
    v_mfma_f32_32x32x16_bf16 v[88:103], v[28:31], v[20:23], v[88:103]
    v_exp_f32 v82, v82
    v_exp_f32 v83, v83
    s_waitcnt lgkmcnt(1)
    v_smfmac_f32_32x32x32_bf16 v[56:71], v[32:35], v[72:79], v5
    ds_read_b128 v[32:35], v2 offset:26624
    v_exp_f32 v84, v84
    v_exp_f32 v85, v85
    v_exp_f32 v86, v86
    v_smfmac_f32_16x16x64_bf16 v[12:15], v[8:11], v[72:79], v5
    v_exp_f32 v87, v87
    s_nop 1
    v_exp_f32 v88, v88
    v_exp_f32 v89, v89
    s_waitcnt lgkmcnt(1)
    v_smfmac_f32_32x32x32_bf16 v[56:71], v[36:39], v[80:87], v5
    s_setprio 0
    ds_read_b128 v[36:39], v2 offset:27648
    v_exp_f32 v90, v90
    v_exp_f32 v91, v91
    v_exp_f32 v92, v92
    v_smfmac_f32_16x16x64_bf16 v[12:15], v[8:11], v[80:87], v5
    v_exp_f32 v93, v93
    v_exp_f32 v94, v94
    v_exp_f32 v95, v95
    v_exp_f32 v96, v96
    v_exp_f32 v97, v97
    v_exp_f32 v98, v98
    v_exp_f32 v99, v99
    s_waitcnt lgkmcnt(1)
    v_smfmac_f32_32x32x32_bf16 v[56:71], v[32:35], v[88:95], v5
    v_exp_f32 v100, v100
    v_exp_f32 v101, v101
    v_exp_f32 v102, v102
    v_smfmac_f32_16x16x64_bf16 v[12:15], v[8:11], v[88:95], v5
    v_exp_f32 v103, v103
    s_waitcnt lgkmcnt(0)
    s_nop 0
    v_smfmac_f32_32x32x32_bf16 v[56:71], v[36:39], v[96:103], v5
    v_smfmac_f32_16x16x64_bf16 v[12:15], v[8:11], v[96:103], v5
    s_setprio 0
    v_lshrrev_b32 v7, 5, v0
    v_and_b32 v154, 0x1f0, v1
    v_lshl_add_u32 v153, v7, 13, v154
    s_andn2_b32 s96, s59, 0x2000
    s_lshl_b32 s97, s55, 9
    s_add_u32 s97, s97, s96
    s_xor_b32 s3, s97, 4096
    v_add_u32 v145, s3, v153
    s_xor_b32 s3, s97, 16384
    v_add_u32 v146, s3, v153
    s_xor_b32 s3, s97, 20480
    v_add_u32 v147, s3, v153
    v_add_u32 v153, s96, v153
    v_add_f32 v6, |v56|, |v57|
    v_add_f32 v7, |v58|, |v59|
    v_add_f32 v6, v6, |v60|
    v_add_f32 v7, v7, |v61|
    v_add_f32 v6, v6, |v62|
    v_add_f32 v7, v7, |v63|
    v_add_f32 v6, v6, |v64|
    v_add_f32 v7, v7, |v65|
    v_add_f32 v6, v6, |v66|
    v_add_f32 v7, v7, |v67|
    v_add_f32 v6, v6, |v68|
    v_add_f32 v7, v7, |v69|
    v_add_f32 v6, v6, |v70|
    v_add_f32 v7, v7, |v71|
    v_add_f32 v6, v6, v7
    s_mov_b32 s3, 0x0b800000
    s_mov_b32 s52, 0x7b800000
    v_cmp_lt_f32 s[96:97], s3, v6
    v_cmp_gt_f32 s[100:101], s52, v6
    v_cmp_gt_f32 vcc, s52, v12
    s_and_b64 s[96:97], s[96:97], s[100:101]
    s_and_b64 s[96:97], s[96:97], vcc
    s_cmp_eq_u64 s[96:97], -1
    s_cbranch_scc0 AT_SLOW
AT_FIN:
    v_rcp_f32 v6, v12
    s_nop 0
    v_pk_mul_f32 v[56:57], v[56:57], v[6:7] op_sel_hi:[1,0]
    v_pk_mul_f32 v[58:59], v[58:59], v[6:7] op_sel_hi:[1,0]
    v_pk_mul_f32 v[60:61], v[60:61], v[6:7] op_sel_hi:[1,0]
    v_pk_mul_f32 v[62:63], v[62:63], v[6:7] op_sel_hi:[1,0]
    v_cvt_pk_bf16_f32 v96, v56, v57
    v_cvt_pk_bf16_f32 v97, v58, v59
    v_cvt_pk_bf16_f32 v98, v60, v61
    v_cvt_pk_bf16_f32 v99, v62, v63
    v_min_u32 v96, -2, v96
    v_min_u32 v97, -2, v97
    v_min_u32 v98, -2, v98
    v_min_u32 v99, -2, v99
    buffer_store_dwordx4 v[96:99], v1, s[36:39], s77 offen offset:0 sc1
    v_pk_mul_f32 v[64:65], v[64:65], v[6:7] op_sel_hi:[1,0]
    v_pk_mul_f32 v[66:67], v[66:67], v[6:7] op_sel_hi:[1,0]
    v_pk_mul_f32 v[68:69], v[68:69], v[6:7] op_sel_hi:[1,0]
    v_pk_mul_f32 v[70:71], v[70:71], v[6:7] op_sel_hi:[1,0]
    v_cvt_pk_bf16_f32 v100, v64, v65
    v_cvt_pk_bf16_f32 v101, v66, v67
    v_cvt_pk_bf16_f32 v102, v68, v69
    v_cvt_pk_bf16_f32 v103, v70, v71
    v_min_u32 v100, -2, v100
    v_min_u32 v101, -2, v101
    v_min_u32 v102, -2, v102
    v_min_u32 v103, -2, v103
    buffer_store_dwordx4 v[100:103], v1, s[36:39], s77 offen offset:1024 sc1
    s_sub_u32 s96, 0, s55
    s_sub_u32 s97, s55, 1
    s_barrier
    ds_write_b128 v145, v[132:135] offset:0
    ds_write_b128 v146, v[136:139] offset:1024
    ds_write_b128 v147, v[140:143] offset:2048
    s_mov_b64 exec, s[96:97]
    ds_write_b128 v153, v[128:131] offset:3584
    s_lshl_b32 s3, s54, 14
    s_lshl_b32 s52, s34, 7
    s_add_u32 s52, s3, s52
    s_mov_b64 exec, 0xffff
    v_lshl_add_u32 v6, v0, 2, s52
    ds_write_b32 v6, v168 offset:3072
    ds_write_b32 v6, v169 offset:3136
    s_mov_b64 exec, -1
    v_add_u32 v144, s59, v1
    v_add_u32 v154, s59, v154
    v_lshrrev_b32 v2, 5, v0
    v_bfe_u32 v3, v0, 2, 2
    v_lshl_add_u32 v2, v2, 2, v3
    v_lshlrev_b32 v2, 7, v2
    v_bfe_u32 v3, v0, 3, 1
    v_xor_b32 v3, s54, v3
    v_lshl_add_u32 v2, v3, 6, v2
    v_bfe_u32 v3, v0, 4, 1
    v_lshl_add_u32 v2, v3, 5, v2
    v_and_b32 v3, 3, v0
    v_lshl_add_u32 v2, v3, 3, v2
    s_add_u32 s3, s3, 32768
    v_add_u32 v2, s3, v2
    v_xor_b32 v3, 64, v2
    v_xor_b32 v4, 0x10000, v2
    v_xor_b32 v5, 0x10000, v3
    s_waitcnt vmcnt(2)
    s_waitcnt lgkmcnt(0)
    s_barrier
    ds_read_b64_tr_b16 v[8:9], v4 offset:0
    ds_read_b64_tr_b16 v[10:11], v4 offset:1024
    ds_read_b64_tr_b16 v[12:13], v5 offset:0
    ds_read_b64_tr_b16 v[14:15], v5 offset:1024
    ds_read_b64_tr_b16 v[16:17], v4 offset:2048
    ds_read_b64_tr_b16 v[18:19], v4 offset:3072
    ds_read_b64_tr_b16 v[20:21], v5 offset:2048
    ds_read_b64_tr_b16 v[22:23], v5 offset:3072
    ds_read_b128 v[132:135], v144 offset:0
    ds_read_b128 v[136:139], v144 offset:1024
    ds_read_b128 v[140:143], v144 offset:2048
    s_mov_b64 exec, s[96:97]
    ds_read_b128 v[128:131], v154 offset:3584
    s_mov_b64 exec, -1
    s_xor_b32 s101, s60, 0
    buffer_load_dwordx4 v[192:195], v1, s[36:39], s101 offen offset:0 sc1
    buffer_load_dwordx4 v[196:199], v1, s[36:39], s101 offen offset:1024 sc1
    buffer_load_dwordx4 v[200:203], v1, s[36:39], s101 offen offset:2048 sc1
    buffer_load_dwordx4 v[204:207], v1, s[36:39], s101 offen offset:3072 sc1
    s_lshl_b32 s3, s57, 31
    v_xor_b32 v148, s3, v105
    s_lshl_b32 s52, s54, 31
    v_lshrrev_b32 v149, 5, v0
    v_lshl_add_u32 v149, v149, 2, v123
    v_add_u32 v150, s59, v149
    s_waitcnt lgkmcnt(0)
    v_add_f32 v128, v128, v132
    v_add_f32 v136, v136, v140
    v_sub_f32 v153, v128, v136
    v_add_f32 v154, v128, v136
    v_xor_b32 v153, s52, v153
    v_add_f32 v154, v154, v148
    v_add_f32 v153, v153, v105
    v_cvt_pk_bf16_f32 v156, v153, v154
    v_add_f32 v129, v129, v133
    v_add_f32 v137, v137, v141
    v_sub_f32 v153, v129, v137
    v_add_f32 v154, v129, v137
    v_xor_b32 v153, s52, v153
    v_sub_f32 v154, v154, v148
    v_sub_f32 v153, v153, v105
    v_cvt_pk_bf16_f32 v157, v153, v154
    ds_write2_b32 v150, v156, v157 offset0:0 offset1:64
    v_add_f32 v130, v130, v134
    v_add_f32 v138, v138, v142
    v_sub_f32 v153, v130, v138
    v_add_f32 v154, v130, v138
    v_xor_b32 v153, s52, v153
    v_add_f32 v154, v154, v148
    v_add_f32 v153, v153, v105
    v_cvt_pk_bf16_f32 v158, v153, v154
    v_add_f32 v131, v131, v135
    v_add_f32 v139, v139, v143
    v_sub_f32 v153, v131, v139
    v_add_f32 v154, v131, v139
    v_xor_b32 v153, s52, v153
    v_sub_f32 v154, v154, v148
    v_sub_f32 v153, v153, v105
    v_cvt_pk_bf16_f32 v159, v153, v154
    ds_write2_b32 v150, v158, v159 offset0:128 offset1:192
    v_lshl_add_u32 v150, v123, 2, s59
    ds_read_b128 v[172:175], v150
    ds_read_b128 v[176:179], v150 offset:16
    s_xor_b32 s101, s60, 4096
    buffer_load_dwordx4 v[208:211], v1, s[36:39], s101 offen offset:0 sc1
    buffer_load_dwordx4 v[212:215], v1, s[36:39], s101 offen offset:1024 sc1
    buffer_load_dwordx4 v[216:219], v1, s[36:39], s101 offen offset:2048 sc1
    buffer_load_dwordx4 v[220:223], v1, s[36:39], s101 offen offset:3072 sc1
    s_waitcnt vmcnt(4)
    v_max3_u32 v6, v192, v193, v194
    v_max3_u32 v7, v195, v196, v197
    v_max3_u32 v7, v7, v198, v199
    v_max3_u32 v6, v6, v200, v201
    v_max3_u32 v7, v7, v202, v203
    v_max3_u32 v6, v6, v204, v205
    v_max3_u32 v7, v7, v206, v207
    v_max_u32 v6, v6, v7
    v_cmp_eq_u32 vcc, -1, v6
    s_cmp_eq_u64 vcc, 0
    s_cbranch_scc0 OG0
OB0:
    v_mfma_f32_32x32x16_bf16 v[32:47], v[8:11], v[192:195], 0
    ds_read_b64_tr_b16 v[24:25], v4 offset:4096
    ds_read_b64_tr_b16 v[26:27], v4 offset:5120
    s_lshr_b32 s3, s57, 1
    s_lshl_b32 s3, s3, 2
    s_add_u32 s3, s3, s63
    s_lshl_b32 s3, s3, 1
    s_add_u32 s3, s3, s55
    s_lshl_b32 s3, s3, 3
    s_and_b32 s52, s57, 1
    s_add_u32 s3, s3, s52
    s_lshl_b32 s3, s3, 12
    v_and_b32 v153, 0x180, v1
    v_lshl_add_u32 v153, v153, 6, s3
    s_mov_b32 s96, 0
    s_mov_b32 s97, -1
    v_sub_u32 v154, 8388608, v153
    v_cndmask_b32 v153, v153, v154, s[96:97]
    v_mfma_f32_32x32x16_bf16 v[48:63], v[12:15], v[192:195], 0
    ds_read_b64_tr_b16 v[28:29], v5 offset:4096
    ds_read_b64_tr_b16 v[30:31], v5 offset:5120
    s_lshr_b32 s52, s58, 1
    s_lshl_b32 s52, s52, 7
    v_and_b32 v154, 0x70, v1
    v_add3_u32 v151, v153, v154, s52
    v_sub_u32 v152, 8390642, v151
    v_mov_b32 v155, 0x05040100
    s_xor_b32 s101, s60, 8192
    buffer_load_dwordx4 v[224:227], v1, s[36:39], s101 offen offset:0 sc1
    v_mfma_f32_32x32x16_bf16 v[32:47], v[16:19], v[196:199], v[32:47]
    ds_read_b64_tr_b16 v[8:9], v4 offset:6144
    ds_read_b64_tr_b16 v[10:11], v4 offset:7168
    v_mov_b32 v153, 0x07060302
    v_cndmask_b32 v155, v155, v153, s[96:97]
    s_waitcnt lgkmcnt(6)
    v_perm_b32 v180, v173, v172, v155
    v_perm_b32 v184, v178, v179, v155
    v_mfma_f32_32x32x16_bf16 v[48:63], v[20:23], v[196:199], v[48:63]
    ds_read_b64_tr_b16 v[12:13], v5 offset:6144
    ds_read_b64_tr_b16 v[14:15], v5 offset:7168
    v_perm_b32 v181, v175, v174, v155
    v_perm_b32 v185, v176, v177, v155
    v_perm_b32 v182, v177, v176, v155
    v_perm_b32 v186, v174, v175, v155
    buffer_load_dwordx4 v[228:231], v1, s[36:39], s101 offen offset:1024 sc1
    s_waitcnt lgkmcnt(6)
    v_mfma_f32_32x32x16_bf16 v[32:47], v[24:27], v[200:203], v[32:47]
    ds_read_b64_tr_b16 v[16:17], v4 offset:8192
    ds_read_b64_tr_b16 v[18:19], v4 offset:9216
    v_perm_b32 v183, v179, v178, v155
    v_perm_b32 v187, v172, v173, v155
    s_cmp_lg_u32 s52, 0
    s_cbranch_scc1 T_NB
    v_mov_b32 v153, 1073741824
    v_cmp_eq_u32 vcc, 0, v154
    s_nop 1
    v_cndmask_b32 v154, v153, v152, vcc
    v_cndmask_b32 v152, v152, v153, vcc
    buffer_store_dwordx3 v[184:186], v154, s[48:51], 0 offen
    buffer_store_short v187, v154, s[48:51], 0 offen offset:12
    s_nop 0
T_NB:
    s_waitcnt lgkmcnt(6)
    v_mfma_f32_32x32x16_bf16 v[48:63], v[28:31], v[200:203], v[48:63]
    ds_read_b64_tr_b16 v[20:21], v5 offset:8192
    ds_read_b64_tr_b16 v[22:23], v5 offset:9216
    s_or_b32 s53, s53, s34
    s_cmp_lg_u32 s53, 0
    s_cbranch_scc1 T_NR
    v_lshrrev_b32 v153, 5, v0
    v_lshl_add_u32 v153, v153, 8, v125
    v_add_u32 v153, s59, v153
    ds_read_b32 v168, v153 offset:3072
    ds_read_b32 v169, v153 offset:3200
    v_lshrrev_b32 v149, 1, v149
    v_add_u32 v149, s52, v149
    v_sub_u32 v150, 2048, v149
    v_mov_b32 v153, 1073741824
    v_cmp_eq_u32 vcc, 0, v149
    s_nop 1
    v_cndmask_b32 v150, v150, v153, vcc
    s_waitcnt lgkmcnt(0)
    v_add_f32 v168, v168, v169
    v_add_f32 v168, v168, v105
    v_cvt_pk_bf16_f32 v168, v168, v168
    s_mov_b32 s53, 4194304
    buffer_store_short v168, v149, s[48:51], s53 offen
    buffer_store_short v168, v150, s[48:51], s53 offen
T_NR:
    v_and_b32 v148, 31, v0
    v_lshrrev_b32 v149, 5, v0
    buffer_load_dwordx4 v[232:235], v1, s[36:39], s101 offen offset:2048 sc1
    s_waitcnt lgkmcnt(6)
    v_mfma_f32_32x32x16_bf16 v[32:47], v[8:11], v[204:207], v[32:47]
    ds_read_b64_tr_b16 v[24:25], v4 offset:10240
    ds_read_b64_tr_b16 v[26:27], v4 offset:11264
    v_lshlrev_b32 v149, 4, v149
    v_lshl_add_u32 v148, v148, 12, v149
    s_lshl_b32 s52, s64, 17
    s_lshl_b32 s59, s62, 7
    s_add_u32 s52, s52, s59
    s_lshl_b32 s59, s54, 6
    s_add_u32 s52, s52, s59
    s_add_u32 s52, s52, 2048
    v_xor_b32 v149, 0x4000, v144
    s_waitcnt lgkmcnt(6)
    v_mfma_f32_32x32x16_bf16 v[48:63], v[12:15], v[204:207], v[48:63]
    ds_read_b64_tr_b16 v[28:29], v5 offset:10240
    ds_read_b64_tr_b16 v[30:31], v5 offset:11264
    buffer_load_dwordx4 v[236:239], v1, s[36:39], s101 offen offset:3072 sc1
    s_waitcnt vmcnt(4)
    v_max3_u32 v6, v208, v209, v210
    v_max3_u32 v7, v211, v212, v213
    v_max3_u32 v7, v7, v214, v215
    v_max3_u32 v6, v6, v216, v217
    v_max3_u32 v7, v7, v218, v219
    v_max3_u32 v6, v6, v220, v221
    v_max3_u32 v7, v7, v222, v223
    v_max_u32 v6, v6, v7
    v_cmp_eq_u32 vcc, -1, v6
    s_cmp_eq_u64 vcc, 0
    s_cbranch_scc0 OG1
OB1:
    s_waitcnt lgkmcnt(6)
    v_mfma_f32_32x32x16_bf16 v[32:47], v[16:19], v[208:211], v[32:47]
    ds_read_b64_tr_b16 v[8:9], v4 offset:12288
    ds_read_b64_tr_b16 v[10:11], v4 offset:13312
    s_waitcnt lgkmcnt(6)
    v_mfma_f32_32x32x16_bf16 v[48:63], v[20:23], v[208:211], v[48:63]
    ds_read_b64_tr_b16 v[12:13], v5 offset:12288
    ds_read_b64_tr_b16 v[14:15], v5 offset:13312
    s_xor_b32 s101, s60, 12288
    buffer_load_dwordx4 v[240:243], v1, s[36:39], s101 offen offset:0 sc1
    s_waitcnt lgkmcnt(6)
    v_mfma_f32_32x32x16_bf16 v[32:47], v[24:27], v[212:215], v[32:47]
    ds_read_b64_tr_b16 v[16:17], v4 offset:14336
    ds_read_b64_tr_b16 v[18:19], v4 offset:15360
    s_waitcnt lgkmcnt(6)
    v_mfma_f32_32x32x16_bf16 v[48:63], v[28:31], v[212:215], v[48:63]
    ds_read_b64_tr_b16 v[20:21], v5 offset:14336
    ds_read_b64_tr_b16 v[22:23], v5 offset:15360
    buffer_load_dwordx4 v[244:247], v1, s[36:39], s101 offen offset:1024 sc1
    s_waitcnt lgkmcnt(6)
    v_mfma_f32_32x32x16_bf16 v[32:47], v[8:11], v[216:219], v[32:47]
    ds_read_b64_tr_b16 v[24:25], v4 offset:32768
    ds_read_b64_tr_b16 v[26:27], v4 offset:33792
    s_waitcnt lgkmcnt(6)
    v_mfma_f32_32x32x16_bf16 v[48:63], v[12:15], v[216:219], v[48:63]
    ds_read_b64_tr_b16 v[28:29], v5 offset:32768
    ds_read_b64_tr_b16 v[30:31], v5 offset:33792
    buffer_load_dwordx4 v[248:251], v1, s[36:39], s101 offen offset:2048 sc1
    s_waitcnt lgkmcnt(6)
    v_mfma_f32_32x32x16_bf16 v[32:47], v[16:19], v[220:223], v[32:47]
    ds_read_b64_tr_b16 v[8:9], v4 offset:34816
    ds_read_b64_tr_b16 v[10:11], v4 offset:35840
    s_waitcnt lgkmcnt(6)
    v_mfma_f32_32x32x16_bf16 v[48:63], v[20:23], v[220:223], v[48:63]
    ds_read_b64_tr_b16 v[12:13], v5 offset:34816
    ds_read_b64_tr_b16 v[14:15], v5 offset:35840
    buffer_load_dwordx4 v[252:255], v1, s[36:39], s101 offen offset:3072 sc1
    s_waitcnt vmcnt(4)
    v_max3_u32 v6, v224, v225, v226
    v_max3_u32 v7, v227, v228, v229
    v_max3_u32 v7, v7, v230, v231
    v_max3_u32 v6, v6, v232, v233
    v_max3_u32 v7, v7, v234, v235
    v_max3_u32 v6, v6, v236, v237
    v_max3_u32 v7, v7, v238, v239
    v_max_u32 v6, v6, v7
    v_cmp_eq_u32 vcc, -1, v6
    s_cmp_eq_u64 vcc, 0
    s_cbranch_scc0 OG2
OB2:
    s_waitcnt lgkmcnt(6)
    v_mfma_f32_32x32x16_bf16 v[32:47], v[24:27], v[224:227], v[32:47]
    ds_read_b64_tr_b16 v[16:17], v4 offset:36864
    ds_read_b64_tr_b16 v[18:19], v4 offset:37888
    s_waitcnt lgkmcnt(6)
    v_mfma_f32_32x32x16_bf16 v[48:63], v[28:31], v[224:227], v[48:63]
    ds_read_b64_tr_b16 v[20:21], v5 offset:36864
    ds_read_b64_tr_b16 v[22:23], v5 offset:37888
    s_xor_b32 s101, s60, 16384
    buffer_load_dwordx4 v[64:67], v1, s[36:39], s101 offen offset:0 sc1
    s_waitcnt lgkmcnt(6)
    v_mfma_f32_32x32x16_bf16 v[32:47], v[8:11], v[228:231], v[32:47]
    ds_read_b64_tr_b16 v[24:25], v4 offset:38912
    ds_read_b64_tr_b16 v[26:27], v4 offset:39936
    s_waitcnt lgkmcnt(6)
    v_mfma_f32_32x32x16_bf16 v[48:63], v[12:15], v[228:231], v[48:63]
    ds_read_b64_tr_b16 v[28:29], v5 offset:38912
    ds_read_b64_tr_b16 v[30:31], v5 offset:39936
    buffer_load_dwordx4 v[68:71], v1, s[36:39], s101 offen offset:1024 sc1
    s_waitcnt lgkmcnt(6)
    v_mfma_f32_32x32x16_bf16 v[32:47], v[16:19], v[232:235], v[32:47]
    ds_read_b64_tr_b16 v[8:9], v4 offset:40960
    ds_read_b64_tr_b16 v[10:11], v4 offset:41984
    s_waitcnt lgkmcnt(6)
    v_mfma_f32_32x32x16_bf16 v[48:63], v[20:23], v[232:235], v[48:63]
    ds_read_b64_tr_b16 v[12:13], v5 offset:40960
    ds_read_b64_tr_b16 v[14:15], v5 offset:41984
    buffer_load_dwordx4 v[72:75], v1, s[36:39], s101 offen offset:2048 sc1
    s_waitcnt lgkmcnt(6)
    v_mfma_f32_32x32x16_bf16 v[32:47], v[24:27], v[236:239], v[32:47]
    ds_read_b64_tr_b16 v[16:17], v4 offset:43008
    ds_read_b64_tr_b16 v[18:19], v4 offset:44032
    s_waitcnt lgkmcnt(6)
    v_mfma_f32_32x32x16_bf16 v[48:63], v[28:31], v[236:239], v[48:63]
    ds_read_b64_tr_b16 v[20:21], v5 offset:43008
    ds_read_b64_tr_b16 v[22:23], v5 offset:44032
    buffer_load_dwordx4 v[76:79], v1, s[36:39], s101 offen offset:3072 sc1
    s_waitcnt vmcnt(4)
    v_max3_u32 v6, v240, v241, v242
    v_max3_u32 v7, v243, v244, v245
    v_max3_u32 v7, v7, v246, v247
    v_max3_u32 v6, v6, v248, v249
    v_max3_u32 v7, v7, v250, v251
    v_max3_u32 v6, v6, v252, v253
    v_max3_u32 v7, v7, v254, v255
    v_max_u32 v6, v6, v7
    v_cmp_eq_u32 vcc, -1, v6
    s_cmp_eq_u64 vcc, 0
    s_cbranch_scc0 OG3
OB3:
    s_waitcnt lgkmcnt(6)
    v_mfma_f32_32x32x16_bf16 v[32:47], v[8:11], v[240:243], v[32:47]
    ds_read_b64_tr_b16 v[24:25], v4 offset:45056
    ds_read_b64_tr_b16 v[26:27], v4 offset:46080
    s_waitcnt lgkmcnt(6)
    v_mfma_f32_32x32x16_bf16 v[48:63], v[12:15], v[240:243], v[48:63]
    ds_read_b64_tr_b16 v[28:29], v5 offset:45056
    ds_read_b64_tr_b16 v[30:31], v5 offset:46080
    s_xor_b32 s101, s60, 20480
    buffer_load_dwordx4 v[80:83], v1, s[36:39], s101 offen offset:0 sc1
    s_waitcnt lgkmcnt(6)
    v_mfma_f32_32x32x16_bf16 v[32:47], v[16:19], v[244:247], v[32:47]
    ds_read_b64_tr_b16 v[8:9], v4 offset:47104
    ds_read_b64_tr_b16 v[10:11], v4 offset:48128
    s_waitcnt lgkmcnt(6)
    v_mfma_f32_32x32x16_bf16 v[48:63], v[20:23], v[244:247], v[48:63]
    ds_read_b64_tr_b16 v[12:13], v5 offset:47104
    ds_read_b64_tr_b16 v[14:15], v5 offset:48128
    buffer_load_dwordx4 v[84:87], v1, s[36:39], s101 offen offset:1024 sc1
    s_waitcnt lgkmcnt(6)
    v_mfma_f32_32x32x16_bf16 v[32:47], v[24:27], v[248:251], v[32:47]
    ds_read_b64_tr_b16 v[16:17], v2 offset:0
    ds_read_b64_tr_b16 v[18:19], v2 offset:1024
    s_waitcnt lgkmcnt(6)
    v_mfma_f32_32x32x16_bf16 v[48:63], v[28:31], v[248:251], v[48:63]
    ds_read_b64_tr_b16 v[20:21], v3 offset:0
    ds_read_b64_tr_b16 v[22:23], v3 offset:1024
    buffer_load_dwordx4 v[88:91], v1, s[36:39], s101 offen offset:2048 sc1
    s_waitcnt lgkmcnt(6)
    v_mfma_f32_32x32x16_bf16 v[32:47], v[8:11], v[252:255], v[32:47]
    ds_read_b64_tr_b16 v[24:25], v2 offset:2048
    ds_read_b64_tr_b16 v[26:27], v2 offset:3072
    s_waitcnt lgkmcnt(6)
    v_mfma_f32_32x32x16_bf16 v[48:63], v[12:15], v[252:255], v[48:63]
    ds_read_b64_tr_b16 v[28:29], v3 offset:2048
    ds_read_b64_tr_b16 v[30:31], v3 offset:3072
    buffer_load_dwordx4 v[92:95], v1, s[36:39], s101 offen offset:3072 sc1
    s_waitcnt vmcnt(4)
    v_max3_u32 v6, v64, v65, v66
    v_max3_u32 v7, v67, v68, v69
    v_max3_u32 v7, v7, v70, v71
    v_max3_u32 v6, v6, v72, v73
    v_max3_u32 v7, v7, v74, v75
    v_max3_u32 v6, v6, v76, v77
    v_max3_u32 v7, v7, v78, v79
    v_max_u32 v6, v6, v7
    v_cmp_eq_u32 vcc, -1, v6
    s_cmp_eq_u64 vcc, 0
    s_cbranch_scc0 OG4
OB4:
    s_waitcnt lgkmcnt(6)
    v_mfma_f32_32x32x16_bf16 v[32:47], v[16:19], v[64:67], v[32:47]
    ds_read_b64_tr_b16 v[8:9], v2 offset:4096
    ds_read_b64_tr_b16 v[10:11], v2 offset:5120
    s_waitcnt lgkmcnt(6)
    v_mfma_f32_32x32x16_bf16 v[48:63], v[20:23], v[64:67], v[48:63]
    ds_read_b64_tr_b16 v[12:13], v3 offset:4096
    ds_read_b64_tr_b16 v[14:15], v3 offset:5120
    s_xor_b32 s101, s60, 24576
    buffer_load_dwordx4 v[192:195], v1, s[36:39], s101 offen offset:0 sc1
    s_waitcnt lgkmcnt(6)
    v_mfma_f32_32x32x16_bf16 v[32:47], v[24:27], v[68:71], v[32:47]
    ds_read_b64_tr_b16 v[16:17], v2 offset:6144
    ds_read_b64_tr_b16 v[18:19], v2 offset:7168
    s_waitcnt lgkmcnt(6)
    v_mfma_f32_32x32x16_bf16 v[48:63], v[28:31], v[68:71], v[48:63]
    ds_read_b64_tr_b16 v[20:21], v3 offset:6144
    ds_read_b64_tr_b16 v[22:23], v3 offset:7168
    buffer_load_dwordx4 v[196:199], v1, s[36:39], s101 offen offset:1024 sc1
    s_waitcnt lgkmcnt(6)
    v_mfma_f32_32x32x16_bf16 v[32:47], v[8:11], v[72:75], v[32:47]
    ds_read_b64_tr_b16 v[24:25], v2 offset:8192
    ds_read_b64_tr_b16 v[26:27], v2 offset:9216
    s_waitcnt lgkmcnt(6)
    v_mfma_f32_32x32x16_bf16 v[48:63], v[12:15], v[72:75], v[48:63]
    ds_read_b64_tr_b16 v[28:29], v3 offset:8192
    ds_read_b64_tr_b16 v[30:31], v3 offset:9216
    buffer_load_dwordx4 v[200:203], v1, s[36:39], s101 offen offset:2048 sc1
    s_waitcnt lgkmcnt(6)
    v_mfma_f32_32x32x16_bf16 v[32:47], v[16:19], v[76:79], v[32:47]
    ds_read_b64_tr_b16 v[8:9], v2 offset:10240
    ds_read_b64_tr_b16 v[10:11], v2 offset:11264
    s_waitcnt lgkmcnt(6)
    v_mfma_f32_32x32x16_bf16 v[48:63], v[20:23], v[76:79], v[48:63]
    ds_read_b64_tr_b16 v[12:13], v3 offset:10240
    ds_read_b64_tr_b16 v[14:15], v3 offset:11264
    buffer_load_dwordx4 v[204:207], v1, s[36:39], s101 offen offset:3072 sc1
    s_waitcnt vmcnt(4)
    v_max3_u32 v6, v80, v81, v82
    v_max3_u32 v7, v83, v84, v85
    v_max3_u32 v7, v7, v86, v87
    v_max3_u32 v6, v6, v88, v89
    v_max3_u32 v7, v7, v90, v91
    v_max3_u32 v6, v6, v92, v93
    v_max3_u32 v7, v7, v94, v95
    v_max_u32 v6, v6, v7
    v_cmp_eq_u32 vcc, -1, v6
    s_cmp_eq_u64 vcc, 0
    s_cbranch_scc0 OG5
OB5:
    s_waitcnt lgkmcnt(6)
    v_mfma_f32_32x32x16_bf16 v[32:47], v[24:27], v[80:83], v[32:47]
    ds_read_b64_tr_b16 v[16:17], v2 offset:12288
    ds_read_b64_tr_b16 v[18:19], v2 offset:13312
    s_waitcnt lgkmcnt(6)
    v_mfma_f32_32x32x16_bf16 v[48:63], v[28:31], v[80:83], v[48:63]
    ds_read_b64_tr_b16 v[20:21], v3 offset:12288
    ds_read_b64_tr_b16 v[22:23], v3 offset:13312
    s_xor_b32 s101, s60, 28672
    buffer_load_dwordx4 v[208:211], v1, s[36:39], s101 offen offset:0 sc1
    s_waitcnt lgkmcnt(6)
    v_mfma_f32_32x32x16_bf16 v[32:47], v[8:11], v[84:87], v[32:47]
    ds_read_b64_tr_b16 v[24:25], v2 offset:14336
    ds_read_b64_tr_b16 v[26:27], v2 offset:15360
    s_waitcnt lgkmcnt(6)
    v_mfma_f32_32x32x16_bf16 v[48:63], v[12:15], v[84:87], v[48:63]
    ds_read_b64_tr_b16 v[28:29], v3 offset:14336
    ds_read_b64_tr_b16 v[30:31], v3 offset:15360
    buffer_load_dwordx4 v[212:215], v1, s[36:39], s101 offen offset:1024 sc1
    s_waitcnt lgkmcnt(6)
    v_mfma_f32_32x32x16_bf16 v[32:47], v[16:19], v[88:91], v[32:47]
    ds_read_b64_tr_b16 v[8:9], v2 offset:32768
    ds_read_b64_tr_b16 v[10:11], v2 offset:33792
    s_waitcnt lgkmcnt(6)
    v_mfma_f32_32x32x16_bf16 v[48:63], v[20:23], v[88:91], v[48:63]
    ds_read_b64_tr_b16 v[12:13], v3 offset:32768
    ds_read_b64_tr_b16 v[14:15], v3 offset:33792
    buffer_load_dwordx4 v[216:219], v1, s[36:39], s101 offen offset:2048 sc1
    s_waitcnt lgkmcnt(6)
    v_mfma_f32_32x32x16_bf16 v[32:47], v[24:27], v[92:95], v[32:47]
    ds_read_b64_tr_b16 v[16:17], v2 offset:34816
    ds_read_b64_tr_b16 v[18:19], v2 offset:35840
    s_waitcnt lgkmcnt(6)
    v_mfma_f32_32x32x16_bf16 v[48:63], v[28:31], v[92:95], v[48:63]
    ds_read_b64_tr_b16 v[20:21], v3 offset:34816
    ds_read_b64_tr_b16 v[22:23], v3 offset:35840
    buffer_load_dwordx4 v[220:223], v1, s[36:39], s101 offen offset:3072 sc1
    s_waitcnt vmcnt(4)
    v_max3_u32 v6, v192, v193, v194
    v_max3_u32 v7, v195, v196, v197
    v_max3_u32 v7, v7, v198, v199
    v_max3_u32 v6, v6, v200, v201
    v_max3_u32 v7, v7, v202, v203
    v_max3_u32 v6, v6, v204, v205
    v_max3_u32 v7, v7, v206, v207
    v_max_u32 v6, v6, v7
    v_cmp_eq_u32 vcc, -1, v6
    s_cmp_eq_u64 vcc, 0
    s_cbranch_scc0 OG6
OB6:
    s_waitcnt lgkmcnt(6)
    v_mfma_f32_32x32x16_bf16 v[32:47], v[8:11], v[192:195], v[32:47]
    ds_read_b64_tr_b16 v[24:25], v2 offset:36864
    ds_read_b64_tr_b16 v[26:27], v2 offset:37888
    s_waitcnt lgkmcnt(6)
    v_mfma_f32_32x32x16_bf16 v[48:63], v[12:15], v[192:195], v[48:63]
    ds_read_b64_tr_b16 v[28:29], v3 offset:36864
    ds_read_b64_tr_b16 v[30:31], v3 offset:37888
    buffer_store_dwordx4 v[180:183], v151, s[48:51], 0 offen
    s_waitcnt lgkmcnt(6)
    v_mfma_f32_32x32x16_bf16 v[32:47], v[16:19], v[196:199], v[32:47]
    ds_read_b64_tr_b16 v[8:9], v2 offset:38912
    ds_read_b64_tr_b16 v[10:11], v2 offset:39936
    s_waitcnt lgkmcnt(6)
    v_mfma_f32_32x32x16_bf16 v[48:63], v[20:23], v[196:199], v[48:63]
    ds_read_b64_tr_b16 v[12:13], v3 offset:38912
    ds_read_b64_tr_b16 v[14:15], v3 offset:39936
    buffer_store_dwordx4 v[184:187], v152, s[48:51], 0 offen
    s_waitcnt lgkmcnt(6)
    v_mfma_f32_32x32x16_bf16 v[32:47], v[24:27], v[200:203], v[32:47]
    ds_read_b64_tr_b16 v[16:17], v2 offset:40960
    ds_read_b64_tr_b16 v[18:19], v2 offset:41984
    s_waitcnt lgkmcnt(6)
    v_mfma_f32_32x32x16_bf16 v[48:63], v[28:31], v[200:203], v[48:63]
    ds_read_b64_tr_b16 v[20:21], v3 offset:40960
    ds_read_b64_tr_b16 v[22:23], v3 offset:41984
    s_waitcnt lgkmcnt(6)
    v_mfma_f32_32x32x16_bf16 v[32:47], v[8:11], v[204:207], v[32:47]
    ds_read_b64_tr_b16 v[24:25], v2 offset:43008
    ds_read_b64_tr_b16 v[26:27], v2 offset:44032
    s_waitcnt lgkmcnt(6)
    v_mfma_f32_32x32x16_bf16 v[48:63], v[12:15], v[204:207], v[48:63]
    ds_read_b64_tr_b16 v[28:29], v3 offset:43008
    ds_read_b64_tr_b16 v[30:31], v3 offset:44032
    s_waitcnt vmcnt(2)
    v_max3_u32 v6, v208, v209, v210
    v_max3_u32 v7, v211, v212, v213
    v_max3_u32 v7, v7, v214, v215
    v_max3_u32 v6, v6, v216, v217
    v_max3_u32 v7, v7, v218, v219
    v_max3_u32 v6, v6, v220, v221
    v_max3_u32 v7, v7, v222, v223
    v_max_u32 v6, v6, v7
    v_cmp_eq_u32 vcc, -1, v6
    s_cmp_eq_u64 vcc, 0
    s_cbranch_scc0 OG7
OB7:
    s_waitcnt lgkmcnt(6)
    v_mfma_f32_32x32x16_bf16 v[32:47], v[16:19], v[208:211], v[32:47]
    ds_read_b64_tr_b16 v[8:9], v2 offset:45056
    ds_read_b64_tr_b16 v[10:11], v2 offset:46080
    s_waitcnt lgkmcnt(6)
    v_mfma_f32_32x32x16_bf16 v[48:63], v[20:23], v[208:211], v[48:63]
    ds_read_b64_tr_b16 v[12:13], v3 offset:45056
    ds_read_b64_tr_b16 v[14:15], v3 offset:46080
    ds_read_b64_tr_b16 v[16:17], v2 offset:47104
    ds_read_b64_tr_b16 v[18:19], v2 offset:48128
    s_waitcnt lgkmcnt(6)
    v_mfma_f32_32x32x16_bf16 v[48:63], v[28:31], v[212:215], v[48:63]
    ds_read_b64_tr_b16 v[20:21], v3 offset:47104
    ds_read_b64_tr_b16 v[22:23], v3 offset:48128
    s_waitcnt lgkmcnt(4)
    v_mfma_f32_32x32x16_bf16 v[48:63], v[12:15], v[216:219], v[48:63]
    s_waitcnt lgkmcnt(0)
    v_mfma_f32_32x32x16_bf16 v[48:63], v[20:23], v[220:223], v[48:63]
    v_mfma_f32_32x32x16_bf16 v[32:47], v[24:27], v[212:215], v[32:47]
    v_mfma_f32_32x32x16_bf16 v[32:47], v[8:11], v[216:219], v[32:47]
    s_nop 9
    ds_write_b128 v144, v[48:51] offset:0
    ds_write_b128 v144, v[52:55] offset:1024
    v_mfma_f32_32x32x16_bf16 v[32:47], v[16:19], v[220:223], v[32:47]
    ds_write_b128 v144, v[56:59] offset:2048
    ds_write_b128 v144, v[60:63] offset:3072
    s_waitcnt lgkmcnt(0)
    s_barrier
    ds_read_b128 v[48:51], v149 offset:0
    ds_read_b128 v[52:55], v149 offset:1024
    ds_read_b128 v[56:59], v149 offset:2048
    ds_read_b128 v[60:63], v149 offset:3072
    s_waitcnt lgkmcnt(3)
    s_nop 2
    v_pk_add_f32 v[32:33], v[32:33], v[48:49]
    v_pk_add_f32 v[34:35], v[34:35], v[50:51]
    v_cvt_pk_bf16_f32 v8, v32, v33
    v_cvt_pk_bf16_f32 v9, v34, v35
    s_waitcnt lgkmcnt(2)
    v_pk_add_f32 v[36:37], v[36:37], v[52:53]
    v_pk_add_f32 v[38:39], v[38:39], v[54:55]
    v_cvt_pk_bf16_f32 v10, v36, v37
    v_cvt_pk_bf16_f32 v11, v38, v39
    s_nop 0
    v_permlane32_swap_b32 v8, v10
    v_permlane32_swap_b32 v9, v11
    buffer_store_dwordx4 v[8:11], v148, s[48:51], s52 offen offset:0
    s_waitcnt lgkmcnt(1)
    v_pk_add_f32 v[40:41], v[40:41], v[56:57]
    v_pk_add_f32 v[42:43], v[42:43], v[58:59]
    v_cvt_pk_bf16_f32 v12, v40, v41
    v_cvt_pk_bf16_f32 v13, v42, v43
    s_waitcnt lgkmcnt(0)
    v_pk_add_f32 v[44:45], v[44:45], v[60:61]
    v_pk_add_f32 v[46:47], v[46:47], v[62:63]
    v_cvt_pk_bf16_f32 v14, v44, v45
    v_cvt_pk_bf16_f32 v15, v46, v47
    s_nop 0
    v_permlane32_swap_b32 v12, v14
    v_permlane32_swap_b32 v13, v15
    buffer_store_dwordx4 v[12:15], v148, s[48:51], s52 offen offset:32
F_END:
    s_endpgm
KS1:
    s_mov_b32 s100, 0x1fc
    s_call_b64 s[96:97], KVSPIN
    s_branch KB1
KS2:
    s_mov_b32 s100, -1
    s_call_b64 s[96:97], KVSPIN
    s_branch KB2
CK1_O:
SP7:
    v_cmp_eq_u64 vcc, s[32:33], v[190:191]
    s_cmp_eq_u64 vcc, -1
    s_cbranch_scc1 SQ8
    s_sub_u32 s35, s35, 1
    s_cbranch_scc1 SQ8_t
    s_sleep 2
    buffer_load_dwordx2 v[190:191], v123, s[36:39], s79 offen sc1
    s_waitcnt vmcnt(0)
    s_branch SP7
SQ8_t:
    s_mov_b32 s35, 0
SQ8:
    s_branch CK1_B
CK2_O:
SP9:
    v_cmp_eq_u64 vcc, s[32:33], v[106:107]
    s_cmp_eq_u64 vcc, -1
    s_cbranch_scc1 SQ10
    s_sub_u32 s35, s35, 1
    s_cbranch_scc1 SQ10_t
    s_sleep 2
    buffer_load_dwordx2 v[106:107], v124, s[36:39], s86 offen sc1
    s_waitcnt vmcnt(0)
    s_branch SP9
SQ10_t:
    s_mov_b32 s35, 0
SQ10:
    s_branch CK2_B
CK3_O:
SP11:
    v_cmp_eq_u64 vcc, s[32:33], v[190:191]
    s_cmp_eq_u64 vcc, -1
    s_cbranch_scc1 SQ12
    s_sub_u32 s35, s35, 1
    s_cbranch_scc1 SQ12_t
    s_sleep 2
    buffer_load_dwordx2 v[190:191], v127, s[36:39], 0 offen sc1
    s_waitcnt vmcnt(0)
    s_branch SP11
SQ12_t:
    s_mov_b32 s35, 0
SQ12:
    s_branch CK3_B
CK4_O:
SP13:
    v_cmp_eq_u64 vcc, s[32:33], v[106:107]
    s_cmp_eq_u64 vcc, -1
    s_cbranch_scc1 SQ14
    s_sub_u32 s35, s35, 1
    s_cbranch_scc1 SQ14_t
    s_sleep 2
    buffer_load_dwordx2 v[106:107], v124, s[36:39], s91 offen sc1
    s_waitcnt vmcnt(0)
    s_branch SP13
SQ14_t:
    s_mov_b32 s35, 0
SQ14:
    s_branch CK4_B
KVSPIN:
    s_waitcnt vmcnt(0)
SP15:
    v_cmp_eq_u64 vcc, s[32:33], v[106:107]
    s_and_b32 s53, vcc_lo, vcc_hi
    s_andn2_b32 s3, s100, s53
    s_cmp_eq_u32 s3, 0
    s_cbranch_scc1 SQ16
    s_sub_u32 s35, s35, 1
    s_cbranch_scc1 SQ16_t
    s_sleep 2
    buffer_load_dwordx2 v[106:107], v104, s[36:39], 0 offen sc1
    s_waitcnt vmcnt(0)
    s_branch SP15
SQ16_t:
    s_mov_b32 s35, 0
SQ16:
    s_setpc_b64 s[96:97]
AT_SLOW:
    v_mov_b32 v6, 0xff800000
    s_mov_b32 s3, s65
    s_add_u32 s52, s65, 0x40000
AT_MP:
    buffer_load_dwordx4 v[24:27], v1, s[40:43], s3 offen sc1
    buffer_load_dwordx4 v[28:31], v1, s[40:43], s3 offen offset:1024 sc1
    s_waitcnt vmcnt(0)
    v_mfma_f32_32x32x16_bf16 v[72:87], v[24:27], v[16:19], 0
    v_mfma_f32_32x32x16_bf16 v[72:87], v[28:31], v[20:23], v[72:87]
    s_nop 11
    v_max3_f32 v6, v6, v72, v73
    v_max3_f32 v6, v6, v74, v75
    v_max3_f32 v6, v6, v76, v77
    v_max3_f32 v6, v6, v78, v79
    v_max3_f32 v6, v6, v80, v81
    v_max3_f32 v6, v6, v82, v83
    v_max3_f32 v6, v6, v84, v85
    v_max3_f32 v6, v6, v86, v87
    s_add_u32 s3, s3, 4096
    s_cmp_lg_u32 s3, s52
    s_cbranch_scc1 AT_MP
    v_mov_b32 v7, v6
    s_nop 1
    v_permlane32_swap_b32 v6, v7
    v_max_f32 v6, v6, v7
    v_sub_f32 v40, 0, v6
    v_sub_f32 v41, 0, v6
    v_sub_f32 v42, 0, v6
    v_sub_f32 v43, 0, v6
    v_sub_f32 v44, 0, v6
    v_sub_f32 v45, 0, v6
    v_sub_f32 v46, 0, v6
    v_sub_f32 v47, 0, v6
    v_sub_f32 v48, 0, v6
    v_sub_f32 v49, 0, v6
    v_sub_f32 v50, 0, v6
    v_sub_f32 v51, 0, v6
    v_sub_f32 v52, 0, v6
    v_sub_f32 v53, 0, v6
    v_sub_f32 v54, 0, v6
    v_sub_f32 v55, 0, v6
    v_mov_b32 v56, 0
    v_mov_b32 v57, 0
    v_mov_b32 v58, 0
    v_mov_b32 v59, 0
    v_mov_b32 v60, 0
    v_mov_b32 v61, 0
    v_mov_b32 v62, 0
    v_mov_b32 v63, 0
    v_mov_b32 v64, 0
    v_mov_b32 v65, 0
    v_mov_b32 v66, 0
    v_mov_b32 v67, 0
    v_mov_b32 v68, 0
    v_mov_b32 v69, 0
    v_mov_b32 v70, 0
    v_mov_b32 v71, 0
    v_mov_b32 v12, 0
    v_mov_b32 v13, 0
    v_mov_b32 v14, 0
    v_mov_b32 v15, 0
    s_mov_b32 s3, s65
AT_SL:
    buffer_load_dwordx4 v[24:27], v1, s[40:43], s3 offen offset:0 sc1
    buffer_load_dwordx4 v[28:31], v1, s[40:43], s3 offen offset:1024 sc1
    buffer_load_dwordx4 v[32:35], v1, s[40:43], s3 offen offset:2048 sc1
    buffer_load_dwordx4 v[36:39], v1, s[40:43], s3 offen offset:3072 sc1
    s_waitcnt vmcnt(0)
    v_mfma_f32_32x32x16_bf16 v[72:87], v[24:27], v[16:19], v[40:55]
    v_mfma_f32_32x32x16_bf16 v[72:87], v[28:31], v[20:23], v[72:87]
    s_nop 11
    v_exp_f32 v72, v72
    v_exp_f32 v73, v73
    v_exp_f32 v74, v74
    v_exp_f32 v75, v75
    v_exp_f32 v76, v76
    v_exp_f32 v77, v77
    v_exp_f32 v78, v78
    v_exp_f32 v79, v79
    v_exp_f32 v80, v80
    v_exp_f32 v81, v81
    v_exp_f32 v82, v82
    v_exp_f32 v83, v83
    v_exp_f32 v84, v84
    v_exp_f32 v85, v85
    v_exp_f32 v86, v86
    v_exp_f32 v87, v87
    v_smfmac_f32_32x32x32_bf16 v[56:71], v[32:35], v[72:79], v5
    v_smfmac_f32_16x16x64_bf16 v[12:15], v[8:11], v[72:79], v5
    v_smfmac_f32_32x32x32_bf16 v[56:71], v[36:39], v[80:87], v5
    v_smfmac_f32_16x16x64_bf16 v[12:15], v[8:11], v[80:87], v5
    s_nop 15
    s_add_u32 s3, s3, 4096
    s_cmp_lg_u32 s3, s52
    s_cbranch_scc1 AT_SL
    s_branch AT_FIN
OG0:
    s_waitcnt vmcnt(0) lgkmcnt(0)
OL0:
    s_sub_u32 s35, s35, 1
    s_cbranch_scc1 OT0
    s_sleep 1
    s_xor_b32 s60, s60, 0x4000
    v_swap_b32 v2, v4
    v_swap_b32 v3, v5
    s_xor_b32 s3, s60, 0
    buffer_load_dwordx4 v[192:195], v1, s[36:39], s3 offen offset:0 sc1
    buffer_load_dwordx4 v[196:199], v1, s[36:39], s3 offen offset:1024 sc1
    buffer_load_dwordx4 v[200:203], v1, s[36:39], s3 offen offset:2048 sc1
    buffer_load_dwordx4 v[204:207], v1, s[36:39], s3 offen offset:3072 sc1
    s_xor_b32 s3, s60, 4096
    buffer_load_dwordx4 v[208:211], v1, s[36:39], s3 offen offset:0 sc1
    buffer_load_dwordx4 v[212:215], v1, s[36:39], s3 offen offset:1024 sc1
    buffer_load_dwordx4 v[216:219], v1, s[36:39], s3 offen offset:2048 sc1
    buffer_load_dwordx4 v[220:223], v1, s[36:39], s3 offen offset:3072 sc1
    ds_read_b64_tr_b16 v[8:9], v4 offset:0
    ds_read_b64_tr_b16 v[10:11], v4 offset:1024
    ds_read_b64_tr_b16 v[12:13], v5 offset:0
    ds_read_b64_tr_b16 v[14:15], v5 offset:1024
    ds_read_b64_tr_b16 v[16:17], v4 offset:2048
    ds_read_b64_tr_b16 v[18:19], v4 offset:3072
    ds_read_b64_tr_b16 v[20:21], v5 offset:2048
    ds_read_b64_tr_b16 v[22:23], v5 offset:3072
    s_waitcnt vmcnt(0) lgkmcnt(0)
    v_max3_u32 v6, v192, v193, v194
    v_max3_u32 v7, v195, v196, v197
    v_max3_u32 v7, v7, v198, v199
    v_max3_u32 v6, v6, v200, v201
    v_max3_u32 v7, v7, v202, v203
    v_max3_u32 v6, v6, v204, v205
    v_max3_u32 v7, v7, v206, v207
    v_max_u32 v6, v6, v7
    v_cmp_eq_u32 vcc, -1, v6
    s_cmp_eq_u64 vcc, 0
    s_cbranch_scc0 OL0
    s_branch OB0
OT0:
    s_mov_b32 s35, 0
    s_branch OB0
OG1:
    s_waitcnt vmcnt(0)
OL1:
    s_sub_u32 s35, s35, 1
    s_cbranch_scc1 OT1
    s_sleep 1
    s_xor_b32 s3, s60, 4096
    buffer_load_dwordx4 v[208:211], v1, s[36:39], s3 offen offset:0 sc1
    buffer_load_dwordx4 v[212:215], v1, s[36:39], s3 offen offset:1024 sc1
    buffer_load_dwordx4 v[216:219], v1, s[36:39], s3 offen offset:2048 sc1
    buffer_load_dwordx4 v[220:223], v1, s[36:39], s3 offen offset:3072 sc1
    v_max3_u32 v6, v224, v225, v226
    v_max3_u32 v7, v227, v228, v229
    v_max3_u32 v7, v7, v230, v231
    v_max3_u32 v6, v6, v232, v233
    v_max3_u32 v7, v7, v234, v235
    v_max3_u32 v6, v6, v236, v237
    v_max3_u32 v7, v7, v238, v239
    v_max_u32 v6, v6, v7
    v_cmp_eq_u32 vcc, -1, v6
    s_cmp_eq_u64 vcc, 0
    s_cbranch_scc1 OS1_2
    s_xor_b32 s3, s60, 8192
    buffer_load_dwordx4 v[224:227], v1, s[36:39], s3 offen offset:0 sc1
    buffer_load_dwordx4 v[228:231], v1, s[36:39], s3 offen offset:1024 sc1
    buffer_load_dwordx4 v[232:235], v1, s[36:39], s3 offen offset:2048 sc1
    buffer_load_dwordx4 v[236:239], v1, s[36:39], s3 offen offset:3072 sc1
OS1_2:
    s_waitcnt vmcnt(0)
    v_max3_u32 v6, v208, v209, v210
    v_max3_u32 v7, v211, v212, v213
    v_max3_u32 v7, v7, v214, v215
    v_max3_u32 v6, v6, v216, v217
    v_max3_u32 v7, v7, v218, v219
    v_max3_u32 v6, v6, v220, v221
    v_max3_u32 v7, v7, v222, v223
    v_max_u32 v6, v6, v7
    v_cmp_eq_u32 vcc, -1, v6
    s_cmp_eq_u64 vcc, 0
    s_cbranch_scc0 OL1
    s_branch OB1
OT1:
    s_mov_b32 s35, 0
    s_branch OB1
OG2:
    s_waitcnt vmcnt(0)
OL2:
    s_sub_u32 s35, s35, 1
    s_cbranch_scc1 OT2
    s_sleep 1
    s_xor_b32 s3, s60, 8192
    buffer_load_dwordx4 v[224:227], v1, s[36:39], s3 offen offset:0 sc1
    buffer_load_dwordx4 v[228:231], v1, s[36:39], s3 offen offset:1024 sc1
    buffer_load_dwordx4 v[232:235], v1, s[36:39], s3 offen offset:2048 sc1
    buffer_load_dwordx4 v[236:239], v1, s[36:39], s3 offen offset:3072 sc1
    v_max3_u32 v6, v240, v241, v242
    v_max3_u32 v7, v243, v244, v245
    v_max3_u32 v7, v7, v246, v247
    v_max3_u32 v6, v6, v248, v249
    v_max3_u32 v7, v7, v250, v251
    v_max3_u32 v6, v6, v252, v253
    v_max3_u32 v7, v7, v254, v255
    v_max_u32 v6, v6, v7
    v_cmp_eq_u32 vcc, -1, v6
    s_cmp_eq_u64 vcc, 0
    s_cbranch_scc1 OS2_3
    s_xor_b32 s3, s60, 12288
    buffer_load_dwordx4 v[240:243], v1, s[36:39], s3 offen offset:0 sc1
    buffer_load_dwordx4 v[244:247], v1, s[36:39], s3 offen offset:1024 sc1
    buffer_load_dwordx4 v[248:251], v1, s[36:39], s3 offen offset:2048 sc1
    buffer_load_dwordx4 v[252:255], v1, s[36:39], s3 offen offset:3072 sc1
OS2_3:
    s_waitcnt vmcnt(0)
    v_max3_u32 v6, v224, v225, v226
    v_max3_u32 v7, v227, v228, v229
    v_max3_u32 v7, v7, v230, v231
    v_max3_u32 v6, v6, v232, v233
    v_max3_u32 v7, v7, v234, v235
    v_max3_u32 v6, v6, v236, v237
    v_max3_u32 v7, v7, v238, v239
    v_max_u32 v6, v6, v7
    v_cmp_eq_u32 vcc, -1, v6
    s_cmp_eq_u64 vcc, 0
    s_cbranch_scc0 OL2
    s_branch OB2
OT2:
    s_mov_b32 s35, 0
    s_branch OB2
OG3:
    s_waitcnt vmcnt(0)
OL3:
    s_sub_u32 s35, s35, 1
    s_cbranch_scc1 OT3
    s_sleep 1
    s_xor_b32 s3, s60, 12288
    buffer_load_dwordx4 v[240:243], v1, s[36:39], s3 offen offset:0 sc1
    buffer_load_dwordx4 v[244:247], v1, s[36:39], s3 offen offset:1024 sc1
    buffer_load_dwordx4 v[248:251], v1, s[36:39], s3 offen offset:2048 sc1
    buffer_load_dwordx4 v[252:255], v1, s[36:39], s3 offen offset:3072 sc1
    v_max3_u32 v6, v64, v65, v66
    v_max3_u32 v7, v67, v68, v69
    v_max3_u32 v7, v7, v70, v71
    v_max3_u32 v6, v6, v72, v73
    v_max3_u32 v7, v7, v74, v75
    v_max3_u32 v6, v6, v76, v77
    v_max3_u32 v7, v7, v78, v79
    v_max_u32 v6, v6, v7
    v_cmp_eq_u32 vcc, -1, v6
    s_cmp_eq_u64 vcc, 0
    s_cbranch_scc1 OS3_4
    s_xor_b32 s3, s60, 16384
    buffer_load_dwordx4 v[64:67], v1, s[36:39], s3 offen offset:0 sc1
    buffer_load_dwordx4 v[68:71], v1, s[36:39], s3 offen offset:1024 sc1
    buffer_load_dwordx4 v[72:75], v1, s[36:39], s3 offen offset:2048 sc1
    buffer_load_dwordx4 v[76:79], v1, s[36:39], s3 offen offset:3072 sc1
OS3_4:
    s_waitcnt vmcnt(0)
    v_max3_u32 v6, v240, v241, v242
    v_max3_u32 v7, v243, v244, v245
    v_max3_u32 v7, v7, v246, v247
    v_max3_u32 v6, v6, v248, v249
    v_max3_u32 v7, v7, v250, v251
    v_max3_u32 v6, v6, v252, v253
    v_max3_u32 v7, v7, v254, v255
    v_max_u32 v6, v6, v7
    v_cmp_eq_u32 vcc, -1, v6
    s_cmp_eq_u64 vcc, 0
    s_cbranch_scc0 OL3
    s_branch OB3
OT3:
    s_mov_b32 s35, 0
    s_branch OB3
OG4:
    s_waitcnt vmcnt(0)
OL4:
    s_sub_u32 s35, s35, 1
    s_cbranch_scc1 OT4
    s_sleep 1
    s_xor_b32 s3, s60, 16384
    buffer_load_dwordx4 v[64:67], v1, s[36:39], s3 offen offset:0 sc1
    buffer_load_dwordx4 v[68:71], v1, s[36:39], s3 offen offset:1024 sc1
    buffer_load_dwordx4 v[72:75], v1, s[36:39], s3 offen offset:2048 sc1
    buffer_load_dwordx4 v[76:79], v1, s[36:39], s3 offen offset:3072 sc1
    v_max3_u32 v6, v80, v81, v82
    v_max3_u32 v7, v83, v84, v85
    v_max3_u32 v7, v7, v86, v87
    v_max3_u32 v6, v6, v88, v89
    v_max3_u32 v7, v7, v90, v91
    v_max3_u32 v6, v6, v92, v93
    v_max3_u32 v7, v7, v94, v95
    v_max_u32 v6, v6, v7
    v_cmp_eq_u32 vcc, -1, v6
    s_cmp_eq_u64 vcc, 0
    s_cbranch_scc1 OS4_5
    s_xor_b32 s3, s60, 20480
    buffer_load_dwordx4 v[80:83], v1, s[36:39], s3 offen offset:0 sc1
    buffer_load_dwordx4 v[84:87], v1, s[36:39], s3 offen offset:1024 sc1
    buffer_load_dwordx4 v[88:91], v1, s[36:39], s3 offen offset:2048 sc1
    buffer_load_dwordx4 v[92:95], v1, s[36:39], s3 offen offset:3072 sc1
OS4_5:
    s_waitcnt vmcnt(0)
    v_max3_u32 v6, v64, v65, v66
    v_max3_u32 v7, v67, v68, v69
    v_max3_u32 v7, v7, v70, v71
    v_max3_u32 v6, v6, v72, v73
    v_max3_u32 v7, v7, v74, v75
    v_max3_u32 v6, v6, v76, v77
    v_max3_u32 v7, v7, v78, v79
    v_max_u32 v6, v6, v7
    v_cmp_eq_u32 vcc, -1, v6
    s_cmp_eq_u64 vcc, 0
    s_cbranch_scc0 OL4
    s_branch OB4
OT4:
    s_mov_b32 s35, 0
    s_branch OB4
OG5:
    s_waitcnt vmcnt(0)
OL5:
    s_sub_u32 s35, s35, 1
    s_cbranch_scc1 OT5
    s_sleep 1
    s_xor_b32 s3, s60, 20480
    buffer_load_dwordx4 v[80:83], v1, s[36:39], s3 offen offset:0 sc1
    buffer_load_dwordx4 v[84:87], v1, s[36:39], s3 offen offset:1024 sc1
    buffer_load_dwordx4 v[88:91], v1, s[36:39], s3 offen offset:2048 sc1
    buffer_load_dwordx4 v[92:95], v1, s[36:39], s3 offen offset:3072 sc1
    v_max3_u32 v6, v192, v193, v194
    v_max3_u32 v7, v195, v196, v197
    v_max3_u32 v7, v7, v198, v199
    v_max3_u32 v6, v6, v200, v201
    v_max3_u32 v7, v7, v202, v203
    v_max3_u32 v6, v6, v204, v205
    v_max3_u32 v7, v7, v206, v207
    v_max_u32 v6, v6, v7
    v_cmp_eq_u32 vcc, -1, v6
    s_cmp_eq_u64 vcc, 0
    s_cbranch_scc1 OS5_6
    s_xor_b32 s3, s60, 24576
    buffer_load_dwordx4 v[192:195], v1, s[36:39], s3 offen offset:0 sc1
    buffer_load_dwordx4 v[196:199], v1, s[36:39], s3 offen offset:1024 sc1
    buffer_load_dwordx4 v[200:203], v1, s[36:39], s3 offen offset:2048 sc1
    buffer_load_dwordx4 v[204:207], v1, s[36:39], s3 offen offset:3072 sc1
OS5_6:
    s_waitcnt vmcnt(0)
    v_max3_u32 v6, v80, v81, v82
    v_max3_u32 v7, v83, v84, v85
    v_max3_u32 v7, v7, v86, v87
    v_max3_u32 v6, v6, v88, v89
    v_max3_u32 v7, v7, v90, v91
    v_max3_u32 v6, v6, v92, v93
    v_max3_u32 v7, v7, v94, v95
    v_max_u32 v6, v6, v7
    v_cmp_eq_u32 vcc, -1, v6
    s_cmp_eq_u64 vcc, 0
    s_cbranch_scc0 OL5
    s_branch OB5
OT5:
    s_mov_b32 s35, 0
    s_branch OB5
OG6:
    s_waitcnt vmcnt(0)
OL6:
    s_sub_u32 s35, s35, 1
    s_cbranch_scc1 OT6
    s_sleep 1
    s_xor_b32 s3, s60, 24576
    buffer_load_dwordx4 v[192:195], v1, s[36:39], s3 offen offset:0 sc1
    buffer_load_dwordx4 v[196:199], v1, s[36:39], s3 offen offset:1024 sc1
    buffer_load_dwordx4 v[200:203], v1, s[36:39], s3 offen offset:2048 sc1
    buffer_load_dwordx4 v[204:207], v1, s[36:39], s3 offen offset:3072 sc1
    v_max3_u32 v6, v208, v209, v210
    v_max3_u32 v7, v211, v212, v213
    v_max3_u32 v7, v7, v214, v215
    v_max3_u32 v6, v6, v216, v217
    v_max3_u32 v7, v7, v218, v219
    v_max3_u32 v6, v6, v220, v221
    v_max3_u32 v7, v7, v222, v223
    v_max_u32 v6, v6, v7
    v_cmp_eq_u32 vcc, -1, v6
    s_cmp_eq_u64 vcc, 0
    s_cbranch_scc1 OS6_7
    s_xor_b32 s3, s60, 28672
    buffer_load_dwordx4 v[208:211], v1, s[36:39], s3 offen offset:0 sc1
    buffer_load_dwordx4 v[212:215], v1, s[36:39], s3 offen offset:1024 sc1
    buffer_load_dwordx4 v[216:219], v1, s[36:39], s3 offen offset:2048 sc1
    buffer_load_dwordx4 v[220:223], v1, s[36:39], s3 offen offset:3072 sc1
OS6_7:
    s_waitcnt vmcnt(0)
    v_max3_u32 v6, v192, v193, v194
    v_max3_u32 v7, v195, v196, v197
    v_max3_u32 v7, v7, v198, v199
    v_max3_u32 v6, v6, v200, v201
    v_max3_u32 v7, v7, v202, v203
    v_max3_u32 v6, v6, v204, v205
    v_max3_u32 v7, v7, v206, v207
    v_max_u32 v6, v6, v7
    v_cmp_eq_u32 vcc, -1, v6
    s_cmp_eq_u64 vcc, 0
    s_cbranch_scc0 OL6
    s_branch OB6
OT6:
    s_mov_b32 s35, 0
    s_branch OB6
OG7:
    s_waitcnt vmcnt(0)
OL7:
    s_sub_u32 s35, s35, 1
    s_cbranch_scc1 OT7
    s_sleep 1
    s_xor_b32 s3, s60, 28672
    buffer_load_dwordx4 v[208:211], v1, s[36:39], s3 offen offset:0 sc1
    buffer_load_dwordx4 v[212:215], v1, s[36:39], s3 offen offset:1024 sc1
    buffer_load_dwordx4 v[216:219], v1, s[36:39], s3 offen offset:2048 sc1
    buffer_load_dwordx4 v[220:223], v1, s[36:39], s3 offen offset:3072 sc1
    s_waitcnt vmcnt(0)
    v_max3_u32 v6, v208, v209, v210
    v_max3_u32 v7, v211, v212, v213
    v_max3_u32 v7, v7, v214, v215
    v_max3_u32 v6, v6, v216, v217
    v_max3_u32 v7, v7, v218, v219
    v_max3_u32 v6, v6, v220, v221
    v_max3_u32 v7, v7, v222, v223
    v_max_u32 v6, v6, v7
    v_cmp_eq_u32 vcc, -1, v6
    s_cmp_eq_u64 vcc, 0
    s_cbranch_scc0 OL7
    s_branch OB7
OT7:
    s_mov_b32 s35, 0
    s_branch OB7
.section .rodata,"a"
.p2align 6
.amdhsa_kernel concat_heads__spectral_fnet__mha_block__prompt_kernel
  .amdhsa_next_free_vgpr 256
  .amdhsa_next_free_sgpr 102
  .amdhsa_accum_offset 256
  .amdhsa_group_segment_fixed_size 0
  .amdhsa_kernarg_size 88
  .amdhsa_user_sgpr_count 2
  .amdhsa_user_sgpr_kernarg_segment_ptr 1
  .amdhsa_system_sgpr_workgroup_id_x 1
.end_amdhsa_kernel
```
